```python
import torch

def _softmax(x, axis=-1):
    return torch.softmax(x, dim=axis)
def _gelu(x):
    return torch.nn.functional.gelu(x, approximate="tanh")
def _silu(x):
    return torch.nn.functional.silu(x)
def _sigmoid(x):
    return torch.sigmoid(x)
def _layernorm(x, axis=-1, eps=1e-5):
    m = x.mean(dim=axis, keepdim=True)
    v = x.var(dim=axis, keepdim=True, unbiased=False)
    return (x - m) / torch.sqrt(v + eps)
def _scatter_add(tgt, idx, src, axis=0):
    return tgt.clone().index_add_(axis, idx, src)
def _segment_sum(src, seg, n):
    out = torch.zeros((n,) + src.shape[1:], dtype=src.dtype)
    return out.index_add_(0, seg, src)
def _pad(x, pw):
    flat = tuple(v for pair in reversed(pw) for v in pair)
    return torch.nn.functional.pad(x, flat)

kernel_name = 'concat_heads__mha_block_cached__gqa_block_cached__near_ridge'

def setup_inputs():

    _w = (lambda a: (lambda t: t.to(torch.bfloat16) if t.is_floating_point() else t)(torch.as_tensor(a)))
    def _A_setup():
        B, Sq, D = 8, 96, 576
        H, Sk, Dh = 32, 1024, 128
        return {
            "x": _w((lambda *s: torch.randn(*s, dtype=torch.bfloat16) * 0.8)(B, Sq, D)),
            "k_cache": _w((lambda *s: torch.randn(*s, dtype=torch.bfloat16) * 0.8)(B, H, Sk, Dh)),
            "v_cache": _w((lambda *s: torch.randn(*s, dtype=torch.bfloat16) * 0.05)(B, H, Sk, Dh)),
            "wq": _w((lambda *s: torch.randn(*s, dtype=torch.bfloat16) * 0.8)(D, H * Dh) * (D ** -0.5)),
            "wo": _w((lambda *s: torch.randn(*s, dtype=torch.bfloat16) * 0.05)(H * Dh, D) * ((H * Dh) ** -0.5)),
        }
    _A_in = _A_setup()

    def _B_setup():
        B, Sq, D = 8, 96, 576
        Hq, Hkv, Sk, Dh = 32, 32, 1024, 128
        assert Hq % Hkv == 0, (Hq, Hkv)
        return {
            "x": _w((lambda *s: torch.randn(*s, dtype=torch.bfloat16) * 0.8)(B, Sq, D)),
            "k_cache": _w((lambda *s: torch.randn(*s, dtype=torch.bfloat16) * 0.8)(B, Hkv, Sk, Dh)),
            "v_cache": _w((lambda *s: torch.randn(*s, dtype=torch.bfloat16) * 0.05)(B, Hkv, Sk, Dh)),
            "wq": _w((lambda *s: torch.randn(*s, dtype=torch.bfloat16) * 0.8)(D, Hq * Dh) * (D ** -0.5)),
            "wo": _w((lambda *s: torch.randn(*s, dtype=torch.bfloat16) * 0.05)(Hq * Dh, D) * ((Hq * Dh) ** -0.5)),
        }
    _B_in = _B_setup()

    return {
        "A_x": _A_in["x"],
        "A_k_cache": _A_in["k_cache"],
        "A_v_cache": _A_in["v_cache"],
        "A_wq": _A_in["wq"],
        "A_wo": _A_in["wo"],
        "B_x": _B_in["x"],
        "B_k_cache": _B_in["k_cache"],
        "B_v_cache": _B_in["v_cache"],
        "B_wq": _B_in["wq"],
        "B_wo": _B_in["wo"],
    }

def reference(A_x, A_k_cache, A_v_cache, A_wq, A_wo, B_x, B_k_cache, B_v_cache, B_wq, B_wo):
    def _A_ref(x, k_cache, v_cache, wq, wo):
        B, Sq, D = x.shape
        H, Dh = 32, 128
        q = (lambda x, *d: x.permute(*d))((x @ wq).reshape(B, Sq, H, Dh), 0, 2, 1, 3)
        scores = torch.einsum("bhqd,bhkd->bhqk", q, k_cache) * (Dh ** -0.5)
        p = _softmax(scores, axis=-1)
        o = torch.einsum("bhqk,bhkd->bhqd", p, v_cache)
        return (lambda x, *d: x.permute(*d))(o, 0, 2, 1, 3).reshape(B, Sq, H * Dh) @ wo

    def _B_ref(x, k_cache, v_cache, wq, wo):
        B, Sq, D = x.shape
        Hq, Dh = 32, 128
        Hkv = k_cache.shape[1]
        rep = Hq // Hkv
        q = (lambda x, *d: x.permute(*d))((x @ wq).reshape(B, Sq, Hq, Dh), 0, 2, 1, 3)
        k = (lambda x, n, axis: torch.repeat_interleave(x, n, dim=axis))(k_cache, rep, axis=1)
        v = (lambda x, n, axis: torch.repeat_interleave(x, n, dim=axis))(v_cache, rep, axis=1)
        scores = torch.einsum("bhqd,bhkd->bhqk", q, k) * (Dh ** -0.5)
        p = _softmax(scores, axis=-1)
        o = torch.einsum("bhqk,bhkd->bhqd", p, v)
        return (lambda x, *d: x.permute(*d))(o, 0, 2, 1, 3).reshape(B, Sq, Hq * Dh) @ wo

    a = _A_ref(A_x, A_k_cache, A_v_cache, A_wq, A_wo)
    b = _B_ref(B_x, B_k_cache, B_v_cache, B_wq, B_wo)
    return torch.concatenate([a, b], axis=-1)
```

```asm
; @launch grid=(256,1,1) block=(512,1,1) lds=163840
.amdgcn_target "amdgcn-amd-amdhsa--gfx950"
.text
.globl concat_heads__mha_block_cached__gqa_block_cached__near_ridge_kernel
.p2align 8
.type concat_heads__mha_block_cached__gqa_block_cached__near_ridge_kernel,@function
concat_heads__mha_block_cached__gqa_block_cached__near_ridge_kernel:
  s_cmp_ge_u32 s2, 256
  s_cbranch_scc1 L_end
  s_load_dwordx16 s[16:31], s[0:1], 0
  s_load_dwordx8 s[32:39], s[0:1], 64
  s_load_dwordx2 s[40:41], s[0:1], 96
  v_lshrrev_b32 v1, 6, v0
  s_mov_b32 s13, s2
  s_and_b32 s9, s2, 7
  v_readfirstlane_b32 s4, v1
  s_lshr_b32 s5, s9, 2
  s_and_b32 s6, s9, 3
  s_lshr_b32 s10, s2, 3
  s_lshr_b32 s7, s10, 2
  s_and_b32 s8, s10, 3
  s_xor_b32 s100, s8, 2
  v_and_b32 v0, 63, v0
  s_xor_b32 s9, s6, 3
  s_sub_u32 s9, s9, s6
  s_lshl_b32 s9, s9, 2
  s_add_u32 s99, s9, 16
  s_cmp_lt_u32 s4, 6
  s_cbranch_scc1 L_attn
  s_sub_u32 s83, s4, 6
  s_lshl_b32 s14, s83, 13
  v_lshrrev_b32 v36, 4, v0
  v_and_b32 v37, 15, v0
  v_lshlrev_b32 v38, 2, v36
  v_xor_b32 v38, v38, v37
  v_lshlrev_b32 v38, 4, v38
  v_lshl_add_u32 v6, v36, 13, v38
  v_add_u32 v7, 31744, v6
  v_add_u32 v8, 63488, v6
  v_add_u32 v9, 95232, v6
  s_lshl_b32 s9, s6, 2
  s_add_u32 s9, s9, s8
  s_add_u32 s10, s99, s100
  s_sub_u32 s10, s10, s8
  s_mul_i32 s10, s83, s10
  s_add_u32 s9, s9, s10
  s_lshl_b32 s85, s9, 8
  s_mul_i32 s9, s8, 3
  s_mul_i32 s87, s7, 2
  s_add_u32 s87, s9, s87
  s_mul_i32 s9, s87, 7282
  s_lshr_b32 s9, s9, 16
  s_mul_i32 s9, s9, 9
  s_sub_u32 s87, s87, s9
  s_mov_b32 s88, s87
  s_cmp_eq_u32 s5, 0
  s_waitcnt lgkmcnt(0)
  s_cselect_b64 s[56:57], s[22:23], s[32:33]
  s_mov_b32 s58, 4718592
  s_mov_b32 s59, 0x20000
  s_cselect_b64 s[44:45], s[16:17], s[26:27]
  s_mov_b32 s46, 884736
  s_mov_b32 s47, 0x20000
  s_lshl_b32 s78, s87, 19
  s_add_u32 s78, s78, s85
  s_add_u32 m0, s14, 98304
  s_nop 0
  buffer_load_dwordx4 v6, s[56:59], s78 offen offset:0  lds
  buffer_load_dwordx4 v7, s[56:59], s78 offen offset:1024  lds
  buffer_load_dwordx4 v8, s[56:59], s78 offen offset:2048  lds
  buffer_load_dwordx4 v9, s[56:59], s78 offen offset:3072  lds
  s_lshl_b32 s78, s87, 19
  s_add_u32 s78, s78, s85
  s_add_u32 s78, s78, 131072
  s_add_u32 m0, s14, 102400
  s_nop 0
  buffer_load_dwordx4 v6, s[56:59], s78 offen offset:0  lds
  buffer_load_dwordx4 v7, s[56:59], s78 offen offset:1024  lds
  buffer_load_dwordx4 v8, s[56:59], s78 offen offset:2048  lds
  buffer_load_dwordx4 v9, s[56:59], s78 offen offset:3072  lds
  v_lshrrev_b32 v39, 3, v0
  v_mul_u32_u24 v39, 1152, v39
  v_and_b32 v31, 7, v0
  v_add_u32 v10, 0, v36
  v_and_b32 v10, 7, v10
  v_xor_b32 v10, v10, v31
  v_lshl_add_u32 v10, v10, 4, v39
  v_add_u32 v11, 4, v36
  v_and_b32 v11, 7, v11
  v_xor_b32 v11, v11, v31
  v_lshl_add_u32 v11, v11, 4, v39
  v_add_u32 v11, 8192, v11
  v_add_u32 v12, 8, v36
  v_and_b32 v12, 7, v12
  v_xor_b32 v12, v12, v31
  v_lshl_add_u32 v12, v12, 4, v39
  v_add_u32 v12, 16384, v12
  v_add_u32 v13, 12, v36
  v_and_b32 v13, 7, v13
  v_xor_b32 v13, v13, v31
  v_lshl_add_u32 v13, v13, 4, v39
  v_add_u32 v13, 24576, v13
  s_mul_i32 s86, s7, 110592
  s_mul_i32 s10, s83, 55296
  s_add_u32 s86, s86, s10
  s_mul_i32 s89, s83, 6144
  s_lshl_b32 s78, s88, 7
  s_add_u32 s78, s78, s86
  s_add_u32 m0, s89, 65536
  s_nop 0
  buffer_load_dwordx4 v10, s[44:47], s78 offen offset:0  lds
  buffer_load_dwordx4 v11, s[44:47], s78 offen offset:1024  lds
  buffer_load_dwordx4 v12, s[44:47], s78 offen offset:2048  lds
  buffer_load_dwordx4 v13, s[44:47], s78 offen offset:3072  lds
  s_lshl_b32 s78, s88, 7
  s_add_u32 s78, s78, s86
  s_add_u32 s78, s78, 36864
  s_add_u32 m0, s89, 69632
  s_nop 0
  buffer_load_dwordx4 v10, s[44:47], s78 offen offset:0  lds
  buffer_load_dwordx4 v11, s[44:47], s78 offen offset:1024  lds
  s_add_u32 s88, s88, 1
  s_cmp_eq_u32 s88, 9
  s_cselect_b32 s88, 0, s88
  s_lshl_b32 s78, s87, 19
  s_add_u32 s78, s78, s85
  s_add_u32 s78, s78, 262144
  s_add_u32 m0, s14, 114688
  s_nop 0
  buffer_load_dwordx4 v6, s[56:59], s78 offen offset:0  lds
  buffer_load_dwordx4 v7, s[56:59], s78 offen offset:1024  lds
  buffer_load_dwordx4 v8, s[56:59], s78 offen offset:2048  lds
  buffer_load_dwordx4 v9, s[56:59], s78 offen offset:3072  lds
  s_lshl_b32 s78, s87, 19
  s_add_u32 s78, s78, s85
  s_add_u32 s78, s78, 393216
  s_add_u32 m0, s14, 118784
  s_nop 0
  buffer_load_dwordx4 v6, s[56:59], s78 offen offset:0  lds
  buffer_load_dwordx4 v7, s[56:59], s78 offen offset:1024  lds
  buffer_load_dwordx4 v8, s[56:59], s78 offen offset:2048  lds
  buffer_load_dwordx4 v9, s[56:59], s78 offen offset:3072  lds
  s_add_u32 s87, s87, 1
  s_cmp_eq_u32 s87, 9
  s_cselect_b32 s87, 0, s87
  s_lshl_b32 s9, s6, 2
  s_lshl_b32 s10, s7, 5
  s_add_u32 s10, s10, s9
  s_add_u32 s11, s10, s8
  s_lshl_b32 s72, s11, 18
  s_lshl_b32 s11, s5, 8
  s_add_u32 s10, s10, s11
  s_mul_i32 s42, s10, 24576
  s_add_u32 s10, s99, s100
  s_sub_u32 s10, s10, s8
  s_lshl_b32 s10, s10, 18
  s_add_u32 s92, s72, s10
  s_mul_i32 s10, s99, 24576
  s_add_u32 s93, s42, s10
  s_lshl_b32 s84, s83, 14
  s_cmp_eq_u32 s5, 0
  s_cselect_b64 s[48:49], s[18:19], s[28:29]
  s_mov_b32 s50, 67108864
  s_mov_b32 s51, 0x20000
  s_cselect_b64 s[52:53], s[20:21], s[30:31]
  s_cselect_b64 s[64:65], s[24:25], s[34:35]
  s_mov_b32 s66, 4718592
  s_mov_b32 s67, 0x20000
  s_mov_b64 s[60:61], s[40:41]
  s_mov_b32 s62, 289079296
  s_mov_b32 s63, 0x20000
  s_mov_b64 s[68:69], s[36:37]
  s_mov_b32 s70, 1769472
  s_mov_b32 s71, 0x20000
  s_mov_b64 s[16:17], s[38:39]
  s_mov_b32 s18, 256
  s_mov_b32 s19, 0x20000
  s_cmp_eq_u32 s83, 0
  s_cselect_b64 s[48:49], s[48:49], s[52:53]
  s_cselect_b64 vcc, -1, 0
  v_add_u32 v39, 0, v36
  v_xor_b32 v39, v39, v37
  v_lshlrev_b32 v39, 4, v39
  v_cndmask_b32 v39, v38, v39, vcc
  v_lshl_add_u32 v2, v36, 8, v39
  v_add_u32 v39, 4, v36
  v_xor_b32 v39, v39, v37
  v_lshlrev_b32 v39, 4, v39
  v_cndmask_b32 v39, v38, v39, vcc
  v_lshl_add_u32 v3, v36, 8, v39
  v_add_u32 v39, 8, v36
  v_xor_b32 v39, v39, v37
  v_lshlrev_b32 v39, 4, v39
  v_cndmask_b32 v39, v38, v39, vcc
  v_lshl_add_u32 v4, v36, 8, v39
  v_add_u32 v39, 12, v36
  v_xor_b32 v39, v39, v37
  v_lshlrev_b32 v39, 4, v39
  v_cndmask_b32 v39, v38, v39, vcc
  v_lshl_add_u32 v5, v36, 8, v39
  v_add_u32 v39, 0, v0
  v_mul_u32_u24 v31, 3641, v39
  v_lshrrev_b32 v31, 16, v31
  v_mul_u32_u24 v32, 18, v31
  v_sub_u32 v32, v39, v32
  v_mul_u32_u24 v31, 1152, v31
  v_lshl_add_u32 v31, v32, 4, v31
  v_subrev_u32 v14, 0, v31
  v_add_u32 v39, 64, v0
  v_mul_u32_u24 v31, 3641, v39
  v_lshrrev_b32 v31, 16, v31
  v_mul_u32_u24 v32, 18, v31
  v_sub_u32 v32, v39, v32
  v_mul_u32_u24 v31, 1152, v31
  v_lshl_add_u32 v31, v32, 4, v31
  v_subrev_u32 v15, 1024, v31
  v_add_u32 v39, 128, v0
  v_mul_u32_u24 v31, 3641, v39
  v_lshrrev_b32 v31, 16, v31
  v_mul_u32_u24 v32, 18, v31
  v_sub_u32 v32, v39, v32
  v_mul_u32_u24 v31, 1152, v31
  v_lshl_add_u32 v31, v32, 4, v31
  v_subrev_u32 v16, 2048, v31
  v_add_u32 v39, 192, v0
  v_mul_u32_u24 v31, 3641, v39
  v_lshrrev_b32 v31, 16, v31
  v_mul_u32_u24 v32, 18, v31
  v_sub_u32 v32, v39, v32
  v_mul_u32_u24 v31, 1152, v31
  v_lshl_add_u32 v31, v32, 4, v31
  v_subrev_u32 v17, 3072, v31
  v_add_u32 v39, 256, v0
  v_mul_u32_u24 v31, 3641, v39
  v_lshrrev_b32 v31, 16, v31
  v_mul_u32_u24 v32, 18, v31
  v_sub_u32 v32, v39, v32
  v_mul_u32_u24 v31, 1152, v31
  v_lshl_add_u32 v31, v32, 4, v31
  v_subrev_u32 v18, 0, v31
  v_add_u32 v39, 320, v0
  v_mul_u32_u24 v31, 3641, v39
  v_lshrrev_b32 v31, 16, v31
  v_mul_u32_u24 v32, 18, v31
  v_sub_u32 v32, v39, v32
  v_mul_u32_u24 v31, 1152, v31
  v_lshl_add_u32 v31, v32, 4, v31
  v_subrev_u32 v19, 1024, v31
  v_add_u32 v39, 384, v0
  v_mul_u32_u24 v31, 3641, v39
  v_lshrrev_b32 v31, 16, v31
  v_mul_u32_u24 v32, 18, v31
  v_sub_u32 v32, v39, v32
  v_mul_u32_u24 v31, 1152, v31
  v_lshl_add_u32 v31, v32, 4, v31
  v_subrev_u32 v20, 2048, v31
  v_add_u32 v39, 448, v0
  v_mul_u32_u24 v31, 3641, v39
  v_lshrrev_b32 v31, 16, v31
  v_mul_u32_u24 v32, 18, v31
  v_sub_u32 v32, v39, v32
  v_mul_u32_u24 v31, 1152, v31
  v_lshl_add_u32 v31, v32, 4, v31
  v_subrev_u32 v21, 3072, v31
  v_add_u32 v39, 512, v0
  v_mul_u32_u24 v31, 3641, v39
  v_lshrrev_b32 v31, 16, v31
  v_mul_u32_u24 v32, 18, v31
  v_sub_u32 v32, v39, v32
  v_mul_u32_u24 v31, 1152, v31
  v_lshl_add_u32 v31, v32, 4, v31
  v_subrev_u32 v22, 0, v31
  s_lshl_b32 s9, s6, 9
  s_lshl_b32 s10, s83, 5
  s_add_u32 s9, s9, s10
  s_mul_i32 s15, s9, 1152
  s_mul_i32 s9, s8, 288
  s_add_u32 s15, s15, s9
  s_mul_i32 s9, s99, 147456
  s_add_u32 s3, s15, s9
  s_mul_i32 s20, s83, 9216
  s_add_u32 s20, s20, 98304
  s_mul_i32 s21, s83, 9216
  s_add_u32 s21, s21, 116736
  s_mul_i32 s22, s83, 9216
  s_add_u32 s22, s22, 135168
  s_mul_i32 s23, s83, -88064
  s_add_u32 s23, s23, 153600
  s_mul_i32 s24, s83, 9216
  s_add_u32 s24, s24, 74752
  s_mul_i32 s25, s83, 9216
  s_add_u32 s25, s25, 0
  s_mul_i32 s26, s83, 14336
  s_add_u32 s26, s26, 18432
  s_mul_i32 s27, s83, 9216
  s_add_u32 s27, s27, 41984
  v_lshlrev_b32 v24, 4, v0
  v_add_u32 v26, s84, v24
  v_add_u32 v27, 65536, v26
  v_bfe_u32 v39, v0, 3, 2
  v_lshlrev_b32 v39, 14, v39
  v_and_b32 v31, 7, v0
  v_min_u32 v31, 5, v31
  v_lshl_add_u32 v39, v31, 2, v39
  s_and_b32 s9, s13, 0xe7
  s_lshl_b32 s9, s9, 11
  s_add_u32 s9, s9, 20447232
  v_add_u32 v23, s9, v39
  v_lshlrev_b32 v30, 2, v0
  s_mul_i32 s9, s8, 0
  s_mul_i32 s10, s6, 1
  s_add_u32 s9, s9, s10
  s_mul_i32 s10, s5, 4
  s_add_u32 s9, s9, s10
  s_and_b32 s9, s9, 15
  s_lshl_b32 s29, s9, 14
  s_lshl_b32 s78, s87, 19
  s_add_u32 s78, s78, s85
  s_add_u32 m0, s14, 131072
  s_nop 0
  buffer_load_dwordx4 v6, s[56:59], s78 offen offset:0  lds
  buffer_load_dwordx4 v7, s[56:59], s78 offen offset:1024  lds
  buffer_load_dwordx4 v8, s[56:59], s78 offen offset:2048  lds
  buffer_load_dwordx4 v9, s[56:59], s78 offen offset:3072  lds
  s_lshl_b32 s78, s87, 19
  s_add_u32 s78, s78, s85
  s_add_u32 s78, s78, 131072
  s_add_u32 m0, s14, 135168
  s_nop 0
  buffer_load_dwordx4 v6, s[56:59], s78 offen offset:0  lds
  buffer_load_dwordx4 v7, s[56:59], s78 offen offset:1024  lds
  buffer_load_dwordx4 v8, s[56:59], s78 offen offset:2048  lds
  buffer_load_dwordx4 v9, s[56:59], s78 offen offset:3072  lds
  s_lshl_b32 s78, s88, 7
  s_add_u32 s78, s78, s86
  s_add_u32 m0, s89, 77824
  s_nop 0
  buffer_load_dwordx4 v10, s[44:47], s78 offen offset:0  lds
  buffer_load_dwordx4 v11, s[44:47], s78 offen offset:1024  lds
  buffer_load_dwordx4 v12, s[44:47], s78 offen offset:2048  lds
  buffer_load_dwordx4 v13, s[44:47], s78 offen offset:3072  lds
  s_lshl_b32 s78, s88, 7
  s_add_u32 s78, s78, s86
  s_add_u32 s78, s78, 36864
  s_add_u32 m0, s89, 81920
  s_nop 0
  buffer_load_dwordx4 v10, s[44:47], s78 offen offset:0  lds
  buffer_load_dwordx4 v11, s[44:47], s78 offen offset:1024  lds
  s_add_u32 s88, s88, 1
  s_cmp_eq_u32 s88, 9
  s_cselect_b32 s88, 0, s88
  s_waitcnt vmcnt(28)
  s_waitcnt vmcnt(22)
  s_barrier
  s_lshl_b32 s78, s87, 19
  s_add_u32 s78, s78, s85
  s_add_u32 s78, s78, 262144
  s_add_u32 m0, s14, 147456
  s_nop 0
  buffer_load_dwordx4 v6, s[56:59], s78 offen offset:0  lds
  buffer_load_dwordx4 v7, s[56:59], s78 offen offset:1024  lds
  buffer_load_dwordx4 v8, s[56:59], s78 offen offset:2048  lds
  buffer_load_dwordx4 v9, s[56:59], s78 offen offset:3072  lds
  s_lshl_b32 s78, s87, 19
  s_add_u32 s78, s78, s85
  s_add_u32 s78, s78, 393216
  s_add_u32 m0, s14, 151552
  s_nop 0
  buffer_load_dwordx4 v6, s[56:59], s78 offen offset:0  lds
  buffer_load_dwordx4 v7, s[56:59], s78 offen offset:1024  lds
  buffer_load_dwordx4 v8, s[56:59], s78 offen offset:2048  lds
  buffer_load_dwordx4 v9, s[56:59], s78 offen offset:3072  lds
  s_add_u32 s87, s87, 1
  s_cmp_eq_u32 s87, 9
  s_cselect_b32 s87, 0, s87
  s_add_u32 s28, s29, 0
  s_and_b32 s28, s28, 0x3ffff
  s_add_u32 s28, s28, s72
  s_add_u32 s82, s28, 0
  s_add_u32 m0, s84, 0
  s_nop 0
  buffer_load_dwordx4 v2, s[48:51], s82 offen offset:0 nt lds
  buffer_load_dwordx4 v3, s[48:51], s82 offen offset:1024 nt lds
  buffer_load_dwordx4 v4, s[48:51], s82 offen offset:2048 nt lds
  buffer_load_dwordx4 v5, s[48:51], s82 offen offset:3072 nt lds
  s_add_u32 s82, s28, 4096
  s_add_u32 m0, s84, 4096
  s_nop 0
  buffer_load_dwordx4 v2, s[48:51], s82 offen offset:0 nt lds
  buffer_load_dwordx4 v3, s[48:51], s82 offen offset:1024 nt lds
  s_waitcnt vmcnt(28)
  s_barrier
  s_lshl_b32 s78, s87, 19
  s_add_u32 s78, s78, s85
  s_add_u32 m0, s14, 98304
  s_nop 0
  buffer_load_dwordx4 v6, s[56:59], s78 offen offset:0  lds
  buffer_load_dwordx4 v7, s[56:59], s78 offen offset:1024  lds
  buffer_load_dwordx4 v8, s[56:59], s78 offen offset:2048  lds
  buffer_load_dwordx4 v9, s[56:59], s78 offen offset:3072  lds
  s_lshl_b32 s78, s87, 19
  s_add_u32 s78, s78, s85
  s_add_u32 s78, s78, 131072
  s_add_u32 m0, s14, 102400
  s_nop 0
  buffer_load_dwordx4 v6, s[56:59], s78 offen offset:0  lds
  buffer_load_dwordx4 v7, s[56:59], s78 offen offset:1024  lds
  buffer_load_dwordx4 v8, s[56:59], s78 offen offset:2048  lds
  buffer_load_dwordx4 v9, s[56:59], s78 offen offset:3072  lds
  s_add_u32 m0, s84, 4096
  s_nop 0
  buffer_load_dwordx4 v4, s[48:51], s82 offen offset:2048 nt lds
  buffer_load_dwordx4 v5, s[48:51], s82 offen offset:3072 nt lds
  s_add_u32 s82, s28, 8192
  s_add_u32 m0, s84, 8192
  s_nop 0
  buffer_load_dwordx4 v2, s[48:51], s82 offen offset:0 nt lds
  buffer_load_dwordx4 v3, s[48:51], s82 offen offset:1024 nt lds
  buffer_load_dwordx4 v4, s[48:51], s82 offen offset:2048 nt lds
  s_waitcnt vmcnt(33)
  s_waitcnt vmcnt(27)
  s_barrier
  s_lshl_b32 s78, s87, 19
  s_add_u32 s78, s78, s85
  s_add_u32 s78, s78, 262144
  s_add_u32 m0, s14, 114688
  s_nop 0
  buffer_load_dwordx4 v6, s[56:59], s78 offen offset:0  lds
  buffer_load_dwordx4 v7, s[56:59], s78 offen offset:1024  lds
  buffer_load_dwordx4 v8, s[56:59], s78 offen offset:2048  lds
  buffer_load_dwordx4 v9, s[56:59], s78 offen offset:3072  lds
  s_lshl_b32 s78, s87, 19
  s_add_u32 s78, s78, s85
  s_add_u32 s78, s78, 393216
  s_add_u32 m0, s14, 118784
  s_nop 0
  buffer_load_dwordx4 v6, s[56:59], s78 offen offset:0  lds
  buffer_load_dwordx4 v7, s[56:59], s78 offen offset:1024  lds
  buffer_load_dwordx4 v8, s[56:59], s78 offen offset:2048  lds
  buffer_load_dwordx4 v9, s[56:59], s78 offen offset:3072  lds
  s_add_u32 s87, s87, 1
  s_cmp_eq_u32 s87, 9
  s_cselect_b32 s87, 0, s87
  s_lshl_b32 s78, s88, 7
  s_add_u32 s78, s78, s86
  s_add_u32 m0, s89, 65536
  s_nop 0
  buffer_load_dwordx4 v10, s[44:47], s78 offen offset:0  lds
  buffer_load_dwordx4 v11, s[44:47], s78 offen offset:1024  lds
  buffer_load_dwordx4 v12, s[44:47], s78 offen offset:2048  lds
  buffer_load_dwordx4 v13, s[44:47], s78 offen offset:3072  lds
  s_lshl_b32 s78, s88, 7
  s_add_u32 s78, s78, s86
  s_add_u32 s78, s78, 36864
  s_add_u32 m0, s89, 69632
  s_nop 0
  buffer_load_dwordx4 v10, s[44:47], s78 offen offset:0  lds
  buffer_load_dwordx4 v11, s[44:47], s78 offen offset:1024  lds
  s_add_u32 s88, s88, 1
  s_cmp_eq_u32 s88, 9
  s_cselect_b32 s88, 0, s88
  s_add_u32 m0, s84, 8192
  s_nop 0
  buffer_load_dwordx4 v5, s[48:51], s82 offen offset:3072 nt lds
  s_add_u32 s82, s28, 12288
  s_add_u32 m0, s84, 12288
  s_nop 0
  buffer_load_dwordx4 v2, s[48:51], s82 offen offset:0 nt lds
  buffer_load_dwordx4 v3, s[48:51], s82 offen offset:1024 nt lds
  buffer_load_dwordx4 v4, s[48:51], s82 offen offset:2048 nt lds
  buffer_load_dwordx4 v5, s[48:51], s82 offen offset:3072 nt lds
  s_waitcnt vmcnt(38)
  s_barrier
  s_lshl_b32 s78, s87, 19
  s_add_u32 s78, s78, s85
  s_add_u32 m0, s14, 131072
  s_nop 0
  buffer_load_dwordx4 v6, s[56:59], s78 offen offset:0  lds
  buffer_load_dwordx4 v7, s[56:59], s78 offen offset:1024  lds
  buffer_load_dwordx4 v8, s[56:59], s78 offen offset:2048  lds
  buffer_load_dwordx4 v9, s[56:59], s78 offen offset:3072  lds
  s_lshl_b32 s78, s87, 19
  s_add_u32 s78, s78, s85
  s_add_u32 s78, s78, 131072
  s_add_u32 m0, s14, 135168
  s_nop 0
  buffer_load_dwordx4 v6, s[56:59], s78 offen offset:0  lds
  buffer_load_dwordx4 v7, s[56:59], s78 offen offset:1024  lds
  buffer_load_dwordx4 v8, s[56:59], s78 offen offset:2048  lds
  buffer_load_dwordx4 v9, s[56:59], s78 offen offset:3072  lds
  s_add_u32 s28, s29, 16384
  s_and_b32 s28, s28, 0x3ffff
  s_add_u32 s28, s28, s72
  s_add_u32 s82, s28, 0
  s_add_u32 m0, s84, 32768
  s_nop 0
  buffer_load_dwordx4 v2, s[48:51], s82 offen offset:0 nt lds
  buffer_load_dwordx4 v3, s[48:51], s82 offen offset:1024 nt lds
  buffer_load_dwordx4 v4, s[48:51], s82 offen offset:2048 nt lds
  buffer_load_dwordx4 v5, s[48:51], s82 offen offset:3072 nt lds
  s_add_u32 s82, s28, 4096
  s_add_u32 m0, s84, 36864
  s_nop 0
  buffer_load_dwordx4 v2, s[48:51], s82 offen offset:0 nt lds
  s_waitcnt vmcnt(37)
  s_waitcnt vmcnt(18)
  s_barrier
  s_lshl_b32 s78, s87, 19
  s_add_u32 s78, s78, s85
  s_add_u32 s78, s78, 262144
  s_add_u32 m0, s14, 147456
  s_nop 0
  buffer_load_dwordx4 v6, s[56:59], s78 offen offset:0  lds
  buffer_load_dwordx4 v7, s[56:59], s78 offen offset:1024  lds
  buffer_load_dwordx4 v8, s[56:59], s78 offen offset:2048  lds
  buffer_load_dwordx4 v9, s[56:59], s78 offen offset:3072  lds
  s_lshl_b32 s78, s87, 19
  s_add_u32 s78, s78, s85
  s_add_u32 s78, s78, 393216
  s_add_u32 m0, s14, 151552
  s_nop 0
  buffer_load_dwordx4 v6, s[56:59], s78 offen offset:0  lds
  buffer_load_dwordx4 v7, s[56:59], s78 offen offset:1024  lds
  buffer_load_dwordx4 v8, s[56:59], s78 offen offset:2048  lds
  buffer_load_dwordx4 v9, s[56:59], s78 offen offset:3072  lds
  s_add_u32 s87, s87, 1
  s_cmp_eq_u32 s87, 9
  s_cselect_b32 s87, 0, s87
  s_lshl_b32 s78, s88, 7
  s_add_u32 s78, s78, s86
  s_add_u32 m0, s89, 77824
  s_nop 0
  buffer_load_dwordx4 v10, s[44:47], s78 offen offset:0  lds
  buffer_load_dwordx4 v11, s[44:47], s78 offen offset:1024  lds
  buffer_load_dwordx4 v12, s[44:47], s78 offen offset:2048  lds
  buffer_load_dwordx4 v13, s[44:47], s78 offen offset:3072  lds
  s_lshl_b32 s78, s88, 7
  s_add_u32 s78, s78, s86
  s_add_u32 s78, s78, 36864
  s_add_u32 m0, s89, 81920
  s_nop 0
  buffer_load_dwordx4 v10, s[44:47], s78 offen offset:0  lds
  buffer_load_dwordx4 v11, s[44:47], s78 offen offset:1024  lds
  s_add_u32 s88, s88, 1
  s_cmp_eq_u32 s88, 9
  s_cselect_b32 s88, 0, s88
  s_add_u32 m0, s84, 36864
  s_nop 0
  buffer_load_dwordx4 v3, s[48:51], s82 offen offset:1024 nt lds
  buffer_load_dwordx4 v4, s[48:51], s82 offen offset:2048 nt lds
  buffer_load_dwordx4 v5, s[48:51], s82 offen offset:3072 nt lds
  s_add_u32 s82, s28, 8192
  s_add_u32 m0, s84, 40960
  s_nop 0
  buffer_load_dwordx4 v2, s[48:51], s82 offen offset:0 nt lds
  s_barrier
  s_lshl_b32 s78, s87, 19
  s_add_u32 s78, s78, s85
  s_add_u32 m0, s14, 98304
  s_nop 0
  buffer_load_dwordx4 v6, s[56:59], s78 offen offset:0  lds
  buffer_load_dwordx4 v7, s[56:59], s78 offen offset:1024  lds
  buffer_load_dwordx4 v8, s[56:59], s78 offen offset:2048  lds
  buffer_load_dwordx4 v9, s[56:59], s78 offen offset:3072  lds
  s_lshl_b32 s78, s87, 19
  s_add_u32 s78, s78, s85
  s_add_u32 s78, s78, 131072
  s_add_u32 m0, s14, 102400
  s_nop 0
  buffer_load_dwordx4 v6, s[56:59], s78 offen offset:0  lds
  buffer_load_dwordx4 v7, s[56:59], s78 offen offset:1024  lds
  buffer_load_dwordx4 v8, s[56:59], s78 offen offset:2048  lds
  buffer_load_dwordx4 v9, s[56:59], s78 offen offset:3072  lds
  s_add_u32 m0, s84, 40960
  s_nop 0
  buffer_load_dwordx4 v3, s[48:51], s82 offen offset:1024 nt lds
  buffer_load_dwordx4 v4, s[48:51], s82 offen offset:2048 nt lds
  buffer_load_dwordx4 v5, s[48:51], s82 offen offset:3072 nt lds
  s_add_u32 s82, s28, 12288
  s_add_u32 m0, s84, 45056
  s_nop 0
  buffer_load_dwordx4 v2, s[48:51], s82 offen offset:0 nt lds
  buffer_load_dwordx4 v3, s[48:51], s82 offen offset:1024 nt lds
  s_waitcnt vmcnt(36)
  s_waitcnt vmcnt(17)
  s_barrier
  s_lshl_b32 s78, s87, 19
  s_add_u32 s78, s78, s85
  s_add_u32 s78, s78, 262144
  s_add_u32 m0, s14, 114688
  s_nop 0
  buffer_load_dwordx4 v6, s[56:59], s78 offen offset:0  lds
  buffer_load_dwordx4 v7, s[56:59], s78 offen offset:1024  lds
  buffer_load_dwordx4 v8, s[56:59], s78 offen offset:2048  lds
  buffer_load_dwordx4 v9, s[56:59], s78 offen offset:3072  lds
  s_lshl_b32 s78, s87, 19
  s_add_u32 s78, s78, s85
  s_add_u32 s78, s78, 393216
  s_add_u32 m0, s14, 118784
  s_nop 0
  buffer_load_dwordx4 v6, s[56:59], s78 offen offset:0  lds
  buffer_load_dwordx4 v7, s[56:59], s78 offen offset:1024  lds
  buffer_load_dwordx4 v8, s[56:59], s78 offen offset:2048  lds
  buffer_load_dwordx4 v9, s[56:59], s78 offen offset:3072  lds
  s_add_u32 s87, s87, 1
  s_cmp_eq_u32 s87, 9
  s_cselect_b32 s87, 0, s87
  s_lshl_b32 s78, s88, 7
  s_add_u32 s78, s78, s86
  s_add_u32 m0, s89, 65536
  s_nop 0
  buffer_load_dwordx4 v10, s[44:47], s78 offen offset:0  lds
  buffer_load_dwordx4 v11, s[44:47], s78 offen offset:1024  lds
  buffer_load_dwordx4 v12, s[44:47], s78 offen offset:2048  lds
  buffer_load_dwordx4 v13, s[44:47], s78 offen offset:3072  lds
  s_lshl_b32 s78, s88, 7
  s_add_u32 s78, s78, s86
  s_add_u32 s78, s78, 36864
  s_add_u32 m0, s89, 69632
  s_nop 0
  buffer_load_dwordx4 v10, s[44:47], s78 offen offset:0  lds
  buffer_load_dwordx4 v11, s[44:47], s78 offen offset:1024  lds
  s_add_u32 s88, s88, 1
  s_cmp_eq_u32 s88, 9
  s_cselect_b32 s88, 0, s88
  s_add_u32 m0, s84, 45056
  s_nop 0
  buffer_load_dwordx4 v4, s[48:51], s82 offen offset:2048 nt lds
  buffer_load_dwordx4 v5, s[48:51], s82 offen offset:3072 nt lds
  s_add_u32 s28, s29, 32768
  s_and_b32 s28, s28, 0x3ffff
  s_add_u32 s28, s28, s72
  s_add_u32 s82, s28, 0
  buffer_load_dwordx4 v[40:43], v2, s[48:51], s82 offen offset:0 nt
  buffer_load_dwordx4 v[44:47], v3, s[48:51], s82 offen offset:1024 nt
  s_barrier
  s_lshl_b32 s78, s87, 19
  s_add_u32 s78, s78, s85
  s_add_u32 m0, s14, 131072
  s_nop 0
  buffer_load_dwordx4 v6, s[56:59], s78 offen offset:0  lds
  buffer_load_dwordx4 v7, s[56:59], s78 offen offset:1024  lds
  buffer_load_dwordx4 v8, s[56:59], s78 offen offset:2048  lds
  buffer_load_dwordx4 v9, s[56:59], s78 offen offset:3072  lds
  s_lshl_b32 s78, s87, 19
  s_add_u32 s78, s78, s85
  s_add_u32 s78, s78, 131072
  s_add_u32 m0, s14, 135168
  s_nop 0
  buffer_load_dwordx4 v6, s[56:59], s78 offen offset:0  lds
  buffer_load_dwordx4 v7, s[56:59], s78 offen offset:1024  lds
  buffer_load_dwordx4 v8, s[56:59], s78 offen offset:2048  lds
  buffer_load_dwordx4 v9, s[56:59], s78 offen offset:3072  lds
  buffer_load_dwordx4 v[48:51], v4, s[48:51], s82 offen offset:2048 nt
  buffer_load_dwordx4 v[52:55], v5, s[48:51], s82 offen offset:3072 nt
  s_add_u32 s82, s28, 4096
  buffer_load_dwordx4 v[56:59], v2, s[48:51], s82 offen offset:0 nt
  buffer_load_dwordx4 v[60:63], v3, s[48:51], s82 offen offset:1024 nt
  buffer_load_dwordx4 v[64:67], v4, s[48:51], s82 offen offset:2048 nt
  s_waitcnt vmcnt(36)
  s_waitcnt vmcnt(17)
  s_barrier
  s_lshl_b32 s78, s87, 19
  s_add_u32 s78, s78, s85
  s_add_u32 s78, s78, 262144
  s_add_u32 m0, s14, 147456
  s_nop 0
  buffer_load_dwordx4 v6, s[56:59], s78 offen offset:0  lds
  buffer_load_dwordx4 v7, s[56:59], s78 offen offset:1024  lds
  buffer_load_dwordx4 v8, s[56:59], s78 offen offset:2048  lds
  buffer_load_dwordx4 v9, s[56:59], s78 offen offset:3072  lds
  s_lshl_b32 s78, s87, 19
  s_add_u32 s78, s78, s85
  s_add_u32 s78, s78, 393216
  s_add_u32 m0, s14, 151552
  s_nop 0
  buffer_load_dwordx4 v6, s[56:59], s78 offen offset:0  lds
  buffer_load_dwordx4 v7, s[56:59], s78 offen offset:1024  lds
  buffer_load_dwordx4 v8, s[56:59], s78 offen offset:2048  lds
  buffer_load_dwordx4 v9, s[56:59], s78 offen offset:3072  lds
  s_add_u32 s87, s87, 1
  s_cmp_eq_u32 s87, 9
  s_cselect_b32 s87, 0, s87
  s_lshl_b32 s78, s88, 7
  s_add_u32 s78, s78, s86
  s_add_u32 m0, s89, 77824
  s_nop 0
  buffer_load_dwordx4 v10, s[44:47], s78 offen offset:0  lds
  buffer_load_dwordx4 v11, s[44:47], s78 offen offset:1024  lds
  buffer_load_dwordx4 v12, s[44:47], s78 offen offset:2048  lds
  buffer_load_dwordx4 v13, s[44:47], s78 offen offset:3072  lds
  s_lshl_b32 s78, s88, 7
  s_add_u32 s78, s78, s86
  s_add_u32 s78, s78, 36864
  s_add_u32 m0, s89, 81920
  s_nop 0
  buffer_load_dwordx4 v10, s[44:47], s78 offen offset:0  lds
  buffer_load_dwordx4 v11, s[44:47], s78 offen offset:1024  lds
  s_add_u32 s88, s88, 1
  s_cmp_eq_u32 s88, 9
  s_cselect_b32 s88, 0, s88
  buffer_load_dwordx4 v[68:71], v5, s[48:51], s82 offen offset:3072 nt
  s_add_u32 s82, s28, 8192
  buffer_load_dwordx4 v[72:75], v2, s[48:51], s82 offen offset:0 nt
  buffer_load_dwordx4 v[76:79], v3, s[48:51], s82 offen offset:1024 nt
  buffer_load_dwordx4 v[80:83], v4, s[48:51], s82 offen offset:2048 nt
  s_barrier
  s_lshl_b32 s78, s87, 19
  s_add_u32 s78, s78, s85
  s_add_u32 m0, s14, 98304
  s_nop 0
  buffer_load_dwordx4 v6, s[56:59], s78 offen offset:0  lds
  buffer_load_dwordx4 v7, s[56:59], s78 offen offset:1024  lds
  buffer_load_dwordx4 v8, s[56:59], s78 offen offset:2048  lds
  buffer_load_dwordx4 v9, s[56:59], s78 offen offset:3072  lds
  s_lshl_b32 s78, s87, 19
  s_add_u32 s78, s78, s85
  s_add_u32 s78, s78, 131072
  s_add_u32 m0, s14, 102400
  s_nop 0
  buffer_load_dwordx4 v6, s[56:59], s78 offen offset:0  lds
  buffer_load_dwordx4 v7, s[56:59], s78 offen offset:1024  lds
  buffer_load_dwordx4 v8, s[56:59], s78 offen offset:2048  lds
  buffer_load_dwordx4 v9, s[56:59], s78 offen offset:3072  lds
  buffer_load_dwordx4 v[84:87], v5, s[48:51], s82 offen offset:3072 nt
  s_add_u32 s82, s28, 12288
  buffer_load_dwordx4 v[88:91], v2, s[48:51], s82 offen offset:0 nt
  buffer_load_dwordx4 v[92:95], v3, s[48:51], s82 offen offset:1024 nt
  buffer_load_dwordx4 v[96:99], v4, s[48:51], s82 offen offset:2048 nt
  s_waitcnt vmcnt(35)
  s_waitcnt vmcnt(16)
  s_barrier
  s_lshl_b32 s78, s87, 19
  s_add_u32 s78, s78, s85
  s_add_u32 s78, s78, 262144
  s_add_u32 m0, s14, 114688
  s_nop 0
  buffer_load_dwordx4 v6, s[56:59], s78 offen offset:0  lds
  buffer_load_dwordx4 v7, s[56:59], s78 offen offset:1024  lds
  buffer_load_dwordx4 v8, s[56:59], s78 offen offset:2048  lds
  buffer_load_dwordx4 v9, s[56:59], s78 offen offset:3072  lds
  s_lshl_b32 s78, s87, 19
  s_add_u32 s78, s78, s85
  s_add_u32 s78, s78, 393216
  s_add_u32 m0, s14, 118784
  s_nop 0
  buffer_load_dwordx4 v6, s[56:59], s78 offen offset:0  lds
  buffer_load_dwordx4 v7, s[56:59], s78 offen offset:1024  lds
  buffer_load_dwordx4 v8, s[56:59], s78 offen offset:2048  lds
  buffer_load_dwordx4 v9, s[56:59], s78 offen offset:3072  lds
  s_add_u32 s87, s87, 1
  s_cmp_eq_u32 s87, 9
  s_cselect_b32 s87, 0, s87
  s_lshl_b32 s78, s88, 7
  s_add_u32 s78, s78, s86
  s_add_u32 m0, s89, 65536
  s_nop 0
  buffer_load_dwordx4 v10, s[44:47], s78 offen offset:0  lds
  buffer_load_dwordx4 v11, s[44:47], s78 offen offset:1024  lds
  buffer_load_dwordx4 v12, s[44:47], s78 offen offset:2048  lds
  buffer_load_dwordx4 v13, s[44:47], s78 offen offset:3072  lds
  s_lshl_b32 s78, s88, 7
  s_add_u32 s78, s78, s86
  s_add_u32 s78, s78, 36864
  s_add_u32 m0, s89, 69632
  s_nop 0
  buffer_load_dwordx4 v10, s[44:47], s78 offen offset:0  lds
  buffer_load_dwordx4 v11, s[44:47], s78 offen offset:1024  lds
  s_add_u32 s88, s88, 1
  s_cmp_eq_u32 s88, 9
  s_cselect_b32 s88, 0, s88
  buffer_load_dwordx4 v[100:103], v5, s[48:51], s82 offen offset:3072 nt
  s_add_u32 s28, s29, 49152
  s_and_b32 s28, s28, 0x3ffff
  s_add_u32 s28, s28, s72
  s_add_u32 s82, s28, 0
  buffer_load_dwordx4 v[104:107], v2, s[48:51], s82 offen offset:0 nt
  buffer_load_dwordx4 v[108:111], v3, s[48:51], s82 offen offset:1024 nt
  buffer_load_dwordx4 v[112:115], v4, s[48:51], s82 offen offset:2048 nt
  s_barrier
  s_lshl_b32 s78, s87, 19
  s_add_u32 s78, s78, s85
  s_add_u32 m0, s14, 131072
  s_nop 0
  buffer_load_dwordx4 v6, s[56:59], s78 offen offset:0  lds
  buffer_load_dwordx4 v7, s[56:59], s78 offen offset:1024  lds
  buffer_load_dwordx4 v8, s[56:59], s78 offen offset:2048  lds
  buffer_load_dwordx4 v9, s[56:59], s78 offen offset:3072  lds
  s_lshl_b32 s78, s87, 19
  s_add_u32 s78, s78, s85
  s_add_u32 s78, s78, 131072
  s_add_u32 m0, s14, 135168
  s_nop 0
  buffer_load_dwordx4 v6, s[56:59], s78 offen offset:0  lds
  buffer_load_dwordx4 v7, s[56:59], s78 offen offset:1024  lds
  buffer_load_dwordx4 v8, s[56:59], s78 offen offset:2048  lds
  buffer_load_dwordx4 v9, s[56:59], s78 offen offset:3072  lds
  buffer_load_dwordx4 v[116:119], v5, s[48:51], s82 offen offset:3072 nt
  s_add_u32 s82, s28, 4096
  buffer_load_dwordx4 v[120:123], v2, s[48:51], s82 offen offset:0 nt
  buffer_load_dwordx4 v[124:127], v3, s[48:51], s82 offen offset:1024 nt
  buffer_load_dwordx4 v[128:131], v4, s[48:51], s82 offen offset:2048 nt
  s_waitcnt vmcnt(34)
  s_waitcnt vmcnt(16)
  s_barrier
  s_lshl_b32 s78, s87, 19
  s_add_u32 s78, s78, s85
  s_add_u32 s78, s78, 262144
  s_add_u32 m0, s14, 147456
  s_nop 0
  buffer_load_dwordx4 v6, s[56:59], s78 offen offset:0  lds
  buffer_load_dwordx4 v7, s[56:59], s78 offen offset:1024  lds
  buffer_load_dwordx4 v8, s[56:59], s78 offen offset:2048  lds
  buffer_load_dwordx4 v9, s[56:59], s78 offen offset:3072  lds
  s_lshl_b32 s78, s87, 19
  s_add_u32 s78, s78, s85
  s_add_u32 s78, s78, 393216
  s_add_u32 m0, s14, 151552
  s_nop 0
  buffer_load_dwordx4 v6, s[56:59], s78 offen offset:0  lds
  buffer_load_dwordx4 v7, s[56:59], s78 offen offset:1024  lds
  buffer_load_dwordx4 v8, s[56:59], s78 offen offset:2048  lds
  buffer_load_dwordx4 v9, s[56:59], s78 offen offset:3072  lds
  s_add_u32 s87, s87, 1
  s_cmp_eq_u32 s87, 9
  s_cselect_b32 s87, 0, s87
  s_lshl_b32 s78, s88, 7
  s_add_u32 s78, s78, s86
  s_add_u32 m0, s89, 77824
  s_nop 0
  buffer_load_dwordx4 v10, s[44:47], s78 offen offset:0  lds
  buffer_load_dwordx4 v11, s[44:47], s78 offen offset:1024  lds
  buffer_load_dwordx4 v12, s[44:47], s78 offen offset:2048  lds
  buffer_load_dwordx4 v13, s[44:47], s78 offen offset:3072  lds
  s_lshl_b32 s78, s88, 7
  s_add_u32 s78, s78, s86
  s_add_u32 s78, s78, 36864
  s_add_u32 m0, s89, 81920
  s_nop 0
  buffer_load_dwordx4 v10, s[44:47], s78 offen offset:0  lds
  buffer_load_dwordx4 v11, s[44:47], s78 offen offset:1024  lds
  s_add_u32 s88, s88, 1
  s_cmp_eq_u32 s88, 9
  s_cselect_b32 s88, 0, s88
  buffer_load_dwordx4 v[132:135], v5, s[48:51], s82 offen offset:3072 nt
  s_add_u32 s82, s28, 8192
  buffer_load_dwordx4 v[136:139], v2, s[48:51], s82 offen offset:0 nt
  buffer_load_dwordx4 v[140:143], v3, s[48:51], s82 offen offset:1024 nt
  s_barrier
  s_lshl_b32 s78, s87, 19
  s_add_u32 s78, s78, s85
  s_add_u32 m0, s14, 98304
  s_nop 0
  buffer_load_dwordx4 v6, s[56:59], s78 offen offset:0  lds
  buffer_load_dwordx4 v7, s[56:59], s78 offen offset:1024  lds
  buffer_load_dwordx4 v8, s[56:59], s78 offen offset:2048  lds
  buffer_load_dwordx4 v9, s[56:59], s78 offen offset:3072  lds
  s_lshl_b32 s78, s87, 19
  s_add_u32 s78, s78, s85
  s_add_u32 s78, s78, 131072
  s_add_u32 m0, s14, 102400
  s_nop 0
  buffer_load_dwordx4 v6, s[56:59], s78 offen offset:0  lds
  buffer_load_dwordx4 v7, s[56:59], s78 offen offset:1024  lds
  buffer_load_dwordx4 v8, s[56:59], s78 offen offset:2048  lds
  buffer_load_dwordx4 v9, s[56:59], s78 offen offset:3072  lds
  buffer_load_dwordx4 v[144:147], v4, s[48:51], s82 offen offset:2048 nt
  buffer_load_dwordx4 v[148:151], v5, s[48:51], s82 offen offset:3072 nt
  s_add_u32 s82, s28, 12288
  buffer_load_dwordx4 v[152:155], v2, s[48:51], s82 offen offset:0 nt
  s_waitcnt vmcnt(32)
  s_waitcnt vmcnt(14)
  s_barrier
  s_lshl_b32 s78, s87, 19
  s_add_u32 s78, s78, s85
  s_add_u32 s78, s78, 262144
  s_add_u32 m0, s14, 114688
  s_nop 0
  buffer_load_dwordx4 v6, s[56:59], s78 offen offset:0  lds
  buffer_load_dwordx4 v7, s[56:59], s78 offen offset:1024  lds
  buffer_load_dwordx4 v8, s[56:59], s78 offen offset:2048  lds
  buffer_load_dwordx4 v9, s[56:59], s78 offen offset:3072  lds
  s_lshl_b32 s78, s87, 19
  s_add_u32 s78, s78, s85
  s_add_u32 s78, s78, 393216
  s_add_u32 m0, s14, 118784
  s_nop 0
  buffer_load_dwordx4 v6, s[56:59], s78 offen offset:0  lds
  buffer_load_dwordx4 v7, s[56:59], s78 offen offset:1024  lds
  buffer_load_dwordx4 v8, s[56:59], s78 offen offset:2048  lds
  buffer_load_dwordx4 v9, s[56:59], s78 offen offset:3072  lds
  s_add_u32 s87, s87, 1
  s_cmp_eq_u32 s87, 9
  s_cselect_b32 s87, 0, s87
  s_lshl_b32 s78, s88, 7
  s_add_u32 s78, s78, s86
  s_add_u32 m0, s89, 65536
  s_nop 0
  buffer_load_dwordx4 v10, s[44:47], s78 offen offset:0  lds
  buffer_load_dwordx4 v11, s[44:47], s78 offen offset:1024  lds
  buffer_load_dwordx4 v12, s[44:47], s78 offen offset:2048  lds
  buffer_load_dwordx4 v13, s[44:47], s78 offen offset:3072  lds
  s_lshl_b32 s78, s88, 7
  s_add_u32 s78, s78, s86
  s_add_u32 s78, s78, 36864
  s_add_u32 m0, s89, 69632
  s_nop 0
  buffer_load_dwordx4 v10, s[44:47], s78 offen offset:0  lds
  buffer_load_dwordx4 v11, s[44:47], s78 offen offset:1024  lds
  s_add_u32 s88, s88, 1
  s_cmp_eq_u32 s88, 9
  s_cselect_b32 s88, 0, s88
  buffer_load_dwordx4 v[156:159], v3, s[48:51], s82 offen offset:1024 nt
  buffer_load_dwordx4 v[160:163], v4, s[48:51], s82 offen offset:2048 nt
  buffer_load_dwordx4 v[164:167], v5, s[48:51], s82 offen offset:3072 nt
  s_barrier
  s_add_u32 s28, s29, 65536
  s_and_b32 s28, s28, 0x3ffff
  s_add_u32 s28, s28, s72
  s_add_u32 s82, s28, 0
  buffer_load_dwordx4 v[168:171], v2, s[48:51], s82 offen offset:0 nt
  buffer_load_dwordx4 v[172:175], v3, s[48:51], s82 offen offset:1024 nt
  buffer_load_dwordx4 v[176:179], v4, s[48:51], s82 offen offset:2048 nt
  s_waitcnt vmcnt(23)
  s_waitcnt vmcnt(6)
  s_barrier
  buffer_load_dwordx4 v[180:183], v5, s[48:51], s82 offen offset:3072 nt
  s_barrier
  s_add_u32 s82, s28, 4096
  buffer_load_dwordx4 v[184:187], v2, s[48:51], s82 offen offset:0 nt
  buffer_load_dwordx4 v[188:191], v3, s[48:51], s82 offen offset:1024 nt
  buffer_load_dwordx4 v[192:195], v4, s[48:51], s82 offen offset:2048 nt
  buffer_load_dwordx4 v[196:199], v5, s[48:51], s82 offen offset:3072 nt
  s_add_u32 s82, s28, 8192
  buffer_load_dwordx4 v[200:203], v2, s[48:51], s82 offen offset:0 nt
  buffer_load_dwordx4 v[204:207], v3, s[48:51], s82 offen offset:1024 nt
  buffer_load_dwordx4 v[208:211], v4, s[48:51], s82 offen offset:2048 nt
  buffer_load_dwordx4 v[212:215], v5, s[48:51], s82 offen offset:3072 nt
  s_add_u32 s82, s28, 12288
  buffer_load_dwordx4 v[216:219], v2, s[48:51], s82 offen offset:0 nt
  buffer_load_dwordx4 v[220:223], v3, s[48:51], s82 offen offset:1024 nt
  buffer_load_dwordx4 v[224:227], v4, s[48:51], s82 offen offset:2048 nt
  buffer_load_dwordx4 v[228:231], v5, s[48:51], s82 offen offset:3072 nt
  s_add_u32 s28, s29, 81920
  s_and_b32 s28, s28, 0x3ffff
  s_add_u32 s28, s28, s72
  s_add_u32 s82, s28, 0
  buffer_load_dwordx4 v[232:235], v2, s[48:51], s82 offen offset:0 nt
  buffer_load_dwordx4 v[236:239], v3, s[48:51], s82 offen offset:1024 nt
  buffer_load_dwordx4 v[240:243], v4, s[48:51], s82 offen offset:2048 nt
  buffer_load_dwordx4 v[244:247], v5, s[48:51], s82 offen offset:3072 nt
  s_barrier
  s_add_u32 s82, s28, 4096
  s_waitcnt vmcnt(11)
  buffer_load_dwordx4 v[248:251], v2, s[48:51], s82 offen offset:0 nt
  ds_write_b128 v27, v[40:43] offset:0
  ds_write_b128 v27, v[44:47] offset:1024
  ds_write_b128 v27, v[48:51] offset:2048
  s_waitcnt vmcnt(11)
  buffer_load_dwordx4 v[252:255], v3, s[48:51], s82 offen offset:1024 nt
  ds_write_b128 v27, v[52:55] offset:3072
  ds_write_b128 v27, v[56:59] offset:4096
  ds_write_b128 v27, v[60:63] offset:5120
  s_waitcnt lgkmcnt(0)
  s_waitcnt vmcnt(11)
  buffer_load_dwordx4 v[40:43], v4, s[48:51], s82 offen offset:2048 nt
  ds_write_b128 v27, v[64:67] offset:6144
  ds_write_b128 v27, v[68:71] offset:7168
  ds_write_b128 v27, v[72:75] offset:8192
  s_waitcnt vmcnt(11)
  buffer_load_dwordx4 v[44:47], v5, s[48:51], s82 offen offset:3072 nt
  ds_write_b128 v27, v[76:79] offset:9216
  ds_write_b128 v27, v[80:83] offset:10240
  ds_write_b128 v27, v[84:87] offset:11264
  s_add_u32 s82, s28, 8192
  s_waitcnt vmcnt(11)
  buffer_load_dwordx4 v[48:51], v2, s[48:51], s82 offen offset:0 nt
  ds_write_b128 v27, v[88:91] offset:12288
  ds_write_b128 v27, v[92:95] offset:13312
  ds_write_b128 v27, v[96:99] offset:14336
  s_waitcnt vmcnt(11)
  buffer_load_dwordx4 v[52:55], v3, s[48:51], s82 offen offset:1024 nt
  ds_write_b128 v27, v[100:103] offset:15360
  s_waitcnt vmcnt(11)
  buffer_load_dwordx4 v[56:59], v4, s[48:51], s82 offen offset:2048 nt
  s_waitcnt vmcnt(11)
  buffer_load_dwordx4 v[60:63], v5, s[48:51], s82 offen offset:3072 nt
  s_waitcnt lgkmcnt(0)
  s_add_u32 s82, s28, 12288
  s_waitcnt vmcnt(11)
  buffer_load_dwordx4 v[64:67], v2, s[48:51], s82 offen offset:0 nt
  s_waitcnt vmcnt(11)
  buffer_load_dwordx4 v[68:71], v3, s[48:51], s82 offen offset:1024 nt
  s_waitcnt vmcnt(11)
  buffer_load_dwordx4 v[72:75], v4, s[48:51], s82 offen offset:2048 nt
  s_waitcnt vmcnt(11)
  buffer_load_dwordx4 v[76:79], v5, s[48:51], s82 offen offset:3072 nt
  s_add_u32 s28, s29, 98304
  s_and_b32 s28, s28, 0x3ffff
  s_add_u32 s28, s28, s72
  s_add_u32 s82, s28, 0
  s_waitcnt vmcnt(11)
  buffer_load_dwordx4 v[80:83], v2, s[48:51], s82 offen offset:0 nt
  s_waitcnt vmcnt(11)
  buffer_load_dwordx4 v[84:87], v3, s[48:51], s82 offen offset:1024 nt
  s_waitcnt vmcnt(11)
  buffer_load_dwordx4 v[88:91], v4, s[48:51], s82 offen offset:2048 nt
  s_waitcnt vmcnt(11)
  buffer_load_dwordx4 v[92:95], v5, s[48:51], s82 offen offset:3072 nt
  s_barrier
  s_add_u32 s82, s28, 4096
  s_waitcnt vmcnt(11)
  buffer_load_dwordx4 v[96:99], v2, s[48:51], s82 offen offset:0 nt
  ds_write_b128 v26, v[104:107] offset:0
  ds_write_b128 v26, v[108:111] offset:1024
  ds_write_b128 v26, v[112:115] offset:2048
  s_waitcnt vmcnt(11)
  buffer_load_dwordx4 v[100:103], v3, s[48:51], s82 offen offset:1024 nt
  ds_write_b128 v26, v[116:119] offset:3072
  ds_write_b128 v26, v[120:123] offset:4096
  ds_write_b128 v26, v[124:127] offset:5120
  s_waitcnt lgkmcnt(0)
  s_waitcnt vmcnt(11)
  buffer_load_dwordx4 v[104:107], v4, s[48:51], s82 offen offset:2048 nt
  ds_write_b128 v26, v[128:131] offset:6144
  ds_write_b128 v26, v[132:135] offset:7168
  ds_write_b128 v26, v[136:139] offset:8192
  s_waitcnt vmcnt(11)
  buffer_load_dwordx4 v[108:111], v5, s[48:51], s82 offen offset:3072 nt
  ds_write_b128 v26, v[140:143] offset:9216
  ds_write_b128 v26, v[144:147] offset:10240
  ds_write_b128 v26, v[148:151] offset:11264
  s_add_u32 s82, s28, 8192
  s_waitcnt vmcnt(11)
  buffer_load_dwordx4 v[112:115], v2, s[48:51], s82 offen offset:0 nt
  ds_write_b128 v26, v[152:155] offset:12288
  ds_write_b128 v26, v[156:159] offset:13312
  ds_write_b128 v26, v[160:163] offset:14336
  s_waitcnt vmcnt(11)
  buffer_load_dwordx4 v[116:119], v3, s[48:51], s82 offen offset:1024 nt
  ds_write_b128 v26, v[164:167] offset:15360
  s_waitcnt vmcnt(11)
  buffer_load_dwordx4 v[120:123], v4, s[48:51], s82 offen offset:2048 nt
  s_waitcnt vmcnt(11)
  buffer_load_dwordx4 v[124:127], v5, s[48:51], s82 offen offset:3072 nt
  s_waitcnt lgkmcnt(0)
  s_add_u32 s82, s28, 12288
  s_waitcnt vmcnt(11)
  buffer_load_dwordx4 v[128:131], v2, s[48:51], s82 offen offset:0 nt
  s_waitcnt vmcnt(11)
  buffer_load_dwordx4 v[132:135], v3, s[48:51], s82 offen offset:1024 nt
  s_waitcnt vmcnt(11)
  buffer_load_dwordx4 v[136:139], v4, s[48:51], s82 offen offset:2048 nt
  s_waitcnt vmcnt(11)
  buffer_load_dwordx4 v[140:143], v5, s[48:51], s82 offen offset:3072 nt
  s_barrier
  s_add_u32 s28, s29, 114688
  s_and_b32 s28, s28, 0x3ffff
  s_add_u32 s28, s28, s72
  s_add_u32 s82, s28, 0
  s_waitcnt vmcnt(11)
  buffer_load_dwordx4 v[144:147], v2, s[48:51], s82 offen offset:0 nt
  ds_write_b128 v26, v[168:171] offset:32768
  ds_write_b128 v26, v[172:175] offset:33792
  ds_write_b128 v26, v[176:179] offset:34816
  s_waitcnt vmcnt(11)
  buffer_load_dwordx4 v[148:151], v3, s[48:51], s82 offen offset:1024 nt
  ds_write_b128 v26, v[180:183] offset:35840
  ds_write_b128 v26, v[184:187] offset:36864
  ds_write_b128 v26, v[188:191] offset:37888
  s_waitcnt vmcnt(11)
  buffer_load_dwordx4 v[152:155], v4, s[48:51], s82 offen offset:2048 nt
  ds_write_b128 v26, v[192:195] offset:38912
  ds_write_b128 v26, v[196:199] offset:39936
  ds_write_b128 v26, v[200:203] offset:40960
  s_waitcnt vmcnt(11)
  buffer_load_dwordx4 v[156:159], v5, s[48:51], s82 offen offset:3072 nt
  ds_write_b128 v26, v[204:207] offset:41984
  ds_write_b128 v26, v[208:211] offset:43008
  ds_write_b128 v26, v[212:215] offset:44032
  s_add_u32 s82, s28, 4096
  s_waitcnt vmcnt(11)
  buffer_load_dwordx4 v[160:163], v2, s[48:51], s82 offen offset:0 nt
  ds_write_b128 v26, v[216:219] offset:45056
  ds_write_b128 v26, v[220:223] offset:46080
  ds_write_b128 v26, v[224:227] offset:47104
  s_waitcnt vmcnt(11)
  buffer_load_dwordx4 v[164:167], v3, s[48:51], s82 offen offset:1024 nt
  ds_write_b128 v26, v[228:231] offset:48128
  s_waitcnt lgkmcnt(0)
  s_waitcnt vmcnt(11)
  buffer_load_dwordx4 v[168:171], v4, s[48:51], s82 offen offset:2048 nt
  s_waitcnt vmcnt(11)
  buffer_load_dwordx4 v[172:175], v5, s[48:51], s82 offen offset:3072 nt
  s_add_u32 s82, s28, 8192
  s_waitcnt vmcnt(11)
  buffer_load_dwordx4 v[176:179], v2, s[48:51], s82 offen offset:0 nt
  s_waitcnt vmcnt(11)
  buffer_load_dwordx4 v[180:183], v3, s[48:51], s82 offen offset:1024 nt
  s_waitcnt vmcnt(11)
  buffer_load_dwordx4 v[184:187], v4, s[48:51], s82 offen offset:2048 nt
  s_waitcnt vmcnt(11)
  buffer_load_dwordx4 v[188:191], v5, s[48:51], s82 offen offset:3072 nt
  s_barrier
  buffer_load_dword v31, v30, s[16:19], 0 offen sc1
  s_add_u32 s82, s28, 12288
  s_waitcnt vmcnt(12)
  buffer_load_dwordx4 v[192:195], v2, s[48:51], s82 offen offset:0 nt
  ds_write_b128 v27, v[232:235] offset:0
  ds_write_b128 v27, v[236:239] offset:1024
  ds_write_b128 v27, v[240:243] offset:2048
  s_waitcnt vmcnt(12)
  buffer_load_dwordx4 v[196:199], v3, s[48:51], s82 offen offset:1024 nt
  ds_write_b128 v27, v[244:247] offset:3072
  ds_write_b128 v27, v[248:251] offset:4096
  ds_write_b128 v27, v[252:255] offset:5120
  s_waitcnt vmcnt(12)
  buffer_load_dwordx4 v[200:203], v4, s[48:51], s82 offen offset:2048 nt
  ds_write_b128 v27, v[40:43] offset:6144
  ds_write_b128 v27, v[44:47] offset:7168
  ds_write_b128 v27, v[48:51] offset:8192
  s_waitcnt vmcnt(12)
  buffer_load_dwordx4 v[204:207], v5, s[48:51], s82 offen offset:3072 nt
  ds_write_b128 v27, v[52:55] offset:9216
  ds_write_b128 v27, v[56:59] offset:10240
  ds_write_b128 v27, v[60:63] offset:11264
  s_add_u32 s28, s29, 131072
  s_and_b32 s28, s28, 0x3ffff
  s_add_u32 s28, s28, s72
  s_add_u32 s82, s28, 0
  s_waitcnt vmcnt(12)
  buffer_load_dwordx4 v[208:211], v2, s[48:51], s82 offen offset:0 nt
  ds_write_b128 v27, v[64:67] offset:12288
  ds_write_b128 v27, v[68:71] offset:13312
  ds_write_b128 v27, v[72:75] offset:14336
  s_waitcnt vmcnt(12)
  buffer_load_dwordx4 v[212:215], v3, s[48:51], s82 offen offset:1024 nt
  ds_write_b128 v27, v[76:79] offset:15360
  s_waitcnt vmcnt(12)
  buffer_load_dwordx4 v[216:219], v4, s[48:51], s82 offen offset:2048 nt
  s_waitcnt vmcnt(12)
  buffer_load_dwordx4 v[220:223], v5, s[48:51], s82 offen offset:3072 nt
  s_add_u32 s82, s28, 4096
  s_waitcnt vmcnt(12)
  buffer_load_dwordx4 v[224:227], v2, s[48:51], s82 offen offset:0 nt
  s_waitcnt vmcnt(12)
  buffer_load_dwordx4 v[228:231], v3, s[48:51], s82 offen offset:1024 nt
  s_waitcnt lgkmcnt(0)
  s_waitcnt vmcnt(12)
  buffer_load_dwordx4 v[232:235], v4, s[48:51], s82 offen offset:2048 nt
  s_waitcnt vmcnt(12)
  buffer_load_dwordx4 v[236:239], v5, s[48:51], s82 offen offset:3072 nt
  s_barrier
  s_add_u32 s82, s28, 8192
  s_waitcnt vmcnt(11)
  buffer_load_dwordx4 v[240:243], v2, s[48:51], s82 offen offset:0 nt
  ds_write_b128 v26, v[80:83] offset:0
  ds_write_b128 v26, v[84:87] offset:1024
  ds_write_b128 v26, v[88:91] offset:2048
  s_waitcnt vmcnt(11)
  buffer_load_dwordx4 v[244:247], v3, s[48:51], s82 offen offset:1024 nt
  ds_write_b128 v26, v[92:95] offset:3072
  ds_write_b128 v26, v[96:99] offset:4096
  ds_write_b128 v26, v[100:103] offset:5120
  s_waitcnt vmcnt(11)
  buffer_load_dwordx4 v[248:251], v4, s[48:51], s82 offen offset:2048 nt
  ds_write_b128 v26, v[104:107] offset:6144
  ds_write_b128 v26, v[108:111] offset:7168
  ds_write_b128 v26, v[112:115] offset:8192
  s_waitcnt vmcnt(11)
  buffer_load_dwordx4 v[252:255], v5, s[48:51], s82 offen offset:3072 nt
  ds_write_b128 v26, v[116:119] offset:9216
  ds_write_b128 v26, v[120:123] offset:10240
  ds_write_b128 v26, v[124:127] offset:11264
  s_add_u32 s82, s28, 12288
  s_waitcnt vmcnt(11)
  buffer_load_dwordx4 v[40:43], v2, s[48:51], s82 offen offset:0 nt
  ds_write_b128 v26, v[128:131] offset:12288
  ds_write_b128 v26, v[132:135] offset:13312
  ds_write_b128 v26, v[136:139] offset:14336
  s_waitcnt vmcnt(11)
  buffer_load_dwordx4 v[44:47], v3, s[48:51], s82 offen offset:1024 nt
  ds_write_b128 v26, v[140:143] offset:15360
  s_waitcnt vmcnt(11)
  buffer_load_dwordx4 v[48:51], v4, s[48:51], s82 offen offset:2048 nt
  s_waitcnt vmcnt(11)
  buffer_load_dwordx4 v[52:55], v5, s[48:51], s82 offen offset:3072 nt
  s_add_u32 s28, s29, 147456
  s_and_b32 s28, s28, 0x3ffff
  s_add_u32 s28, s28, s72
  s_add_u32 s82, s28, 0
  s_waitcnt vmcnt(11)
  buffer_load_dwordx4 v[56:59], v2, s[48:51], s82 offen offset:0 nt
  s_waitcnt vmcnt(11)
  buffer_load_dwordx4 v[60:63], v3, s[48:51], s82 offen offset:1024 nt
  s_waitcnt vmcnt(11)
  buffer_load_dwordx4 v[64:67], v4, s[48:51], s82 offen offset:2048 nt
  s_waitcnt vmcnt(11)
  buffer_load_dwordx4 v[68:71], v5, s[48:51], s82 offen offset:3072 nt
  s_waitcnt lgkmcnt(0)
  s_barrier
  v_and_b32 v31, 0x01010101, v31
  v_cmp_ne_u32 vcc, 0x01010101, v31
  s_cbranch_vccnz aux_slowc
aux_cok:
  s_add_u32 s82, s28, 4096
  s_waitcnt vmcnt(11)
  buffer_load_dwordx4 v[72:75], v2, s[48:51], s82 offen offset:0 nt
  ds_write_b128 v26, v[144:147] offset:32768
  ds_write_b128 v26, v[148:151] offset:33792
  ds_write_b128 v26, v[152:155] offset:34816
  s_waitcnt vmcnt(11)
  buffer_load_dwordx4 v[76:79], v3, s[48:51], s82 offen offset:1024 nt
  ds_write_b128 v26, v[156:159] offset:35840
  ds_write_b128 v26, v[160:163] offset:36864
  ds_write_b128 v26, v[164:167] offset:37888
  s_waitcnt vmcnt(11)
  buffer_load_dwordx4 v[80:83], v4, s[48:51], s82 offen offset:2048 nt
  ds_write_b128 v26, v[168:171] offset:38912
  ds_write_b128 v26, v[172:175] offset:39936
  ds_write_b128 v26, v[176:179] offset:40960
  s_waitcnt vmcnt(11)
  buffer_load_dwordx4 v[84:87], v5, s[48:51], s82 offen offset:3072 nt
  ds_write_b128 v26, v[180:183] offset:41984
  ds_write_b128 v26, v[184:187] offset:43008
  ds_write_b128 v26, v[188:191] offset:44032
  s_add_u32 s82, s28, 8192
  s_waitcnt vmcnt(11)
  buffer_load_dwordx4 v[88:91], v2, s[48:51], s82 offen offset:0 nt
  ds_write_b128 v26, v[192:195] offset:45056
  ds_write_b128 v26, v[196:199] offset:46080
  ds_write_b128 v26, v[200:203] offset:47104
  s_waitcnt vmcnt(11)
  buffer_load_dwordx4 v[92:95], v3, s[48:51], s82 offen offset:1024 nt
  ds_write_b128 v26, v[204:207] offset:48128
  s_waitcnt vmcnt(11)
  buffer_load_dwordx4 v[96:99], v4, s[48:51], s82 offen offset:2048 nt
  s_waitcnt vmcnt(11)
  buffer_load_dwordx4 v[100:103], v5, s[48:51], s82 offen offset:3072 nt
  s_add_u32 s82, s28, 12288
  s_waitcnt vmcnt(11)
  buffer_load_dwordx4 v[104:107], v2, s[48:51], s82 offen offset:0 nt
  s_waitcnt vmcnt(11)
  buffer_load_dwordx4 v[108:111], v3, s[48:51], s82 offen offset:1024 nt
  s_waitcnt vmcnt(11)
  buffer_load_dwordx4 v[112:115], v4, s[48:51], s82 offen offset:2048 nt
  s_waitcnt vmcnt(11)
  buffer_load_dwordx4 v[116:119], v5, s[48:51], s82 offen offset:3072 nt
  s_waitcnt lgkmcnt(0)
  s_barrier
  s_add_u32 s28, s29, 163840
  s_and_b32 s28, s28, 0x3ffff
  s_add_u32 s28, s28, s72
  s_add_u32 s82, s28, 0
  s_waitcnt vmcnt(11)
  buffer_load_dwordx4 v[120:123], v2, s[48:51], s82 offen offset:0 nt
  ds_write_b128 v27, v[208:211] offset:0
  ds_write_b128 v27, v[212:215] offset:1024
  ds_write_b128 v27, v[216:219] offset:2048
  s_waitcnt vmcnt(11)
  buffer_load_dwordx4 v[124:127], v3, s[48:51], s82 offen offset:1024 nt
  ds_write_b128 v27, v[220:223] offset:3072
  ds_write_b128 v27, v[224:227] offset:4096
  ds_write_b128 v27, v[228:231] offset:5120
  s_waitcnt vmcnt(11)
  buffer_load_dwordx4 v[128:131], v4, s[48:51], s82 offen offset:2048 nt
  ds_write_b128 v27, v[232:235] offset:6144
  ds_write_b128 v27, v[236:239] offset:7168
  ds_write_b128 v27, v[240:243] offset:8192
  s_waitcnt vmcnt(11)
  buffer_load_dwordx4 v[132:135], v5, s[48:51], s82 offen offset:3072 nt
  ds_write_b128 v27, v[244:247] offset:9216
  ds_write_b128 v27, v[248:251] offset:10240
  ds_write_b128 v27, v[252:255] offset:11264
  s_add_u32 s82, s28, 4096
  s_waitcnt vmcnt(11)
  buffer_load_dwordx4 v[136:139], v2, s[48:51], s82 offen offset:0 nt
  ds_write_b128 v27, v[40:43] offset:12288
  ds_write_b128 v27, v[44:47] offset:13312
  ds_write_b128 v27, v[48:51] offset:14336
  s_waitcnt vmcnt(11)
  buffer_load_dwordx4 v[140:143], v3, s[48:51], s82 offen offset:1024 nt
  ds_write_b128 v27, v[52:55] offset:15360
  s_waitcnt vmcnt(11)
  buffer_load_dwordx4 v[144:147], v4, s[48:51], s82 offen offset:2048 nt
  s_waitcnt vmcnt(11)
  buffer_load_dwordx4 v[148:151], v5, s[48:51], s82 offen offset:3072 nt
  s_add_u32 s82, s28, 8192
  s_waitcnt vmcnt(11)
  buffer_load_dwordx4 v[152:155], v2, s[48:51], s82 offen offset:0 nt
  s_waitcnt vmcnt(11)
  buffer_load_dwordx4 v[156:159], v3, s[48:51], s82 offen offset:1024 nt
  s_waitcnt vmcnt(11)
  buffer_load_dwordx4 v[160:163], v4, s[48:51], s82 offen offset:2048 nt
  s_waitcnt vmcnt(11)
  buffer_load_dwordx4 v[164:167], v5, s[48:51], s82 offen offset:3072 nt
  s_waitcnt lgkmcnt(0)
  s_barrier
  s_add_u32 s82, s28, 12288
  s_waitcnt vmcnt(11)
  buffer_load_dwordx4 v[168:171], v2, s[48:51], s82 offen offset:0 nt
  ds_write_b128 v26, v[56:59] offset:0
  ds_write_b128 v26, v[60:63] offset:1024
  ds_write_b128 v26, v[64:67] offset:2048
  s_waitcnt vmcnt(11)
  buffer_load_dwordx4 v[172:175], v3, s[48:51], s82 offen offset:1024 nt
  ds_write_b128 v26, v[68:71] offset:3072
  ds_write_b128 v26, v[72:75] offset:4096
  ds_write_b128 v26, v[76:79] offset:5120
  s_waitcnt vmcnt(11)
  buffer_load_dwordx4 v[176:179], v4, s[48:51], s82 offen offset:2048 nt
  ds_write_b128 v26, v[80:83] offset:6144
  ds_write_b128 v26, v[84:87] offset:7168
  ds_write_b128 v26, v[88:91] offset:8192
  s_waitcnt vmcnt(11)
  buffer_load_dwordx4 v[180:183], v5, s[48:51], s82 offen offset:3072 nt
  ds_write_b128 v26, v[92:95] offset:9216
  ds_write_b128 v26, v[96:99] offset:10240
  ds_write_b128 v26, v[100:103] offset:11264
  s_add_u32 s28, s29, 180224
  s_and_b32 s28, s28, 0x3ffff
  s_add_u32 s28, s28, s72
  s_add_u32 s82, s28, 0
  s_waitcnt vmcnt(11)
  buffer_load_dwordx4 v[184:187], v2, s[48:51], s82 offen offset:0 nt
  ds_write_b128 v26, v[104:107] offset:12288
  ds_write_b128 v26, v[108:111] offset:13312
  ds_write_b128 v26, v[112:115] offset:14336
  s_waitcnt vmcnt(11)
  buffer_load_dwordx4 v[188:191], v3, s[48:51], s82 offen offset:1024 nt
  ds_write_b128 v26, v[116:119] offset:15360
  s_waitcnt vmcnt(11)
  buffer_load_dwordx4 v[192:195], v4, s[48:51], s82 offen offset:2048 nt
  s_waitcnt vmcnt(11)
  buffer_load_dwordx4 v[196:199], v5, s[48:51], s82 offen offset:3072 nt
  s_add_u32 s82, s28, 4096
  s_waitcnt vmcnt(11)
  buffer_load_dwordx4 v[200:203], v2, s[48:51], s82 offen offset:0 nt
  s_waitcnt vmcnt(11)
  buffer_load_dwordx4 v[204:207], v3, s[48:51], s82 offen offset:1024 nt
  s_waitcnt vmcnt(11)
  buffer_load_dwordx4 v[208:211], v4, s[48:51], s82 offen offset:2048 nt
  s_waitcnt vmcnt(11)
  buffer_load_dwordx4 v[212:215], v5, s[48:51], s82 offen offset:3072 nt
  s_waitcnt lgkmcnt(0)
  s_barrier
  s_add_u32 s82, s28, 8192
  s_waitcnt vmcnt(11)
  buffer_load_dwordx4 v[216:219], v2, s[48:51], s82 offen offset:0 nt
  ds_write_b128 v26, v[120:123] offset:32768
  ds_write_b128 v26, v[124:127] offset:33792
  ds_write_b128 v26, v[128:131] offset:34816
  s_waitcnt vmcnt(11)
  buffer_load_dwordx4 v[220:223], v3, s[48:51], s82 offen offset:1024 nt
  ds_write_b128 v26, v[132:135] offset:35840
  ds_write_b128 v26, v[136:139] offset:36864
  ds_write_b128 v26, v[140:143] offset:37888
  s_waitcnt vmcnt(11)
  buffer_load_dwordx4 v[224:227], v4, s[48:51], s82 offen offset:2048 nt
  ds_write_b128 v26, v[144:147] offset:38912
  ds_write_b128 v26, v[148:151] offset:39936
  ds_write_b128 v26, v[152:155] offset:40960
  s_waitcnt vmcnt(11)
  buffer_load_dwordx4 v[228:231], v5, s[48:51], s82 offen offset:3072 nt
  ds_write_b128 v26, v[156:159] offset:41984
  ds_write_b128 v26, v[160:163] offset:43008
  ds_write_b128 v26, v[164:167] offset:44032
  s_add_u32 s82, s28, 12288
  s_waitcnt vmcnt(11)
  buffer_load_dwordx4 v[232:235], v2, s[48:51], s82 offen offset:0 nt
  ds_write_b128 v26, v[168:171] offset:45056
  ds_write_b128 v26, v[172:175] offset:46080
  ds_write_b128 v26, v[176:179] offset:47104
  s_waitcnt vmcnt(11)
  buffer_load_dwordx4 v[236:239], v3, s[48:51], s82 offen offset:1024 nt
  ds_write_b128 v26, v[180:183] offset:48128
  s_waitcnt vmcnt(11)
  buffer_load_dwordx4 v[240:243], v4, s[48:51], s82 offen offset:2048 nt
  s_waitcnt vmcnt(11)
  buffer_load_dwordx4 v[244:247], v5, s[48:51], s82 offen offset:3072 nt
  s_add_u32 s28, s29, 196608
  s_and_b32 s28, s28, 0x3ffff
  s_add_u32 s28, s28, s72
  s_add_u32 s82, s28, 0
  s_waitcnt vmcnt(11)
  buffer_load_dwordx4 v[248:251], v2, s[48:51], s82 offen offset:0 nt
  s_waitcnt vmcnt(11)
  buffer_load_dwordx4 v[252:255], v3, s[48:51], s82 offen offset:1024 nt
  s_waitcnt vmcnt(11)
  buffer_load_dwordx4 v[40:43], v4, s[48:51], s82 offen offset:2048 nt
  s_waitcnt vmcnt(11)
  buffer_load_dwordx4 v[44:47], v5, s[48:51], s82 offen offset:3072 nt
  s_waitcnt lgkmcnt(0)
  s_barrier
  s_add_u32 s82, s28, 4096
  s_waitcnt vmcnt(11)
  buffer_load_dwordx4 v[48:51], v2, s[48:51], s82 offen offset:0 nt
  ds_write_b128 v27, v[184:187] offset:0
  ds_write_b128 v27, v[188:191] offset:1024
  ds_write_b128 v27, v[192:195] offset:2048
  s_waitcnt vmcnt(11)
  buffer_load_dwordx4 v[52:55], v3, s[48:51], s82 offen offset:1024 nt
  ds_write_b128 v27, v[196:199] offset:3072
  ds_write_b128 v27, v[200:203] offset:4096
  ds_write_b128 v27, v[204:207] offset:5120
  s_add_u32 s12, s8, 2
  s_and_b32 s12, s12, 3
  s_mul_i32 s78, s12, 147456
  s_add_u32 s78, s78, s15
  s_add_u32 s78, s78, 73728
  buffer_load_dwordx4 v[56:59], v14, s[64:67], s78 offen offset:0
  s_waitcnt vmcnt(12)
  buffer_load_dwordx4 v[60:63], v4, s[48:51], s82 offen offset:2048 nt
  ds_write_b128 v27, v[208:211] offset:6144
  ds_write_b128 v27, v[212:215] offset:7168
  ds_write_b128 v27, v[216:219] offset:8192
  s_waitcnt vmcnt(12)
  buffer_load_dwordx4 v[64:67], v5, s[48:51], s82 offen offset:3072 nt
  ds_write_b128 v27, v[220:223] offset:9216
  ds_write_b128 v27, v[224:227] offset:10240
  ds_write_b128 v27, v[228:231] offset:11264
  buffer_load_dwordx4 v[68:71], v15, s[64:67], s78 offen offset:1024
  s_add_u32 s82, s28, 8192
  s_waitcnt vmcnt(13)
  buffer_load_dwordx4 v[72:75], v2, s[48:51], s82 offen offset:0 nt
  ds_write_b128 v27, v[232:235] offset:12288
  s_waitcnt vmcnt(13)
  buffer_load_dwordx4 v[76:79], v3, s[48:51], s82 offen offset:1024 nt
  ds_write_b128 v27, v[236:239] offset:13312
  buffer_load_dwordx4 v[80:83], v16, s[64:67], s78 offen offset:2048
  s_waitcnt vmcnt(14)
  buffer_load_dwordx4 v[84:87], v4, s[48:51], s82 offen offset:2048 nt
  ds_write_b128 v27, v[240:243] offset:14336
  s_waitcnt vmcnt(14)
  buffer_load_dwordx4 v[88:91], v5, s[48:51], s82 offen offset:3072 nt
  ds_write_b128 v27, v[244:247] offset:15360
  buffer_load_dwordx4 v[92:95], v17, s[64:67], s78 offen offset:3072
  s_add_u32 s82, s28, 12288
  s_waitcnt vmcnt(15)
  buffer_load_dwordx4 v[96:99], v2, s[48:51], s82 offen offset:0 nt
  s_waitcnt vmcnt(15)
  buffer_load_dwordx4 v[100:103], v3, s[48:51], s82 offen offset:1024 nt
  buffer_load_dwordx4 v[104:107], v18, s[64:67], s78 offen offset:0
  s_waitcnt vmcnt(16)
  buffer_load_dwordx4 v[108:111], v4, s[48:51], s82 offen offset:2048 nt
  s_waitcnt vmcnt(16)
  buffer_load_dwordx4 v[112:115], v5, s[48:51], s82 offen offset:3072 nt
  buffer_load_dwordx4 v[116:119], v19, s[64:67], s78 offen offset:1024
  s_waitcnt lgkmcnt(0)
  s_barrier
  s_add_u32 s28, s29, 212992
  s_and_b32 s28, s28, 0x3ffff
  s_add_u32 s28, s28, s72
  s_add_u32 s82, s28, 0
  s_waitcnt vmcnt(17)
  buffer_load_dwordx4 v[120:123], v2, s[48:51], s82 offen offset:0 nt
  ds_write_b128 v26, v[248:251] offset:0
  ds_write_b128 v26, v[252:255] offset:1024
  ds_write_b128 v26, v[40:43] offset:2048
  s_waitcnt vmcnt(17)
  buffer_load_dwordx4 v[124:127], v3, s[48:51], s82 offen offset:1024 nt
  ds_write_b128 v26, v[44:47] offset:3072
  ds_write_b128 v26, v[48:51] offset:4096
  ds_write_b128 v26, v[52:55] offset:5120
  buffer_load_dwordx4 v[128:131], v20, s[64:67], s78 offen offset:2048
  s_waitcnt vmcnt(17)
  buffer_load_dwordx4 v[132:135], v4, s[48:51], s82 offen offset:2048 nt
  ds_write_b128 v26, v[60:63] offset:6144
  s_waitcnt vmcnt(17)
  buffer_load_dwordx4 v[136:139], v5, s[48:51], s82 offen offset:3072 nt
  ds_write_b128 v26, v[64:67] offset:7168
  buffer_load_dwordx4 v[140:143], v21, s[64:67], s78 offen offset:3072
  s_add_u32 s82, s28, 4096
  s_waitcnt vmcnt(17)
  buffer_load_dwordx4 v[144:147], v2, s[48:51], s82 offen offset:0 nt
  ds_write_b128 v26, v[72:75] offset:8192
  s_waitcnt vmcnt(17)
  buffer_load_dwordx4 v[148:151], v3, s[48:51], s82 offen offset:1024 nt
  ds_write_b128 v26, v[76:79] offset:9216
  buffer_load_dwordx4 v[152:155], v22, s[64:67], s78 offen offset:0
  s_waitcnt vmcnt(17)
  buffer_load_dwordx4 v[156:159], v4, s[48:51], s82 offen offset:2048 nt
  ds_write_b128 v26, v[84:87] offset:10240
  s_waitcnt vmcnt(17)
  buffer_load_dwordx4 v[160:163], v5, s[48:51], s82 offen offset:3072 nt
  ds_write_b128 v26, v[88:91] offset:11264
  s_add_u32 s82, s28, 8192
  s_waitcnt vmcnt(16)
  buffer_load_dwordx4 v[164:167], v2, s[48:51], s82 offen offset:0 nt
  ds_write_b128 v26, v[96:99] offset:12288
  s_waitcnt vmcnt(16)
  buffer_load_dwordx4 v[168:171], v3, s[48:51], s82 offen offset:1024 nt
  ds_write_b128 v26, v[100:103] offset:13312
  s_waitcnt vmcnt(15)
  buffer_load_dwordx4 v[172:175], v4, s[48:51], s82 offen offset:2048 nt
  ds_write_b128 v26, v[108:111] offset:14336
  s_waitcnt vmcnt(15)
  buffer_load_dwordx4 v[176:179], v5, s[48:51], s82 offen offset:3072 nt
  ds_write_b128 v26, v[112:115] offset:15360
  s_waitcnt lgkmcnt(0)
  s_barrier
  s_add_u32 s82, s28, 12288
  s_add_u32 m0, s84, 45056
  s_waitcnt vmcnt(14)
  buffer_load_dwordx4 v2, s[48:51], s82 offen offset:0 nt lds
  ds_write_b128 v26, v[120:123] offset:32768
  s_waitcnt vmcnt(14)
  buffer_load_dwordx4 v3, s[48:51], s82 offen offset:1024 nt lds
  ds_write_b128 v26, v[124:127] offset:33792
  s_add_u32 s12, s8, 3
  s_and_b32 s12, s12, 3
  s_mul_i32 s78, s12, 147456
  s_add_u32 s78, s78, s15
  buffer_load_dwordx4 v[180:183], v14, s[64:67], s78 offen offset:0
  s_waitcnt vmcnt(14)
  buffer_load_dwordx4 v4, s[48:51], s82 offen offset:2048 nt lds
  ds_write_b128 v26, v[132:135] offset:34816
  s_waitcnt vmcnt(14)
  buffer_load_dwordx4 v5, s[48:51], s82 offen offset:3072 nt lds
  ds_write_b128 v26, v[136:139] offset:35840
  buffer_load_dwordx4 v[184:187], v15, s[64:67], s78 offen offset:1024
  s_add_u32 s28, s29, 229376
  s_and_b32 s28, s28, 0x3ffff
  s_add_u32 s28, s28, s72
  s_add_u32 s82, s28, 0
  s_waitcnt vmcnt(14)
  buffer_load_dwordx4 v[188:191], v2, s[48:51], s82 offen offset:0 nt
  ds_write_b128 v26, v[144:147] offset:36864
  s_waitcnt vmcnt(14)
  buffer_load_dwordx4 v[192:195], v3, s[48:51], s82 offen offset:1024 nt
  ds_write_b128 v26, v[148:151] offset:37888
  buffer_load_dwordx4 v[196:199], v16, s[64:67], s78 offen offset:2048
  s_waitcnt vmcnt(14)
  buffer_load_dwordx4 v[200:203], v4, s[48:51], s82 offen offset:2048 nt
  ds_write_b128 v26, v[156:159] offset:38912
  s_waitcnt vmcnt(14)
  buffer_load_dwordx4 v[204:207], v5, s[48:51], s82 offen offset:3072 nt
  ds_write_b128 v26, v[160:163] offset:39936
  buffer_load_dwordx4 v[208:211], v17, s[64:67], s78 offen offset:3072
  s_add_u32 s82, s28, 4096
  s_waitcnt vmcnt(15)
  buffer_load_dwordx4 v[212:215], v2, s[48:51], s82 offen offset:0 nt
  ds_write_b128 v26, v[164:167] offset:40960
  s_waitcnt vmcnt(15)
  buffer_load_dwordx4 v[216:219], v3, s[48:51], s82 offen offset:1024 nt
  ds_write_b128 v26, v[168:171] offset:41984
  buffer_load_dwordx4 v[220:223], v18, s[64:67], s78 offen offset:0
  s_waitcnt vmcnt(16)
  buffer_load_dwordx4 v[224:227], v4, s[48:51], s82 offen offset:2048 nt
  ds_write_b128 v26, v[172:175] offset:43008
  s_waitcnt vmcnt(16)
  buffer_load_dwordx4 v[228:231], v5, s[48:51], s82 offen offset:3072 nt
  ds_write_b128 v26, v[176:179] offset:44032
  buffer_load_dwordx4 v[232:235], v19, s[64:67], s78 offen offset:1024
  s_waitcnt lgkmcnt(0)
  s_barrier
  s_add_u32 s82, s28, 8192
  s_add_u32 m0, s84, 73728
  s_waitcnt vmcnt(17)
  buffer_load_dwordx4 v2, s[48:51], s82 offen offset:0 nt lds
  s_waitcnt vmcnt(17)
  buffer_load_dwordx4 v3, s[48:51], s82 offen offset:1024 nt lds
  buffer_load_dwordx4 v[236:239], v20, s[64:67], s78 offen offset:2048
  s_waitcnt vmcnt(17)
  buffer_load_dwordx4 v4, s[48:51], s82 offen offset:2048 nt lds
  s_waitcnt vmcnt(17)
  buffer_load_dwordx4 v5, s[48:51], s82 offen offset:3072 nt lds
  buffer_load_dwordx4 v[240:243], v21, s[64:67], s78 offen offset:3072
  s_add_u32 s82, s28, 12288
  s_add_u32 m0, s84, 77824
  s_waitcnt vmcnt(17)
  buffer_load_dwordx4 v2, s[48:51], s82 offen offset:0 nt lds
  ds_write_b128 v27, v[188:191] offset:0
  s_waitcnt vmcnt(17)
  buffer_load_dwordx4 v3, s[48:51], s82 offen offset:1024 nt lds
  ds_write_b128 v27, v[192:195] offset:1024
  buffer_load_dwordx4 v[244:247], v22, s[64:67], s78 offen offset:0
  s_waitcnt vmcnt(17)
  buffer_load_dwordx4 v4, s[48:51], s82 offen offset:2048 nt lds
  ds_write_b128 v27, v[200:203] offset:2048
  s_waitcnt vmcnt(17)
  buffer_load_dwordx4 v5, s[48:51], s82 offen offset:3072 nt lds
  ds_write_b128 v27, v[204:207] offset:3072
  s_add_u32 s28, s29, 245760
  s_and_b32 s28, s28, 0x3ffff
  s_add_u32 s28, s28, s72
  s_add_u32 s82, s28, 0
  s_waitcnt vmcnt(16)
  buffer_load_dwordx4 v[248:251], v2, s[48:51], s82 offen offset:0 nt
  ds_write_b128 v27, v[212:215] offset:4096
  s_waitcnt vmcnt(16)
  buffer_load_dwordx4 v[252:255], v3, s[48:51], s82 offen offset:1024 nt
  ds_write_b128 v27, v[216:219] offset:5120
  s_waitcnt vmcnt(15)
  buffer_load_dwordx4 v[40:43], v4, s[48:51], s82 offen offset:2048 nt
  ds_write_b128 v27, v[224:227] offset:6144
  s_waitcnt vmcnt(15)
  buffer_load_dwordx4 v[44:47], v5, s[48:51], s82 offen offset:3072 nt
  ds_write_b128 v27, v[228:231] offset:7168
  s_waitcnt lgkmcnt(0)
  s_barrier
  s_add_u32 s82, s28, 4096
  s_add_u32 m0, s84, 4096
  s_waitcnt vmcnt(14)
  buffer_load_dwordx4 v2, s[48:51], s82 offen offset:0 nt lds
  s_waitcnt vmcnt(14)
  buffer_load_dwordx4 v3, s[48:51], s82 offen offset:1024 nt lds
  s_add_u32 s12, s8, 3
  s_and_b32 s12, s12, 3
  s_mul_i32 s78, s12, 147456
  s_add_u32 s78, s78, s15
  s_add_u32 s78, s78, 73728
  buffer_load_dwordx4 v[48:51], v14, s[64:67], s78 offen offset:0
  s_waitcnt vmcnt(14)
  buffer_load_dwordx4 v4, s[48:51], s82 offen offset:2048 nt lds
  s_waitcnt vmcnt(14)
  buffer_load_dwordx4 v5, s[48:51], s82 offen offset:3072 nt lds
  buffer_load_dwordx4 v[52:55], v15, s[64:67], s78 offen offset:1024
  s_add_u32 s82, s28, 8192
  s_add_u32 m0, s84, 8192
  s_waitcnt vmcnt(14)
  buffer_load_dwordx4 v2, s[48:51], s82 offen offset:0 nt lds
  s_waitcnt vmcnt(14)
  buffer_load_dwordx4 v3, s[48:51], s82 offen offset:1024 nt lds
  buffer_load_dwordx4 v[60:63], v16, s[64:67], s78 offen offset:2048
  s_waitcnt vmcnt(14)
  buffer_load_dwordx4 v4, s[48:51], s82 offen offset:2048 nt lds
  s_waitcnt vmcnt(14)
  buffer_load_dwordx4 v5, s[48:51], s82 offen offset:3072 nt lds
  buffer_load_dwordx4 v[64:67], v17, s[64:67], s78 offen offset:3072
  s_add_u32 s82, s28, 12288
  s_add_u32 m0, s84, 12288
  s_waitcnt vmcnt(15)
  buffer_load_dwordx4 v2, s[48:51], s82 offen offset:0 nt lds
  ds_write_b128 v26, v[248:251] offset:0
  s_waitcnt vmcnt(15)
  buffer_load_dwordx4 v3, s[48:51], s82 offen offset:1024 nt lds
  ds_write_b128 v26, v[252:255] offset:1024
  buffer_load_dwordx4 v[72:75], v18, s[64:67], s78 offen offset:0
  s_waitcnt vmcnt(16)
  buffer_load_dwordx4 v4, s[48:51], s82 offen offset:2048 nt lds
  ds_write_b128 v26, v[40:43] offset:2048
  s_waitcnt vmcnt(16)
  buffer_load_dwordx4 v5, s[48:51], s82 offen offset:3072 nt lds
  ds_write_b128 v26, v[44:47] offset:3072
  buffer_load_dwordx4 v[76:79], v19, s[64:67], s78 offen offset:1024
  s_waitcnt lgkmcnt(0)
  s_barrier
  s_add_u32 s28, s29, 0
  s_and_b32 s28, s28, 0x3ffff
  s_add_u32 s28, s28, s92
  s_add_u32 s82, s28, 0
  s_add_u32 m0, s84, 32768
  s_waitcnt vmcnt(17)
  buffer_load_dwordx4 v2, s[48:51], s82 offen offset:0 nt lds
  s_waitcnt vmcnt(17)
  buffer_load_dwordx4 v3, s[48:51], s82 offen offset:1024 nt lds
  buffer_load_dwordx4 v[84:87], v20, s[64:67], s78 offen offset:2048
  s_waitcnt vmcnt(17)
  buffer_load_dwordx4 v4, s[48:51], s82 offen offset:2048 nt lds
  s_waitcnt vmcnt(17)
  buffer_load_dwordx4 v5, s[48:51], s82 offen offset:3072 nt lds
  buffer_load_dwordx4 v[88:91], v21, s[64:67], s78 offen offset:3072
  s_add_u32 s82, s28, 4096
  s_add_u32 m0, s84, 36864
  s_waitcnt vmcnt(17)
  buffer_load_dwordx4 v2, s[48:51], s82 offen offset:0 nt lds
  s_waitcnt vmcnt(17)
  buffer_load_dwordx4 v3, s[48:51], s82 offen offset:1024 nt lds
  buffer_load_dwordx4 v[96:99], v22, s[64:67], s78 offen offset:0
  s_waitcnt vmcnt(17)
  buffer_load_dwordx4 v4, s[48:51], s82 offen offset:2048 nt lds
  s_waitcnt vmcnt(17)
  buffer_load_dwordx4 v5, s[48:51], s82 offen offset:3072 nt lds
  s_add_u32 s82, s28, 8192
  s_add_u32 m0, s84, 40960
  s_waitcnt vmcnt(16)
  buffer_load_dwordx4 v2, s[48:51], s82 offen offset:0 nt lds
  s_waitcnt vmcnt(16)
  buffer_load_dwordx4 v3, s[48:51], s82 offen offset:1024 nt lds
  s_waitcnt vmcnt(15)
  buffer_load_dwordx4 v4, s[48:51], s82 offen offset:2048 nt lds
  s_waitcnt vmcnt(15)
  buffer_load_dwordx4 v5, s[48:51], s82 offen offset:3072 nt lds
  s_add_u32 s82, s28, 12288
  s_add_u32 m0, s84, 45056
  s_waitcnt vmcnt(14)
  buffer_load_dwordx4 v2, s[48:51], s82 offen offset:0 nt lds
  s_waitcnt vmcnt(14)
  buffer_load_dwordx4 v3, s[48:51], s82 offen offset:1024 nt lds
  s_waitcnt vmcnt(13)
  buffer_load_dwordx4 v4, s[48:51], s82 offen offset:2048 nt lds
  s_waitcnt vmcnt(13)
  buffer_load_dwordx4 v5, s[48:51], s82 offen offset:3072 nt lds
  s_barrier
  s_add_u32 s28, s29, 16384
  s_and_b32 s28, s28, 0x3ffff
  s_add_u32 s28, s28, s92
  s_add_u32 s82, s28, 0
  s_add_u32 m0, s84, 65536
  s_waitcnt vmcnt(12)
  buffer_load_dwordx4 v2, s[48:51], s82 offen offset:0 nt lds
  s_waitcnt vmcnt(12)
  buffer_load_dwordx4 v3, s[48:51], s82 offen offset:1024 nt lds
  s_waitcnt vmcnt(11)
  buffer_load_dwordx4 v4, s[48:51], s82 offen offset:2048 nt lds
  s_waitcnt vmcnt(11)
  buffer_load_dwordx4 v5, s[48:51], s82 offen offset:3072 nt lds
  s_add_u32 s82, s28, 4096
  s_add_u32 m0, s84, 69632
  s_waitcnt vmcnt(11)
  buffer_load_dwordx4 v2, s[48:51], s82 offen offset:0 nt lds
  s_waitcnt vmcnt(11)
  buffer_load_dwordx4 v3, s[48:51], s82 offen offset:1024 nt lds
  s_waitcnt vmcnt(11)
  buffer_load_dwordx4 v4, s[48:51], s82 offen offset:2048 nt lds
  s_waitcnt vmcnt(11)
  buffer_load_dwordx4 v5, s[48:51], s82 offen offset:3072 nt lds
  s_add_u32 s82, s28, 8192
  s_add_u32 m0, s84, 73728
  s_waitcnt vmcnt(11)
  buffer_load_dwordx4 v2, s[48:51], s82 offen offset:0 nt lds
  s_waitcnt vmcnt(11)
  buffer_load_dwordx4 v3, s[48:51], s82 offen offset:1024 nt lds
  s_waitcnt vmcnt(11)
  buffer_load_dwordx4 v4, s[48:51], s82 offen offset:2048 nt lds
  s_waitcnt vmcnt(11)
  buffer_load_dwordx4 v5, s[48:51], s82 offen offset:3072 nt lds
  s_add_u32 s82, s28, 12288
  s_add_u32 m0, s84, 77824
  s_waitcnt vmcnt(11)
  buffer_load_dwordx4 v2, s[48:51], s82 offen offset:0 nt lds
  s_waitcnt vmcnt(11)
  buffer_load_dwordx4 v3, s[48:51], s82 offen offset:1024 nt lds
  s_waitcnt vmcnt(11)
  buffer_load_dwordx4 v4, s[48:51], s82 offen offset:2048 nt lds
  s_waitcnt vmcnt(11)
  buffer_load_dwordx4 v5, s[48:51], s82 offen offset:3072 nt lds
  s_barrier
  s_add_u32 s28, s29, 32768
  s_and_b32 s28, s28, 0x3ffff
  s_add_u32 s28, s28, s92
  s_add_u32 s82, s28, 0
  s_add_u32 m0, s84, 0
  s_waitcnt vmcnt(11)
  buffer_load_dwordx4 v2, s[48:51], s82 offen offset:0 nt lds
  s_waitcnt vmcnt(11)
  buffer_load_dwordx4 v3, s[48:51], s82 offen offset:1024 nt lds
  s_waitcnt vmcnt(11)
  buffer_load_dwordx4 v4, s[48:51], s82 offen offset:2048 nt lds
  s_waitcnt vmcnt(11)
  buffer_load_dwordx4 v5, s[48:51], s82 offen offset:3072 nt lds
  s_add_u32 s82, s28, 4096
  s_add_u32 m0, s84, 4096
  s_waitcnt vmcnt(11)
  buffer_load_dwordx4 v2, s[48:51], s82 offen offset:0 nt lds
  s_waitcnt vmcnt(11)
  buffer_load_dwordx4 v3, s[48:51], s82 offen offset:1024 nt lds
  s_waitcnt vmcnt(11)
  buffer_load_dwordx4 v4, s[48:51], s82 offen offset:2048 nt lds
  s_waitcnt vmcnt(11)
  buffer_load_dwordx4 v5, s[48:51], s82 offen offset:3072 nt lds
  s_add_u32 s82, s28, 8192
  s_add_u32 m0, s84, 8192
  s_waitcnt vmcnt(11)
  buffer_load_dwordx4 v2, s[48:51], s82 offen offset:0 nt lds
  s_waitcnt vmcnt(11)
  buffer_load_dwordx4 v3, s[48:51], s82 offen offset:1024 nt lds
  s_waitcnt vmcnt(11)
  buffer_load_dwordx4 v4, s[48:51], s82 offen offset:2048 nt lds
  s_waitcnt vmcnt(11)
  buffer_load_dwordx4 v5, s[48:51], s82 offen offset:3072 nt lds
  s_add_u32 s82, s28, 12288
  s_add_u32 m0, s84, 12288
  s_waitcnt vmcnt(11)
  buffer_load_dwordx4 v2, s[48:51], s82 offen offset:0 nt lds
  s_waitcnt vmcnt(11)
  buffer_load_dwordx4 v3, s[48:51], s82 offen offset:1024 nt lds
  s_waitcnt vmcnt(11)
  buffer_load_dwordx4 v4, s[48:51], s82 offen offset:2048 nt lds
  s_waitcnt vmcnt(11)
  buffer_load_dwordx4 v5, s[48:51], s82 offen offset:3072 nt lds
  s_add_u32 s28, s29, 49152
  s_and_b32 s28, s28, 0x3ffff
  s_add_u32 s28, s28, s92
  s_add_u32 s82, s28, 0
  s_waitcnt vmcnt(11)
  buffer_load_dwordx4 v[100:103], v2, s[48:51], s82 offen offset:0 nt
  s_waitcnt vmcnt(11)
  buffer_load_dwordx4 v[108:111], v3, s[48:51], s82 offen offset:1024 nt
  s_waitcnt vmcnt(11)
  buffer_load_dwordx4 v[112:115], v4, s[48:51], s82 offen offset:2048 nt
  s_waitcnt vmcnt(11)
  buffer_load_dwordx4 v[120:123], v5, s[48:51], s82 offen offset:3072 nt
  s_add_u32 s82, s28, 4096
  s_waitcnt vmcnt(11)
  buffer_load_dwordx4 v[124:127], v2, s[48:51], s82 offen offset:0 nt
  s_waitcnt vmcnt(11)
  buffer_load_dwordx4 v[132:135], v3, s[48:51], s82 offen offset:1024 nt
  s_waitcnt vmcnt(11)
  buffer_load_dwordx4 v[136:139], v4, s[48:51], s82 offen offset:2048 nt
  s_waitcnt vmcnt(11)
  buffer_load_dwordx4 v[144:147], v5, s[48:51], s82 offen offset:3072 nt
  s_add_u32 s82, s28, 8192
  s_waitcnt vmcnt(11)
  buffer_load_dwordx4 v[148:151], v2, s[48:51], s82 offen offset:0 nt
  s_waitcnt vmcnt(11)
  buffer_load_dwordx4 v[156:159], v3, s[48:51], s82 offen offset:1024 nt
  s_waitcnt vmcnt(11)
  buffer_load_dwordx4 v[160:163], v4, s[48:51], s82 offen offset:2048 nt
  s_barrier
  s_add_u32 m0, s84, 40960
  s_waitcnt vmcnt(11)
  buffer_load_dwordx4 v5, s[48:51], s82 offen offset:3072 nt lds
  s_add_u32 s82, s28, 12288
  s_add_u32 m0, s84, 45056
  s_waitcnt vmcnt(11)
  buffer_load_dwordx4 v2, s[48:51], s82 offen offset:0 nt lds
  ds_write_b128 v26, v[100:103] offset:32768
  s_waitcnt vmcnt(11)
  buffer_load_dwordx4 v3, s[48:51], s82 offen offset:1024 nt lds
  ds_write_b128 v26, v[108:111] offset:33792
  s_waitcnt vmcnt(11)
  buffer_load_dwordx4 v4, s[48:51], s82 offen offset:2048 nt lds
  ds_write_b128 v26, v[112:115] offset:34816
  s_waitcnt vmcnt(11)
  buffer_load_dwordx4 v5, s[48:51], s82 offen offset:3072 nt lds
  ds_write_b128 v26, v[120:123] offset:35840
  s_add_u32 s28, s29, 65536
  s_and_b32 s28, s28, 0x3ffff
  s_add_u32 s28, s28, s92
  s_add_u32 s82, s28, 0
  s_waitcnt vmcnt(11)
  buffer_load_dwordx4 v[164:167], v2, s[48:51], s82 offen offset:0 nt
  ds_write_b128 v26, v[124:127] offset:36864
  s_waitcnt vmcnt(11)
  buffer_load_dwordx4 v[168:171], v3, s[48:51], s82 offen offset:1024 nt
  ds_write_b128 v26, v[132:135] offset:37888
  s_waitcnt vmcnt(11)
  buffer_load_dwordx4 v[172:175], v4, s[48:51], s82 offen offset:2048 nt
  ds_write_b128 v26, v[136:139] offset:38912
  s_waitcnt vmcnt(11)
  buffer_load_dwordx4 v[176:179], v5, s[48:51], s82 offen offset:3072 nt
  ds_write_b128 v26, v[144:147] offset:39936
  s_add_u32 s82, s28, 4096
  s_waitcnt vmcnt(11)
  buffer_load_dwordx4 v[188:191], v2, s[48:51], s82 offen offset:0 nt
  ds_write_b128 v26, v[148:151] offset:40960
  s_waitcnt vmcnt(11)
  buffer_load_dwordx4 v[192:195], v3, s[48:51], s82 offen offset:1024 nt
  ds_write_b128 v26, v[156:159] offset:41984
  s_waitcnt vmcnt(11)
  buffer_load_dwordx4 v[200:203], v4, s[48:51], s82 offen offset:2048 nt
  ds_write_b128 v26, v[160:163] offset:43008
  s_waitcnt lgkmcnt(0)
  s_barrier
  s_add_u32 m0, s84, 69632
  s_waitcnt vmcnt(11)
  buffer_load_dwordx4 v5, s[48:51], s82 offen offset:3072 nt lds
  s_add_u32 s12, s8, 0
  s_and_b32 s12, s12, 3
  s_mul_i32 s78, s12, 147456
  s_add_u32 s78, s78, s15
  s_add_u32 m0, s20, 0
  s_nop 0
  buffer_load_dwordx4 v14, s[64:67], s78 offen offset:0  lds
  s_add_u32 s82, s28, 8192
  s_add_u32 m0, s84, 73728
  s_waitcnt vmcnt(12)
  buffer_load_dwordx4 v2, s[48:51], s82 offen offset:0 nt lds
  s_waitcnt vmcnt(12)
  buffer_load_dwordx4 v3, s[48:51], s82 offen offset:1024 nt lds
  s_add_u32 m0, s20, 0
  s_nop 0
  buffer_load_dwordx4 v15, s[64:67], s78 offen offset:1024  lds
  s_add_u32 m0, s84, 73728
  s_waitcnt vmcnt(13)
  buffer_load_dwordx4 v4, s[48:51], s82 offen offset:2048 nt lds
  s_waitcnt vmcnt(13)
  buffer_load_dwordx4 v5, s[48:51], s82 offen offset:3072 nt lds
  s_add_u32 m0, s20, 0
  s_nop 0
  buffer_load_dwordx4 v16, s[64:67], s78 offen offset:2048  lds
  s_add_u32 s82, s28, 12288
  s_add_u32 m0, s84, 77824
  s_waitcnt vmcnt(14)
  buffer_load_dwordx4 v2, s[48:51], s82 offen offset:0 nt lds
  ds_write_b128 v27, v[164:167] offset:0
  s_waitcnt vmcnt(14)
  buffer_load_dwordx4 v3, s[48:51], s82 offen offset:1024 nt lds
  ds_write_b128 v27, v[168:171] offset:1024
  s_add_u32 m0, s20, 0
  s_nop 0
  buffer_load_dwordx4 v17, s[64:67], s78 offen offset:3072  lds
  s_add_u32 m0, s84, 77824
  s_waitcnt vmcnt(15)
  buffer_load_dwordx4 v4, s[48:51], s82 offen offset:2048 nt lds
  ds_write_b128 v27, v[172:175] offset:2048
  s_waitcnt vmcnt(15)
  buffer_load_dwordx4 v5, s[48:51], s82 offen offset:3072 nt lds
  ds_write_b128 v27, v[176:179] offset:3072
  s_add_u32 m0, s20, 4096
  s_nop 0
  buffer_load_dwordx4 v18, s[64:67], s78 offen offset:0  lds
  s_add_u32 s28, s29, 81920
  s_and_b32 s28, s28, 0x3ffff
  s_add_u32 s28, s28, s92
  s_add_u32 s82, s28, 0
  s_waitcnt vmcnt(16)
  buffer_load_dwordx4 v[204:207], v2, s[48:51], s82 offen offset:0 nt
  ds_write_b128 v27, v[188:191] offset:4096
  s_waitcnt vmcnt(16)
  buffer_load_dwordx4 v[212:215], v3, s[48:51], s82 offen offset:1024 nt
  ds_write_b128 v27, v[192:195] offset:5120
  s_add_u32 m0, s20, 4096
  s_nop 0
  buffer_load_dwordx4 v19, s[64:67], s78 offen offset:1024  lds
  s_waitcnt vmcnt(17)
  buffer_load_dwordx4 v[216:219], v4, s[48:51], s82 offen offset:2048 nt
  ds_write_b128 v27, v[200:203] offset:6144
  s_waitcnt lgkmcnt(0)
  s_barrier
  s_add_u32 m0, s84, 0
  s_waitcnt vmcnt(17)
  buffer_load_dwordx4 v5, s[48:51], s82 offen offset:3072 nt lds
  s_add_u32 m0, s20, 4096
  s_nop 0
  buffer_load_dwordx4 v20, s[64:67], s78 offen offset:2048  lds
  s_add_u32 s82, s28, 4096
  s_add_u32 m0, s84, 4096
  s_waitcnt vmcnt(17)
  buffer_load_dwordx4 v2, s[48:51], s82 offen offset:0 nt lds
  s_waitcnt vmcnt(17)
  buffer_load_dwordx4 v3, s[48:51], s82 offen offset:1024 nt lds
  s_add_u32 m0, s20, 4096
  s_nop 0
  buffer_load_dwordx4 v21, s[64:67], s78 offen offset:3072  lds
  s_add_u32 m0, s84, 4096
  s_waitcnt vmcnt(17)
  buffer_load_dwordx4 v4, s[48:51], s82 offen offset:2048 nt lds
  s_waitcnt vmcnt(17)
  buffer_load_dwordx4 v5, s[48:51], s82 offen offset:3072 nt lds
  s_add_u32 m0, s20, 8192
  s_nop 0
  buffer_load_dwordx4 v22, s[64:67], s78 offen offset:0  lds
  s_add_u32 s82, s28, 8192
  s_add_u32 m0, s84, 8192
  s_waitcnt vmcnt(17)
  buffer_load_dwordx4 v2, s[48:51], s82 offen offset:0 nt lds
  s_waitcnt vmcnt(17)
  buffer_load_dwordx4 v3, s[48:51], s82 offen offset:1024 nt lds
  s_waitcnt vmcnt(16)
  buffer_load_dwordx4 v4, s[48:51], s82 offen offset:2048 nt lds
  s_waitcnt vmcnt(16)
  buffer_load_dwordx4 v5, s[48:51], s82 offen offset:3072 nt lds
  s_add_u32 s82, s28, 12288
  s_add_u32 m0, s84, 12288
  s_waitcnt vmcnt(15)
  buffer_load_dwordx4 v2, s[48:51], s82 offen offset:0 nt lds
  ds_write_b128 v26, v[204:207] offset:0
  s_waitcnt vmcnt(15)
  buffer_load_dwordx4 v3, s[48:51], s82 offen offset:1024 nt lds
  ds_write_b128 v26, v[212:215] offset:1024
  s_waitcnt vmcnt(14)
  buffer_load_dwordx4 v4, s[48:51], s82 offen offset:2048 nt lds
  ds_write_b128 v26, v[216:219] offset:2048
  s_waitcnt vmcnt(14)
  buffer_load_dwordx4 v5, s[48:51], s82 offen offset:3072 nt lds
  s_waitcnt lgkmcnt(0)
  s_barrier
  s_add_u32 s28, s29, 98304
  s_and_b32 s28, s28, 0x3ffff
  s_add_u32 s28, s28, s92
  s_add_u32 s82, s28, 0
  s_add_u32 m0, s84, 32768
  s_waitcnt vmcnt(13)
  buffer_load_dwordx4 v2, s[48:51], s82 offen offset:0 nt lds
  s_waitcnt vmcnt(13)
  buffer_load_dwordx4 v3, s[48:51], s82 offen offset:1024 nt lds
  s_add_u32 s12, s100, 0
  s_and_b32 s12, s12, 3
  s_mul_i32 s78, s12, 147456
  s_add_u32 s78, s78, s3
  buffer_load_dwordx4 v[224:227], v14, s[64:67], s78 offen offset:0
  s_waitcnt vmcnt(13)
  buffer_load_dwordx4 v4, s[48:51], s82 offen offset:2048 nt lds
  s_waitcnt vmcnt(13)
  buffer_load_dwordx4 v5, s[48:51], s82 offen offset:3072 nt lds
  buffer_load_dwordx4 v[228:231], v15, s[64:67], s78 offen offset:1024
  s_add_u32 s82, s28, 4096
  s_add_u32 m0, s84, 36864
  s_waitcnt vmcnt(13)
  buffer_load_dwordx4 v2, s[48:51], s82 offen offset:0 nt lds
  s_waitcnt vmcnt(13)
  buffer_load_dwordx4 v3, s[48:51], s82 offen offset:1024 nt lds
  buffer_load_dwordx4 v[248:251], v16, s[64:67], s78 offen offset:2048
  s_waitcnt vmcnt(14)
  buffer_load_dwordx4 v4, s[48:51], s82 offen offset:2048 nt lds
  s_waitcnt vmcnt(14)
  buffer_load_dwordx4 v5, s[48:51], s82 offen offset:3072 nt lds
  buffer_load_dwordx4 v[252:255], v17, s[64:67], s78 offen offset:3072
  s_add_u32 s82, s28, 8192
  s_add_u32 m0, s84, 40960
  s_waitcnt vmcnt(15)
  buffer_load_dwordx4 v2, s[48:51], s82 offen offset:0 nt lds
  s_waitcnt vmcnt(15)
  buffer_load_dwordx4 v3, s[48:51], s82 offen offset:1024 nt lds
  buffer_load_dwordx4 v[40:43], v18, s[64:67], s78 offen offset:0
  s_waitcnt vmcnt(16)
  buffer_load_dwordx4 v4, s[48:51], s82 offen offset:2048 nt lds
  s_waitcnt vmcnt(16)
  buffer_load_dwordx4 v5, s[48:51], s82 offen offset:3072 nt lds
  buffer_load_dwordx4 v[44:47], v19, s[64:67], s78 offen offset:1024
  s_add_u32 s82, s28, 12288
  s_add_u32 m0, s84, 45056
  s_waitcnt vmcnt(17)
  buffer_load_dwordx4 v2, s[48:51], s82 offen offset:0 nt lds
  s_waitcnt vmcnt(17)
  buffer_load_dwordx4 v3, s[48:51], s82 offen offset:1024 nt lds
  buffer_load_dwordx4 v[100:103], v20, s[64:67], s78 offen offset:2048
  s_waitcnt vmcnt(17)
  buffer_load_dwordx4 v4, s[48:51], s82 offen offset:2048 nt lds
  s_waitcnt vmcnt(17)
  buffer_load_dwordx4 v5, s[48:51], s82 offen offset:3072 nt lds
  buffer_load_dwordx4 v[108:111], v21, s[64:67], s78 offen offset:3072
  s_barrier
  s_add_u32 s28, s29, 114688
  s_and_b32 s28, s28, 0x3ffff
  s_add_u32 s28, s28, s92
  s_add_u32 s82, s28, 0
  s_add_u32 m0, s84, 65536
  s_waitcnt vmcnt(17)
  buffer_load_dwordx4 v2, s[48:51], s82 offen offset:0 nt lds
  s_waitcnt vmcnt(17)
  buffer_load_dwordx4 v3, s[48:51], s82 offen offset:1024 nt lds
  buffer_load_dwordx4 v[112:115], v22, s[64:67], s78 offen offset:0
  s_waitcnt vmcnt(17)
  buffer_load_dwordx4 v4, s[48:51], s82 offen offset:2048 nt lds
  s_waitcnt vmcnt(17)
  buffer_load_dwordx4 v5, s[48:51], s82 offen offset:3072 nt lds
  s_add_u32 s12, s8, 0
  s_and_b32 s12, s12, 3
  s_mul_i32 s78, s12, 147456
  s_add_u32 s78, s78, s15
  s_add_u32 s78, s78, 73728
  s_add_u32 m0, s21, 0
  s_nop 0
  buffer_load_dwordx4 v14, s[64:67], s78 offen offset:0  lds
  s_add_u32 s82, s28, 4096
  s_add_u32 m0, s84, 69632
  s_waitcnt vmcnt(17)
  buffer_load_dwordx4 v2, s[48:51], s82 offen offset:0 nt lds
  s_waitcnt vmcnt(17)
  buffer_load_dwordx4 v3, s[48:51], s82 offen offset:1024 nt lds
  s_add_u32 m0, s21, 0
  s_nop 0
  buffer_load_dwordx4 v15, s[64:67], s78 offen offset:1024  lds
  s_add_u32 m0, s84, 69632
  s_waitcnt vmcnt(17)
  buffer_load_dwordx4 v4, s[48:51], s82 offen offset:2048 nt lds
  s_waitcnt vmcnt(17)
  buffer_load_dwordx4 v5, s[48:51], s82 offen offset:3072 nt lds
  s_add_u32 m0, s21, 0
  s_nop 0
  buffer_load_dwordx4 v16, s[64:67], s78 offen offset:2048  lds
  s_add_u32 s82, s28, 8192
  s_add_u32 m0, s84, 73728
  s_waitcnt vmcnt(17)
  buffer_load_dwordx4 v2, s[48:51], s82 offen offset:0 nt lds
  s_waitcnt vmcnt(17)
  buffer_load_dwordx4 v3, s[48:51], s82 offen offset:1024 nt lds
  s_add_u32 m0, s21, 0
  s_nop 0
  buffer_load_dwordx4 v17, s[64:67], s78 offen offset:3072  lds
  s_add_u32 m0, s84, 73728
  s_waitcnt vmcnt(17)
  buffer_load_dwordx4 v4, s[48:51], s82 offen offset:2048 nt lds
  s_waitcnt vmcnt(17)
  buffer_load_dwordx4 v5, s[48:51], s82 offen offset:3072 nt lds
  s_add_u32 m0, s21, 4096
  s_nop 0
  buffer_load_dwordx4 v18, s[64:67], s78 offen offset:0  lds
  s_add_u32 s82, s28, 12288
  s_add_u32 m0, s84, 77824
  s_waitcnt vmcnt(17)
  buffer_load_dwordx4 v2, s[48:51], s82 offen offset:0 nt lds
  s_waitcnt vmcnt(17)
  buffer_load_dwordx4 v3, s[48:51], s82 offen offset:1024 nt lds
  s_add_u32 m0, s21, 4096
  s_nop 0
  buffer_load_dwordx4 v19, s[64:67], s78 offen offset:1024  lds
  s_add_u32 m0, s84, 77824
  s_waitcnt vmcnt(17)
  buffer_load_dwordx4 v4, s[48:51], s82 offen offset:2048 nt lds
  s_waitcnt vmcnt(17)
  buffer_load_dwordx4 v5, s[48:51], s82 offen offset:3072 nt lds
  s_add_u32 m0, s21, 4096
  s_nop 0
  buffer_load_dwordx4 v20, s[64:67], s78 offen offset:2048  lds
  s_barrier
  s_add_u32 s28, s29, 131072
  s_and_b32 s28, s28, 0x3ffff
  s_add_u32 s28, s28, s92
  s_add_u32 s82, s28, 0
  s_add_u32 m0, s84, 0
  s_waitcnt vmcnt(17)
  buffer_load_dwordx4 v2, s[48:51], s82 offen offset:0 nt lds
  s_waitcnt vmcnt(17)
  buffer_load_dwordx4 v3, s[48:51], s82 offen offset:1024 nt lds
  s_add_u32 m0, s21, 4096
  s_nop 0
  buffer_load_dwordx4 v21, s[64:67], s78 offen offset:3072  lds
  s_add_u32 m0, s84, 0
  s_waitcnt vmcnt(17)
  buffer_load_dwordx4 v4, s[48:51], s82 offen offset:2048 nt lds
  s_waitcnt vmcnt(17)
  buffer_load_dwordx4 v5, s[48:51], s82 offen offset:3072 nt lds
  s_add_u32 m0, s21, 8192
  s_nop 0
  buffer_load_dwordx4 v22, s[64:67], s78 offen offset:0  lds
  s_add_u32 s82, s28, 4096
  s_add_u32 m0, s84, 4096
  s_waitcnt vmcnt(17)
  buffer_load_dwordx4 v2, s[48:51], s82 offen offset:0 nt lds
  s_waitcnt vmcnt(17)
  buffer_load_dwordx4 v3, s[48:51], s82 offen offset:1024 nt lds
  s_waitcnt vmcnt(16)
  buffer_load_dwordx4 v4, s[48:51], s82 offen offset:2048 nt lds
  s_waitcnt vmcnt(16)
  buffer_load_dwordx4 v5, s[48:51], s82 offen offset:3072 nt lds
  s_add_u32 s82, s28, 8192
  s_add_u32 m0, s84, 8192
  s_waitcnt vmcnt(15)
  buffer_load_dwordx4 v2, s[48:51], s82 offen offset:0 nt lds
  s_waitcnt vmcnt(15)
  buffer_load_dwordx4 v3, s[48:51], s82 offen offset:1024 nt lds
  s_waitcnt vmcnt(14)
  buffer_load_dwordx4 v4, s[48:51], s82 offen offset:2048 nt lds
  s_waitcnt vmcnt(14)
  buffer_load_dwordx4 v5, s[48:51], s82 offen offset:3072 nt lds
  s_add_u32 s82, s28, 12288
  s_add_u32 m0, s84, 12288
  s_waitcnt vmcnt(13)
  buffer_load_dwordx4 v2, s[48:51], s82 offen offset:0 nt lds
  s_waitcnt vmcnt(13)
  buffer_load_dwordx4 v3, s[48:51], s82 offen offset:1024 nt lds
  s_waitcnt vmcnt(12)
  buffer_load_dwordx4 v4, s[48:51], s82 offen offset:2048 nt lds
  s_waitcnt vmcnt(12)
  buffer_load_dwordx4 v5, s[48:51], s82 offen offset:3072 nt lds
  s_barrier
  s_add_u32 s28, s29, 147456
  s_and_b32 s28, s28, 0x3ffff
  s_add_u32 s28, s28, s92
  s_add_u32 s82, s28, 0
  s_add_u32 m0, s84, 32768
  s_waitcnt vmcnt(11)
  buffer_load_dwordx4 v2, s[48:51], s82 offen offset:0 nt lds
  s_waitcnt vmcnt(11)
  buffer_load_dwordx4 v3, s[48:51], s82 offen offset:1024 nt lds
  s_add_u32 s12, s100, 0
  s_and_b32 s12, s12, 3
  s_mul_i32 s78, s12, 147456
  s_add_u32 s78, s78, s3
  s_add_u32 s78, s78, 73728
  buffer_load_dwordx4 v[120:123], v14, s[64:67], s78 offen offset:0
  s_waitcnt vmcnt(12)
  buffer_load_dwordx4 v4, s[48:51], s82 offen offset:2048 nt lds
  s_waitcnt vmcnt(12)
  buffer_load_dwordx4 v5, s[48:51], s82 offen offset:3072 nt lds
  buffer_load_dwordx4 v[124:127], v15, s[64:67], s78 offen offset:1024
  s_add_u32 s82, s28, 4096
  s_add_u32 m0, s84, 36864
  s_waitcnt vmcnt(13)
  buffer_load_dwordx4 v2, s[48:51], s82 offen offset:0 nt lds
  s_waitcnt vmcnt(13)
  buffer_load_dwordx4 v3, s[48:51], s82 offen offset:1024 nt lds
  buffer_load_dwordx4 v[132:135], v16, s[64:67], s78 offen offset:2048
  s_waitcnt vmcnt(14)
  buffer_load_dwordx4 v4, s[48:51], s82 offen offset:2048 nt lds
  s_waitcnt vmcnt(14)
  buffer_load_dwordx4 v5, s[48:51], s82 offen offset:3072 nt lds
  buffer_load_dwordx4 v[136:139], v17, s[64:67], s78 offen offset:3072
  s_add_u32 s82, s28, 8192
  s_add_u32 m0, s84, 40960
  s_waitcnt vmcnt(15)
  buffer_load_dwordx4 v2, s[48:51], s82 offen offset:0 nt lds
  s_waitcnt vmcnt(15)
  buffer_load_dwordx4 v3, s[48:51], s82 offen offset:1024 nt lds
  buffer_load_dwordx4 v[144:147], v18, s[64:67], s78 offen offset:0
  s_waitcnt vmcnt(16)
  buffer_load_dwordx4 v4, s[48:51], s82 offen offset:2048 nt lds
  s_waitcnt vmcnt(16)
  buffer_load_dwordx4 v5, s[48:51], s82 offen offset:3072 nt lds
  buffer_load_dwordx4 v[148:151], v19, s[64:67], s78 offen offset:1024
  s_add_u32 s82, s28, 12288
  s_add_u32 m0, s84, 45056
  s_waitcnt vmcnt(17)
  buffer_load_dwordx4 v2, s[48:51], s82 offen offset:0 nt lds
  s_waitcnt vmcnt(17)
  buffer_load_dwordx4 v3, s[48:51], s82 offen offset:1024 nt lds
  buffer_load_dwordx4 v[156:159], v20, s[64:67], s78 offen offset:2048
  s_waitcnt vmcnt(17)
  buffer_load_dwordx4 v4, s[48:51], s82 offen offset:2048 nt lds
  s_waitcnt vmcnt(17)
  buffer_load_dwordx4 v5, s[48:51], s82 offen offset:3072 nt lds
  buffer_load_dwordx4 v[160:163], v21, s[64:67], s78 offen offset:3072
  s_barrier
  s_add_u32 s28, s29, 163840
  s_and_b32 s28, s28, 0x3ffff
  s_add_u32 s28, s28, s92
  s_add_u32 s82, s28, 0
  s_add_u32 m0, s84, 65536
  s_waitcnt vmcnt(17)
  buffer_load_dwordx4 v2, s[48:51], s82 offen offset:0 nt lds
  s_waitcnt vmcnt(17)
  buffer_load_dwordx4 v3, s[48:51], s82 offen offset:1024 nt lds
  buffer_load_dwordx4 v[164:167], v22, s[64:67], s78 offen offset:0
  s_waitcnt vmcnt(17)
  buffer_load_dwordx4 v4, s[48:51], s82 offen offset:2048 nt lds
  s_waitcnt vmcnt(17)
  buffer_load_dwordx4 v5, s[48:51], s82 offen offset:3072 nt lds
  s_add_u32 s12, s8, 1
  s_and_b32 s12, s12, 3
  s_mul_i32 s78, s12, 147456
  s_add_u32 s78, s78, s15
  s_add_u32 m0, s22, 0
  s_nop 0
  buffer_load_dwordx4 v14, s[64:67], s78 offen offset:0  lds
  s_add_u32 s82, s28, 4096
  s_add_u32 m0, s84, 69632
  s_waitcnt vmcnt(17)
  buffer_load_dwordx4 v2, s[48:51], s82 offen offset:0 nt lds
  s_waitcnt vmcnt(17)
  buffer_load_dwordx4 v3, s[48:51], s82 offen offset:1024 nt lds
  s_add_u32 m0, s22, 0
  s_nop 0
  buffer_load_dwordx4 v15, s[64:67], s78 offen offset:1024  lds
  s_add_u32 m0, s84, 69632
  s_waitcnt vmcnt(17)
  buffer_load_dwordx4 v4, s[48:51], s82 offen offset:2048 nt lds
  s_waitcnt vmcnt(17)
  buffer_load_dwordx4 v5, s[48:51], s82 offen offset:3072 nt lds
  s_add_u32 m0, s22, 0
  s_nop 0
  buffer_load_dwordx4 v16, s[64:67], s78 offen offset:2048  lds
  s_add_u32 s82, s28, 8192
  s_add_u32 m0, s84, 73728
  s_waitcnt vmcnt(17)
  buffer_load_dwordx4 v2, s[48:51], s82 offen offset:0 nt lds
  s_waitcnt vmcnt(17)
  buffer_load_dwordx4 v3, s[48:51], s82 offen offset:1024 nt lds
  s_add_u32 m0, s22, 0
  s_nop 0
  buffer_load_dwordx4 v17, s[64:67], s78 offen offset:3072  lds
  s_add_u32 m0, s84, 73728
  s_waitcnt vmcnt(17)
  buffer_load_dwordx4 v4, s[48:51], s82 offen offset:2048 nt lds
  s_waitcnt vmcnt(17)
  buffer_load_dwordx4 v5, s[48:51], s82 offen offset:3072 nt lds
  s_add_u32 m0, s22, 4096
  s_nop 0
  buffer_load_dwordx4 v18, s[64:67], s78 offen offset:0  lds
  s_add_u32 s82, s28, 12288
  s_add_u32 m0, s84, 77824
  s_waitcnt vmcnt(17)
  buffer_load_dwordx4 v2, s[48:51], s82 offen offset:0 nt lds
  s_waitcnt vmcnt(17)
  buffer_load_dwordx4 v3, s[48:51], s82 offen offset:1024 nt lds
  s_add_u32 m0, s22, 4096
  s_nop 0
  buffer_load_dwordx4 v19, s[64:67], s78 offen offset:1024  lds
  s_add_u32 m0, s84, 77824
  s_waitcnt vmcnt(17)
  buffer_load_dwordx4 v4, s[48:51], s82 offen offset:2048 nt lds
  s_waitcnt vmcnt(17)
  buffer_load_dwordx4 v5, s[48:51], s82 offen offset:3072 nt lds
  s_add_u32 m0, s22, 4096
  s_nop 0
  buffer_load_dwordx4 v20, s[64:67], s78 offen offset:2048  lds
  s_barrier
  s_add_u32 s28, s29, 180224
  s_and_b32 s28, s28, 0x3ffff
  s_add_u32 s28, s28, s92
  s_add_u32 s82, s28, 0
  s_add_u32 m0, s84, 0
  s_waitcnt vmcnt(17)
  buffer_load_dwordx4 v2, s[48:51], s82 offen offset:0 nt lds
  s_waitcnt vmcnt(17)
  buffer_load_dwordx4 v3, s[48:51], s82 offen offset:1024 nt lds
  s_add_u32 m0, s22, 4096
  s_nop 0
  buffer_load_dwordx4 v21, s[64:67], s78 offen offset:3072  lds
  s_add_u32 m0, s84, 0
  s_waitcnt vmcnt(17)
  buffer_load_dwordx4 v4, s[48:51], s82 offen offset:2048 nt lds
  s_waitcnt vmcnt(17)
  buffer_load_dwordx4 v5, s[48:51], s82 offen offset:3072 nt lds
  s_add_u32 m0, s22, 8192
  s_nop 0
  buffer_load_dwordx4 v22, s[64:67], s78 offen offset:0  lds
  s_add_u32 s82, s28, 4096
  s_add_u32 m0, s84, 4096
  s_waitcnt vmcnt(17)
  buffer_load_dwordx4 v2, s[48:51], s82 offen offset:0 nt lds
  s_waitcnt vmcnt(17)
  buffer_load_dwordx4 v3, s[48:51], s82 offen offset:1024 nt lds
  s_waitcnt vmcnt(16)
  buffer_load_dwordx4 v4, s[48:51], s82 offen offset:2048 nt lds
  s_waitcnt vmcnt(16)
  buffer_load_dwordx4 v5, s[48:51], s82 offen offset:3072 nt lds
  s_add_u32 s82, s28, 8192
  s_add_u32 m0, s84, 8192
  s_waitcnt vmcnt(15)
  buffer_load_dwordx4 v2, s[48:51], s82 offen offset:0 nt lds
  s_waitcnt vmcnt(15)
  buffer_load_dwordx4 v3, s[48:51], s82 offen offset:1024 nt lds
  s_waitcnt vmcnt(14)
  buffer_load_dwordx4 v4, s[48:51], s82 offen offset:2048 nt lds
  s_waitcnt vmcnt(14)
  buffer_load_dwordx4 v5, s[48:51], s82 offen offset:3072 nt lds
  s_add_u32 s82, s28, 12288
  s_add_u32 m0, s84, 12288
  s_waitcnt vmcnt(13)
  buffer_load_dwordx4 v2, s[48:51], s82 offen offset:0 nt lds
  s_waitcnt vmcnt(13)
  buffer_load_dwordx4 v3, s[48:51], s82 offen offset:1024 nt lds
  s_waitcnt vmcnt(12)
  buffer_load_dwordx4 v4, s[48:51], s82 offen offset:2048 nt lds
  s_waitcnt vmcnt(12)
  buffer_load_dwordx4 v5, s[48:51], s82 offen offset:3072 nt lds
  s_barrier
  s_lshl_b32 s9, s6, 2
  s_add_u32 s9, s9, s99
  s_mul_i32 s9, s9, 147456
  s_lshr_b32 s10, s13, 3
  s_lshl_b32 s10, s10, 1
  s_add_u32 s10, s10, s83
  s_mul_i32 s10, s10, 9216
  s_add_u32 s9, s9, s10
  buffer_load_dwordx4 v[36:39], v24, s[64:67], s9 offen offset:0
  buffer_load_dwordx4 v[36:39], v24, s[64:67], s9 offen offset:1024
  buffer_load_dwordx4 v[36:39], v24, s[64:67], s9 offen offset:2048
  buffer_load_dwordx4 v[36:39], v24, s[64:67], s9 offen offset:3072
  s_add_u32 s9, s9, 4096
  buffer_load_dwordx4 v[36:39], v24, s[64:67], s9 offen offset:0
  buffer_load_dwordx4 v[36:39], v24, s[64:67], s9 offen offset:1024
  buffer_load_dwordx4 v[36:39], v24, s[64:67], s9 offen offset:2048
  buffer_load_dwordx4 v[36:39], v24, s[64:67], s9 offen offset:3072
  s_add_u32 s9, s9, 4096
  buffer_load_dwordx4 v[36:39], v24, s[64:67], s9 offen offset:0
  s_add_u32 s28, s29, 196608
  s_and_b32 s28, s28, 0x3ffff
  s_add_u32 s28, s28, s92
  s_add_u32 s82, s28, 0
  s_add_u32 m0, s84, 32768
  s_waitcnt vmcnt(20)
  buffer_load_dwordx4 v2, s[48:51], s82 offen offset:0 nt lds
  s_waitcnt vmcnt(20)
  buffer_load_dwordx4 v3, s[48:51], s82 offen offset:1024 nt lds
  s_add_u32 s12, s100, 2
  s_and_b32 s12, s12, 3
  s_mul_i32 s78, s12, 147456
  s_add_u32 s78, s78, s3
  s_add_u32 s78, s78, 73728
  buffer_load_dwordx4 v[168:171], v14, s[64:67], s78 offen offset:0
  s_waitcnt vmcnt(21)
  buffer_load_dwordx4 v4, s[48:51], s82 offen offset:2048 nt lds
  s_waitcnt vmcnt(21)
  buffer_load_dwordx4 v5, s[48:51], s82 offen offset:3072 nt lds
  buffer_load_dwordx4 v[172:175], v15, s[64:67], s78 offen offset:1024
  s_add_u32 s82, s28, 4096
  s_add_u32 m0, s84, 36864
  s_waitcnt vmcnt(22)
  buffer_load_dwordx4 v2, s[48:51], s82 offen offset:0 nt lds
  s_waitcnt vmcnt(22)
  buffer_load_dwordx4 v3, s[48:51], s82 offen offset:1024 nt lds
  buffer_load_dwordx4 v[176:179], v16, s[64:67], s78 offen offset:2048
  s_waitcnt vmcnt(23)
  buffer_load_dwordx4 v4, s[48:51], s82 offen offset:2048 nt lds
  s_waitcnt vmcnt(23)
  buffer_load_dwordx4 v5, s[48:51], s82 offen offset:3072 nt lds
  buffer_load_dwordx4 v[188:191], v17, s[64:67], s78 offen offset:3072
  s_add_u32 s82, s28, 8192
  s_add_u32 m0, s84, 40960
  s_waitcnt vmcnt(24)
  buffer_load_dwordx4 v2, s[48:51], s82 offen offset:0 nt lds
  s_waitcnt vmcnt(24)
  buffer_load_dwordx4 v3, s[48:51], s82 offen offset:1024 nt lds
  buffer_load_dwordx4 v[192:195], v18, s[64:67], s78 offen offset:0
  s_waitcnt vmcnt(25)
  buffer_load_dwordx4 v4, s[48:51], s82 offen offset:2048 nt lds
  s_waitcnt vmcnt(25)
  buffer_load_dwordx4 v5, s[48:51], s82 offen offset:3072 nt lds
  buffer_load_dwordx4 v[200:203], v19, s[64:67], s78 offen offset:1024
  s_add_u32 s82, s28, 12288
  s_add_u32 m0, s84, 45056
  s_waitcnt vmcnt(17)
  buffer_load_dwordx4 v2, s[48:51], s82 offen offset:0 nt lds
  s_waitcnt vmcnt(17)
  buffer_load_dwordx4 v3, s[48:51], s82 offen offset:1024 nt lds
  buffer_load_dwordx4 v[204:207], v20, s[64:67], s78 offen offset:2048
  s_waitcnt vmcnt(17)
  buffer_load_dwordx4 v4, s[48:51], s82 offen offset:2048 nt lds
  s_waitcnt vmcnt(17)
  buffer_load_dwordx4 v5, s[48:51], s82 offen offset:3072 nt lds
  buffer_load_dwordx4 v[212:215], v21, s[64:67], s78 offen offset:3072
  s_barrier
  s_add_u32 s28, s29, 212992
  s_and_b32 s28, s28, 0x3ffff
  s_add_u32 s28, s28, s92
  s_add_u32 s82, s28, 0
  s_add_u32 m0, s84, 65536
  s_waitcnt vmcnt(17)
  buffer_load_dwordx4 v2, s[48:51], s82 offen offset:0 nt lds
  s_waitcnt vmcnt(17)
  buffer_load_dwordx4 v3, s[48:51], s82 offen offset:1024 nt lds
  buffer_load_dwordx4 v[216:219], v22, s[64:67], s78 offen offset:0
  s_waitcnt vmcnt(17)
  buffer_load_dwordx4 v4, s[48:51], s82 offen offset:2048 nt lds
  s_waitcnt vmcnt(17)
  buffer_load_dwordx4 v5, s[48:51], s82 offen offset:3072 nt lds
  s_add_u32 s82, s28, 4096
  s_add_u32 m0, s84, 69632
  s_waitcnt vmcnt(16)
  buffer_load_dwordx4 v2, s[48:51], s82 offen offset:0 nt lds
  s_waitcnt vmcnt(16)
  buffer_load_dwordx4 v3, s[48:51], s82 offen offset:1024 nt lds
  s_waitcnt vmcnt(15)
  buffer_load_dwordx4 v4, s[48:51], s82 offen offset:2048 nt lds
  s_waitcnt vmcnt(15)
  buffer_load_dwordx4 v5, s[48:51], s82 offen offset:3072 nt lds
  s_add_u32 s82, s28, 8192
  s_add_u32 m0, s84, 73728
  s_waitcnt vmcnt(14)
  buffer_load_dwordx4 v2, s[48:51], s82 offen offset:0 nt lds
  s_waitcnt vmcnt(14)
  buffer_load_dwordx4 v3, s[48:51], s82 offen offset:1024 nt lds
  s_waitcnt vmcnt(13)
  buffer_load_dwordx4 v4, s[48:51], s82 offen offset:2048 nt lds
  s_waitcnt vmcnt(13)
  buffer_load_dwordx4 v5, s[48:51], s82 offen offset:3072 nt lds
  s_add_u32 s82, s28, 12288
  s_add_u32 m0, s84, 77824
  s_waitcnt vmcnt(12)
  buffer_load_dwordx4 v2, s[48:51], s82 offen offset:0 nt lds
  s_waitcnt vmcnt(12)
  buffer_load_dwordx4 v3, s[48:51], s82 offen offset:1024 nt lds
  s_waitcnt vmcnt(11)
  buffer_load_dwordx4 v4, s[48:51], s82 offen offset:2048 nt lds
  s_waitcnt vmcnt(11)
  buffer_load_dwordx4 v5, s[48:51], s82 offen offset:3072 nt lds
  s_barrier
  s_add_u32 s28, s29, 229376
  s_and_b32 s28, s28, 0x3ffff
  s_add_u32 s28, s28, s92
  s_add_u32 s82, s28, 0
  s_add_u32 m0, s84, 0
  s_waitcnt vmcnt(11)
  buffer_load_dwordx4 v2, s[48:51], s82 offen offset:0 nt lds
  s_waitcnt vmcnt(11)
  buffer_load_dwordx4 v3, s[48:51], s82 offen offset:1024 nt lds
  s_waitcnt vmcnt(11)
  buffer_load_dwordx4 v4, s[48:51], s82 offen offset:2048 nt lds
  s_waitcnt vmcnt(11)
  buffer_load_dwordx4 v5, s[48:51], s82 offen offset:3072 nt lds
  s_add_u32 s82, s28, 4096
  s_add_u32 m0, s84, 4096
  s_waitcnt vmcnt(11)
  buffer_load_dwordx4 v2, s[48:51], s82 offen offset:0 nt lds
  s_waitcnt vmcnt(11)
  buffer_load_dwordx4 v3, s[48:51], s82 offen offset:1024 nt lds
  s_waitcnt vmcnt(11)
  buffer_load_dwordx4 v4, s[48:51], s82 offen offset:2048 nt lds
  s_waitcnt vmcnt(11)
  buffer_load_dwordx4 v5, s[48:51], s82 offen offset:3072 nt lds
  s_add_u32 s82, s28, 8192
  s_add_u32 m0, s84, 8192
  s_waitcnt vmcnt(11)
  buffer_load_dwordx4 v2, s[48:51], s82 offen offset:0 nt lds
  s_waitcnt vmcnt(11)
  buffer_load_dwordx4 v3, s[48:51], s82 offen offset:1024 nt lds
  s_waitcnt vmcnt(11)
  buffer_load_dwordx4 v4, s[48:51], s82 offen offset:2048 nt lds
  s_waitcnt vmcnt(11)
  buffer_load_dwordx4 v5, s[48:51], s82 offen offset:3072 nt lds
  s_add_u32 s82, s28, 12288
  s_add_u32 m0, s84, 12288
  s_waitcnt vmcnt(11)
  buffer_load_dwordx4 v2, s[48:51], s82 offen offset:0 nt lds
  s_waitcnt vmcnt(11)
  buffer_load_dwordx4 v3, s[48:51], s82 offen offset:1024 nt lds
  s_waitcnt vmcnt(11)
  buffer_load_dwordx4 v4, s[48:51], s82 offen offset:2048 nt lds
  s_waitcnt vmcnt(11)
  buffer_load_dwordx4 v5, s[48:51], s82 offen offset:3072 nt lds
  s_barrier
  buffer_load_dword v32, v23, s[60:63], 0 offen sc1
  s_add_u32 s28, s29, 245760
  s_and_b32 s28, s28, 0x3ffff
  s_add_u32 s28, s28, s92
  s_add_u32 s82, s28, 0
  s_add_u32 m0, s84, 32768
  s_waitcnt vmcnt(12)
  buffer_load_dwordx4 v2, s[48:51], s82 offen offset:0 nt lds
  s_waitcnt vmcnt(12)
  buffer_load_dwordx4 v3, s[48:51], s82 offen offset:1024 nt lds
  s_waitcnt vmcnt(12)
  buffer_load_dwordx4 v4, s[48:51], s82 offen offset:2048 nt lds
  s_waitcnt vmcnt(12)
  buffer_load_dwordx4 v5, s[48:51], s82 offen offset:3072 nt lds
  s_add_u32 s82, s28, 4096
  s_add_u32 m0, s84, 36864
  s_waitcnt vmcnt(12)
  buffer_load_dwordx4 v2, s[48:51], s82 offen offset:0 nt lds
  s_waitcnt vmcnt(12)
  buffer_load_dwordx4 v3, s[48:51], s82 offen offset:1024 nt lds
  s_waitcnt vmcnt(12)
  buffer_load_dwordx4 v4, s[48:51], s82 offen offset:2048 nt lds
  s_waitcnt vmcnt(12)
  buffer_load_dwordx4 v5, s[48:51], s82 offen offset:3072 nt lds
  s_add_u32 s82, s28, 8192
  s_add_u32 m0, s84, 40960
  s_waitcnt vmcnt(12)
  buffer_load_dwordx4 v2, s[48:51], s82 offen offset:0 nt lds
  s_waitcnt vmcnt(12)
  buffer_load_dwordx4 v3, s[48:51], s82 offen offset:1024 nt lds
  s_waitcnt vmcnt(12)
  buffer_load_dwordx4 v4, s[48:51], s82 offen offset:2048 nt lds
  s_waitcnt vmcnt(12)
  buffer_load_dwordx4 v5, s[48:51], s82 offen offset:3072 nt lds
  s_add_u32 s82, s28, 12288
  s_add_u32 m0, s84, 45056
  s_waitcnt vmcnt(11)
  buffer_load_dwordx4 v2, s[48:51], s82 offen offset:0 nt lds
  s_waitcnt vmcnt(11)
  buffer_load_dwordx4 v3, s[48:51], s82 offen offset:1024 nt lds
  s_waitcnt vmcnt(11)
  buffer_load_dwordx4 v4, s[48:51], s82 offen offset:2048 nt lds
  s_waitcnt vmcnt(11)
  buffer_load_dwordx4 v5, s[48:51], s82 offen offset:3072 nt lds
  s_barrier
  v_cmp_ne_u32 vcc, 1, v32
  s_cbranch_vccnz aux_slowf
aux_fok:
  s_add_u32 s12, s8, 1
  s_and_b32 s12, s12, 3
  s_mul_i32 s78, s12, 147456
  s_add_u32 s78, s78, s15
  s_add_u32 s78, s78, 73728
  s_add_u32 m0, s23, 0
  s_nop 0
  buffer_load_dwordx4 v14, s[64:67], s78 offen offset:0  lds
  buffer_load_dwordx4 v15, s[64:67], s78 offen offset:1024  lds
  buffer_load_dwordx4 v16, s[64:67], s78 offen offset:2048  lds
  buffer_load_dwordx4 v17, s[64:67], s78 offen offset:3072  lds
  s_add_u32 m0, s23, 4096
  s_nop 0
  buffer_load_dwordx4 v18, s[64:67], s78 offen offset:0  lds
  buffer_load_dwordx4 v19, s[64:67], s78 offen offset:1024  lds
  buffer_load_dwordx4 v20, s[64:67], s78 offen offset:2048  lds
  buffer_load_dwordx4 v21, s[64:67], s78 offen offset:3072  lds
  s_add_u32 m0, s23, 8192
  s_nop 0
  buffer_load_dwordx4 v22, s[64:67], s78 offen offset:0  lds
  s_add_u32 s12, s8, 2
  s_and_b32 s12, s12, 3
  s_mul_i32 s78, s12, 147456
  s_add_u32 s78, s78, s15
  s_add_u32 m0, s24, 0
  s_nop 0
  buffer_load_dwordx4 v14, s[64:67], s78 offen offset:0  lds
  buffer_load_dwordx4 v15, s[64:67], s78 offen offset:1024  lds
  buffer_load_dwordx4 v16, s[64:67], s78 offen offset:2048  lds
  buffer_load_dwordx4 v17, s[64:67], s78 offen offset:3072  lds
  s_add_u32 m0, s24, 4096
  s_nop 0
  buffer_load_dwordx4 v18, s[64:67], s78 offen offset:0  lds
  buffer_load_dwordx4 v19, s[64:67], s78 offen offset:1024  lds
  buffer_load_dwordx4 v20, s[64:67], s78 offen offset:2048  lds
  buffer_load_dwordx4 v21, s[64:67], s78 offen offset:3072  lds
  s_add_u32 m0, s24, 8192
  s_nop 0
  buffer_load_dwordx4 v22, s[64:67], s78 offen offset:0  lds
  s_waitcnt vmcnt(18)
  s_barrier
  s_mul_i32 s9, s8, 24576
  s_add_u32 s9, s9, s42
  s_mul_i32 s10, s83, 12288
  s_add_u32 s9, s9, s10
  buffer_load_dwordx4 v[36:39], v24, s[60:63], s9 offen offset:0 sc1
  buffer_load_dwordx4 v[36:39], v24, s[60:63], s9 offen offset:1024 sc1
  buffer_load_dwordx4 v[36:39], v24, s[60:63], s9 offen offset:2048 sc1
  buffer_load_dwordx4 v[36:39], v24, s[60:63], s9 offen offset:3072 sc1
  s_add_u32 s9, s9, 4096
  buffer_load_dwordx4 v[36:39], v24, s[60:63], s9 offen offset:0 sc1
  buffer_load_dwordx4 v[36:39], v24, s[60:63], s9 offen offset:1024 sc1
  buffer_load_dwordx4 v[36:39], v24, s[60:63], s9 offen offset:2048 sc1
  buffer_load_dwordx4 v[36:39], v24, s[60:63], s9 offen offset:3072 sc1
  s_add_u32 s9, s9, 4096
  buffer_load_dwordx4 v[36:39], v24, s[60:63], s9 offen offset:0 sc1
  buffer_load_dwordx4 v[36:39], v24, s[60:63], s9 offen offset:1024 sc1
  buffer_load_dwordx4 v[36:39], v24, s[60:63], s9 offen offset:2048 sc1
  buffer_load_dwordx4 v[36:39], v24, s[60:63], s9 offen offset:3072 sc1
  s_barrier
  s_waitcnt vmcnt(12)
  s_barrier
  v_add_u32 v25, s25, v24
  ds_write_b128 v25, v[56:59] offset:0
  ds_write_b128 v25, v[68:71] offset:1024
  ds_write_b128 v25, v[80:83] offset:2048
  ds_write_b128 v25, v[92:95] offset:3072
  ds_write_b128 v25, v[104:107] offset:4096
  ds_write_b128 v25, v[116:119] offset:5120
  ds_write_b128 v25, v[128:131] offset:6144
  ds_write_b128 v25, v[140:143] offset:7168
  ds_write_b128 v25, v[152:155] offset:8192
  v_add_u32 v25, s26, v24
  ds_write_b128 v25, v[180:183] offset:0
  ds_write_b128 v25, v[184:187] offset:1024
  ds_write_b128 v25, v[196:199] offset:2048
  ds_write_b128 v25, v[208:211] offset:3072
  ds_write_b128 v25, v[220:223] offset:4096
  ds_write_b128 v25, v[232:235] offset:5120
  ds_write_b128 v25, v[236:239] offset:6144
  ds_write_b128 v25, v[240:243] offset:7168
  ds_write_b128 v25, v[244:247] offset:8192
  v_add_u32 v25, s27, v24
  ds_write_b128 v25, v[48:51] offset:0
  ds_write_b128 v25, v[52:55] offset:1024
  ds_write_b128 v25, v[60:63] offset:2048
  ds_write_b128 v25, v[64:67] offset:3072
  ds_write_b128 v25, v[72:75] offset:4096
  ds_write_b128 v25, v[76:79] offset:5120
  ds_write_b128 v25, v[84:87] offset:6144
  ds_write_b128 v25, v[88:91] offset:7168
  ds_write_b128 v25, v[96:99] offset:8192
  s_waitcnt lgkmcnt(0)
  s_barrier
  s_add_u32 s12, s100, 2
  s_and_b32 s12, s12, 3
  s_mul_i32 s78, s12, 147456
  s_add_u32 s78, s78, s3
  s_add_u32 m0, s22, 0
  s_nop 0
  buffer_load_dwordx4 v14, s[64:67], s78 offen offset:0  lds
  buffer_load_dwordx4 v15, s[64:67], s78 offen offset:1024  lds
  buffer_load_dwordx4 v16, s[64:67], s78 offen offset:2048  lds
  buffer_load_dwordx4 v17, s[64:67], s78 offen offset:3072  lds
  s_add_u32 m0, s22, 4096
  s_nop 0
  buffer_load_dwordx4 v18, s[64:67], s78 offen offset:0  lds
  buffer_load_dwordx4 v19, s[64:67], s78 offen offset:1024  lds
  buffer_load_dwordx4 v20, s[64:67], s78 offen offset:2048  lds
  buffer_load_dwordx4 v21, s[64:67], s78 offen offset:3072  lds
  s_add_u32 m0, s22, 8192
  s_nop 0
  buffer_load_dwordx4 v22, s[64:67], s78 offen offset:0  lds
  s_add_u32 s12, s100, 3
  s_and_b32 s12, s12, 3
  s_mul_i32 s78, s12, 147456
  s_add_u32 s78, s78, s3
  s_add_u32 m0, s24, 0
  s_nop 0
  buffer_load_dwordx4 v14, s[64:67], s78 offen offset:0  lds
  buffer_load_dwordx4 v15, s[64:67], s78 offen offset:1024  lds
  buffer_load_dwordx4 v16, s[64:67], s78 offen offset:2048  lds
  buffer_load_dwordx4 v17, s[64:67], s78 offen offset:3072  lds
  s_add_u32 m0, s24, 4096
  s_nop 0
  buffer_load_dwordx4 v18, s[64:67], s78 offen offset:0  lds
  buffer_load_dwordx4 v19, s[64:67], s78 offen offset:1024  lds
  buffer_load_dwordx4 v20, s[64:67], s78 offen offset:2048  lds
  buffer_load_dwordx4 v21, s[64:67], s78 offen offset:3072  lds
  s_add_u32 m0, s24, 8192
  s_nop 0
  buffer_load_dwordx4 v22, s[64:67], s78 offen offset:0  lds
  v_add_u32 v25, s20, v24
  ds_write_b128 v25, v[224:227] offset:0
  ds_write_b128 v25, v[228:231] offset:1024
  ds_write_b128 v25, v[248:251] offset:2048
  ds_write_b128 v25, v[252:255] offset:3072
  ds_write_b128 v25, v[40:43] offset:4096
  ds_write_b128 v25, v[44:47] offset:5120
  ds_write_b128 v25, v[100:103] offset:6144
  ds_write_b128 v25, v[108:111] offset:7168
  ds_write_b128 v25, v[112:115] offset:8192
  v_add_u32 v25, s21, v24
  ds_write_b128 v25, v[120:123] offset:0
  ds_write_b128 v25, v[124:127] offset:1024
  ds_write_b128 v25, v[132:135] offset:2048
  ds_write_b128 v25, v[136:139] offset:3072
  ds_write_b128 v25, v[144:147] offset:4096
  ds_write_b128 v25, v[148:151] offset:5120
  ds_write_b128 v25, v[156:159] offset:6144
  ds_write_b128 v25, v[160:163] offset:7168
  ds_write_b128 v25, v[164:167] offset:8192
  s_waitcnt vmcnt(0)
  s_waitcnt lgkmcnt(0)
  s_barrier
  s_add_u32 s12, s100, 3
  s_and_b32 s12, s12, 3
  s_mul_i32 s78, s12, 147456
  s_add_u32 s78, s78, s3
  s_add_u32 s78, s78, 73728
  s_add_u32 m0, s25, 0
  s_nop 0
  buffer_load_dwordx4 v14, s[64:67], s78 offen offset:0  lds
  buffer_load_dwordx4 v15, s[64:67], s78 offen offset:1024  lds
  buffer_load_dwordx4 v16, s[64:67], s78 offen offset:2048  lds
  buffer_load_dwordx4 v17, s[64:67], s78 offen offset:3072  lds
  s_add_u32 m0, s25, 4096
  s_nop 0
  buffer_load_dwordx4 v18, s[64:67], s78 offen offset:0  lds
  buffer_load_dwordx4 v19, s[64:67], s78 offen offset:1024  lds
  buffer_load_dwordx4 v20, s[64:67], s78 offen offset:2048  lds
  buffer_load_dwordx4 v21, s[64:67], s78 offen offset:3072  lds
  s_add_u32 m0, s25, 8192
  s_nop 0
  buffer_load_dwordx4 v22, s[64:67], s78 offen offset:0  lds
  s_add_u32 s12, s100, 1
  s_and_b32 s12, s12, 3
  s_mul_i32 s78, s12, 147456
  s_add_u32 s78, s78, s3
  s_add_u32 m0, s26, 0
  s_nop 0
  buffer_load_dwordx4 v14, s[64:67], s78 offen offset:0  lds
  buffer_load_dwordx4 v15, s[64:67], s78 offen offset:1024  lds
  buffer_load_dwordx4 v16, s[64:67], s78 offen offset:2048  lds
  buffer_load_dwordx4 v17, s[64:67], s78 offen offset:3072  lds
  s_add_u32 m0, s26, 4096
  s_nop 0
  buffer_load_dwordx4 v18, s[64:67], s78 offen offset:0  lds
  buffer_load_dwordx4 v19, s[64:67], s78 offen offset:1024  lds
  buffer_load_dwordx4 v20, s[64:67], s78 offen offset:2048  lds
  buffer_load_dwordx4 v21, s[64:67], s78 offen offset:3072  lds
  s_add_u32 m0, s26, 8192
  s_nop 0
  buffer_load_dwordx4 v22, s[64:67], s78 offen offset:0  lds
  s_add_u32 s12, s100, 1
  s_and_b32 s12, s12, 3
  s_mul_i32 s78, s12, 147456
  s_add_u32 s78, s78, s3
  s_add_u32 s78, s78, 73728
  s_add_u32 m0, s27, 0
  s_nop 0
  buffer_load_dwordx4 v14, s[64:67], s78 offen offset:0  lds
  buffer_load_dwordx4 v15, s[64:67], s78 offen offset:1024  lds
  buffer_load_dwordx4 v16, s[64:67], s78 offen offset:2048  lds
  buffer_load_dwordx4 v17, s[64:67], s78 offen offset:3072  lds
  s_add_u32 m0, s27, 4096
  s_nop 0
  buffer_load_dwordx4 v18, s[64:67], s78 offen offset:0  lds
  buffer_load_dwordx4 v19, s[64:67], s78 offen offset:1024  lds
  buffer_load_dwordx4 v20, s[64:67], s78 offen offset:2048  lds
  buffer_load_dwordx4 v21, s[64:67], s78 offen offset:3072  lds
  s_add_u32 m0, s27, 8192
  s_nop 0
  buffer_load_dwordx4 v22, s[64:67], s78 offen offset:0  lds
  v_add_u32 v25, s23, v24
  ds_write_b128 v25, v[168:171] offset:0
  ds_write_b128 v25, v[172:175] offset:1024
  ds_write_b128 v25, v[176:179] offset:2048
  ds_write_b128 v25, v[188:191] offset:3072
  ds_write_b128 v25, v[192:195] offset:4096
  ds_write_b128 v25, v[200:203] offset:5120
  ds_write_b128 v25, v[204:207] offset:6144
  ds_write_b128 v25, v[212:215] offset:7168
  ds_write_b128 v25, v[216:219] offset:8192
  s_waitcnt vmcnt(0)
  s_waitcnt lgkmcnt(0)
  s_barrier
  s_barrier
  s_lshl_b32 s9, s6, 3
  s_add_u32 s9, s9, s4
  s_cmp_ge_u32 s9, 30
  s_cbranch_scc1 aux_done
  v_bfe_u32 v2, v0, 3, 2
  v_lshlrev_b32 v2, 11, v2
  s_and_b32 s10, s13, 0xfc
  s_lshl_b32 s11, s10, 11
  s_add_u32 s11, s11, 20448256
  v_add_u32 v2, s11, v2
  s_mul_i32 s10, s10, 30720
  s_lshl_b32 s11, s9, 10
  s_add_u32 s10, s10, s11
  s_add_u32 s10, s10, 12582912
  v_lshlrev_b32 v3, 4, v0
  s_mul_i32 s11, s9, 13108
  s_lshr_b32 s11, s11, 16
  s_mul_i32 s12, s11, 5
  s_sub_u32 s9, s9, s12
  s_lshl_b32 s12, s11, 2
  s_lshr_b32 s12, 0x513402, s12
  s_and_b32 s12, s12, 7
  s_lshl_b32 s12, s12, 7
  v_add_u32 v2, s12, v2
  s_lshl_b32 s11, s11, 4
  s_mul_i32 s12, s7, 96
  s_add_u32 s11, s11, s12
  s_mul_i32 s11, s11, 2304
  s_mul_i32 s12, s5, 1152
  s_add_u32 s11, s11, s12
  s_mul_i32 s12, s8, 288
  s_add_u32 s11, s11, s12
  s_lshl_b32 s12, s9, 6
  s_add_u32 s11, s11, s12
  v_and_b32 v4, 15, v0
  v_mul_u32_u24 v4, 2304, v4
  v_lshrrev_b32 v5, 4, v0
  v_and_b32 v6, 1, v5
  v_lshl_add_u32 v6, v6, 5, v4
  v_lshrrev_b32 v7, 1, v5
  v_lshl_add_u32 v6, v7, 4, v6
  v_lshl_add_u32 v4, v5, 3, v4
  s_mov_b32 s43, 0
aux_f3_spin:
  buffer_load_dword v5, v2, s[60:63], 0 offen sc1
  s_waitcnt vmcnt(0)
  v_cmp_ne_u32 vcc, 1, v5
  s_cbranch_vccz aux_f3_ok
  s_add_u32 s43, s43, 1
  s_cmp_lt_u32 s43, 65536
  s_cbranch_scc1 aux_f3_spin
aux_f3_ok:
  buffer_load_dwordx4 v[8:11], v3, s[60:63], s10 offen sc1
  s_add_u32 s10, s10, 30720
  buffer_load_dwordx4 v[12:15], v3, s[60:63], s10 offen sc1
  s_add_u32 s10, s10, 30720
  buffer_load_dwordx4 v[16:19], v3, s[60:63], s10 offen sc1
  s_add_u32 s10, s10, 30720
  buffer_load_dwordx4 v[20:23], v3, s[60:63], s10 offen sc1
  s_waitcnt vmcnt(3)
  v_lshlrev_b32 v44, 16, v8
  v_and_b32 v45, 0xffff0000, v8
  v_lshlrev_b32 v46, 16, v9
  v_and_b32 v47, 0xffff0000, v9
  v_lshlrev_b32 v48, 16, v10
  v_and_b32 v49, 0xffff0000, v10
  v_lshlrev_b32 v50, 16, v11
  v_and_b32 v51, 0xffff0000, v11
  s_waitcnt vmcnt(2)
  v_lshlrev_b32 v52, 16, v12
  v_and_b32 v53, 0xffff0000, v12
  v_add_f32 v44, v44, v52
  v_add_f32 v45, v45, v53
  v_lshlrev_b32 v52, 16, v13
  v_and_b32 v53, 0xffff0000, v13
  v_add_f32 v46, v46, v52
  v_add_f32 v47, v47, v53
  v_lshlrev_b32 v52, 16, v14
  v_and_b32 v53, 0xffff0000, v14
  v_add_f32 v48, v48, v52
  v_add_f32 v49, v49, v53
  v_lshlrev_b32 v52, 16, v15
  v_and_b32 v53, 0xffff0000, v15
  v_add_f32 v50, v50, v52
  v_add_f32 v51, v51, v53
  s_waitcnt vmcnt(1)
  v_lshlrev_b32 v52, 16, v16
  v_and_b32 v53, 0xffff0000, v16
  v_add_f32 v44, v44, v52
  v_add_f32 v45, v45, v53
  v_lshlrev_b32 v52, 16, v17
  v_and_b32 v53, 0xffff0000, v17
  v_add_f32 v46, v46, v52
  v_add_f32 v47, v47, v53
  v_lshlrev_b32 v52, 16, v18
  v_and_b32 v53, 0xffff0000, v18
  v_add_f32 v48, v48, v52
  v_add_f32 v49, v49, v53
  v_lshlrev_b32 v52, 16, v19
  v_and_b32 v53, 0xffff0000, v19
  v_add_f32 v50, v50, v52
  v_add_f32 v51, v51, v53
  s_waitcnt vmcnt(0)
  v_lshlrev_b32 v52, 16, v20
  v_and_b32 v53, 0xffff0000, v20
  v_add_f32 v44, v44, v52
  v_add_f32 v45, v45, v53
  v_lshlrev_b32 v52, 16, v21
  v_and_b32 v53, 0xffff0000, v21
  v_add_f32 v46, v46, v52
  v_add_f32 v47, v47, v53
  v_lshlrev_b32 v52, 16, v22
  v_and_b32 v53, 0xffff0000, v22
  v_add_f32 v48, v48, v52
  v_add_f32 v49, v49, v53
  v_lshlrev_b32 v52, 16, v23
  v_and_b32 v53, 0xffff0000, v23
  v_add_f32 v50, v50, v52
  v_add_f32 v51, v51, v53
  v_cvt_pk_bf16_f32 v8, v44, v45
  v_cvt_pk_bf16_f32 v9, v46, v47
  v_cvt_pk_bf16_f32 v10, v48, v49
  v_cvt_pk_bf16_f32 v11, v50, v51
  s_cmp_eq_u32 s9, 4
  s_cbranch_scc1 aux_narrow
  v_permlane16_swap_b32 v8, v10
  v_permlane16_swap_b32 v9, v11
  buffer_store_dwordx4 v[8:11], v6, s[68:71], s11 offen sc1
  s_branch aux_st
aux_narrow:
  buffer_store_dwordx2 v[8:9], v4, s[68:71], s11 offen sc1
aux_st:
aux_done:
  s_endpgm
aux_slowc:
  s_mov_b32 s43, 0
aux_c_spin:
  buffer_load_dword v31, v30, s[16:19], 0 offen sc1
  s_waitcnt vmcnt(0)
  v_and_b32 v31, 0x01010101, v31
  v_cmp_ne_u32 vcc, 0x01010101, v31
  s_cbranch_vccz aux_c_ok
  s_add_u32 s43, s43, 1
  s_cmp_lt_u32 s43, 65536
  s_cbranch_scc1 aux_c_spin
aux_c_ok:
  s_branch aux_cok
aux_slowf:
  s_mov_b32 s43, 0
aux_f1_spin:
  buffer_load_dword v32, v23, s[60:63], 0 offen sc1
  s_waitcnt vmcnt(0)
  v_cmp_ne_u32 vcc, 1, v32
  s_cbranch_vccz aux_f1_ok
  s_add_u32 s43, s43, 1
  s_cmp_lt_u32 s43, 65536
  s_cbranch_scc1 aux_f1_spin
aux_f1_ok:
  s_branch aux_fok
L_attn:
  s_lshl_b32 s9, s6, 2
  s_lshl_b32 s10, s7, 5
  s_add_u32 s10, s10, s9
  s_add_u32 s11, s10, s8
  s_lshl_b32 s72, s11, 18
  s_lshl_b32 s11, s5, 8
  s_add_u32 s10, s10, s11
  s_mul_i32 s42, s10, 24576
  s_add_u32 s10, s99, s100
  s_sub_u32 s10, s10, s8
  s_lshl_b32 s10, s10, 18
  s_add_u32 s92, s72, s10
  s_mul_i32 s10, s99, 24576
  s_add_u32 s93, s42, s10
  s_cmp_ge_u32 s4, 3
  s_cselect_b32 s77, 1, 0
  s_mul_i32 s9, s77, 3
  s_sub_u32 s76, s4, s9
  v_and_b32 v16, 31, v0
  v_lshrrev_b32 v17, 5, v0
  v_bfe_u32 v18, v0, 4, 1
  v_bfe_u32 v19, v0, 2, 2
  v_and_b32 v20, 3, v0
  s_lshl_b32 s9, s77, 13
  v_and_b32 v21, 15, v16
  v_xor_b32 v21, v21, v17
  v_lshlrev_b32 v21, 4, v21
  v_lshl_add_u32 v21, v16, 8, v21
  v_add_u32 v1, s9, v21
  s_lshl_b32 s10, s77, 1
  v_xor_b32 v21, s10, v19
  v_lshlrev_b32 v21, 6, v21
  v_lshl_add_u32 v21, v18, 5, v21
  v_lshl_add_u32 v21, v19, 8, v21
  v_lshl_add_u32 v22, v17, 10, v21
  v_lshl_add_u32 v22, v20, 3, v22
  s_add_u32 s9, s9, 16384
  v_add_u32 v2, s9, v22
  s_lshl_b32 s9, s4, 1
  s_sub_u32 s10, s4, 2
  s_cmp_ge_u32 s4, 4
  s_cselect_b32 s85, s10, s9
  s_cmp_lt_u32 s4, 2
  s_cselect_b32 s85, s4, s85
  s_and_b32 s10, s85, 3
  v_xor_b32 v21, s10, v19
  v_lshlrev_b32 v21, 6, v21
  v_lshl_add_u32 v21, v18, 5, v21
  v_lshl_add_u32 v21, v19, 8, v21
  v_lshl_add_u32 v22, v17, 11, v21
  v_and_b32 v21, 1, v20
  v_lshl_add_u32 v22, v21, 4, v22
  v_lshrrev_b32 v21, 1, v20
  v_lshl_add_u32 v22, v21, 3, v22
  s_lshr_b32 s9, s85, 2
  s_lshl_b32 s9, s9, 13
  v_add_u32 v3, s9, v22
  v_bfe_u32 v21, v16, 1, 3
  v_xor_b32 v21, v21, v17
  v_lshlrev_b32 v21, 4, v21
  v_lshl_add_u32 v4, v16, 7, v21
  v_lshlrev_b32 v5, 4, v0
  s_lshl_b32 s9, s76, 13
  s_lshl_b32 s10, s77, 12
  s_add_u32 s10, s10, s9
  v_add_u32 v11, s10, v5
  s_add_u32 s9, s9, 98304
  s_cmp_eq_u32 s76, 2
  s_cselect_b32 s9, 131072, s9
  v_add_u32 v6, s9, v5
  s_add_u32 s11, s4, 3
  s_cmp_ge_u32 s11, 6
  s_cselect_b32 s10, 6, 0
  s_sub_u32 s11, s11, s10
  s_lshl_b32 s9, s4, 12
  s_add_u32 s9, s9, 98304
  v_add_u32 v7, s9, v5
  s_lshl_b32 s9, s4, 9
  s_add_u32 s9, s9, 122880
  v_lshrrev_b32 v9, 1, v5
  v_add_u32 v9, s9, v9
  s_lshl_b32 s9, s11, 12
  s_add_u32 s9, s9, 98304
  v_add_u32 v8, s9, v5
  s_lshl_b32 s9, s11, 9
  s_add_u32 s9, s9, 122880
  v_lshrrev_b32 v10, 1, v5
  v_add_u32 v10, s9, v10
  s_mov_b32 s79, 0x4e800000
  s_mov_b32 s80, 0x3e0293ee
  s_mov_b32 s81, s80
  s_mov_b32 s75, 0
  s_mov_b32 s89, 99
  s_mov_b32 s73, 0
  s_mul_i32 s98, s8, 24576
  s_add_u32 s98, s98, s42
  s_mov_b32 s83, 98304
  s_mov_b32 s84, 65536
  s_waitcnt lgkmcnt(0)
  s_mov_b64 s[60:61], s[40:41]
  s_mov_b32 s62, 289079296
  s_mov_b32 s63, 0x20000
  s_mov_b64 s[68:69], s[36:37]
  s_mov_b32 s70, 1769472
  s_mov_b32 s71, 0x20000
  s_mov_b64 s[16:17], s[38:39]
  s_mov_b32 s18, 256
  s_mov_b32 s19, 0x20000
  s_cmp_lg_u32 s4, 0
  s_cbranch_scc1 at_noinit
  v_mov_b32 v16, 0
  v_mov_b32 v17, 0
  v_mov_b32 v18, 0
  v_mov_b32 v19, 0
  s_lshl_b32 s9, s13, 11
  s_add_u32 s9, s9, 20447232
  buffer_store_dwordx4 v[16:19], v5, s[60:63], s9 offen sc1
  buffer_store_dwordx4 v[16:19], v5, s[60:63], s9 offen offset:1024 sc1
at_noinit:
  s_cmp_lg_u32 s4, 1
  s_cbranch_scc1 at_nocpf
  s_getpc_b64 s[94:95]
cpf0_pc:
  s_add_u32 s94, s94, concat_heads__mha_block_cached__gqa_block_cached__near_ridge_kernel-cpf0_pc
  s_addc_u32 s95, s95, (concat_heads__mha_block_cached__gqa_block_cached__near_ridge_kernel-cpf0_pc)>>32
  s_lshr_b32 s9, s13, 3
  s_mul_i32 s9, s9, 2048
  s_add_u32 s10, s9, 0
  s_min_u32 s10, s10, L_end-concat_heads__mha_block_cached__gqa_block_cached__near_ridge_kernel-1024
  v_lshl_add_u32 v16, v0, 4, s10
  global_load_dwordx4 v[18:21], v16, s[94:95]
  s_add_u32 s10, s9, 1024
  s_min_u32 s10, s10, L_end-concat_heads__mha_block_cached__gqa_block_cached__near_ridge_kernel-1024
  v_lshl_add_u32 v16, v0, 4, s10
  global_load_dwordx4 v[18:21], v16, s[94:95]
at_nocpf:
  s_cmp_ge_u32 s85, 4
  s_cbranch_scc1 at_q2
  v_add_u32 v24, s83, v3
  v_add_u32 v26, s84, v4
  v_xor_b32 v27, 32, v26
  s_barrier
  ds_read_b64_tr_b16 v[208:209], v24 offset:0
  ds_read_b64_tr_b16 v[210:211], v24 offset:1024
  ds_read_b128 v[160:163], v26 offset:0
  ds_read_b128 v[164:167], v26 offset:4096
  ds_read_b128 v[168:171], v26 offset:8192
  ds_read_b64_tr_b16 v[212:213], v24 offset:4096
  ds_read_b64_tr_b16 v[214:215], v24 offset:5120
  ds_read_b128 v[172:175], v27 offset:0
  ds_read_b128 v[176:179], v27 offset:4096
  ds_read_b128 v[180:183], v27 offset:8192
  s_add_u32 s83, s83, 16384
  s_cmp_eq_u32 s83, 163840
  s_cselect_b32 s83, 98304, s83
  v_add_u32 v24, s83, v3
  v_add_u32 v26, s84, v4
  v_xor_b32 v26, 64, v26
  v_xor_b32 v27, 32, v26
  s_waitcnt lgkmcnt(0)
  s_barrier
  ds_read_b64_tr_b16 v[216:217], v24 offset:0
  ds_read_b64_tr_b16 v[218:219], v24 offset:1024
  ds_read_b128 v[184:187], v26 offset:0
  v_mfma_f32_32x32x16_bf16 v[64:79], v[208:211], v[160:163], 0
  ds_read_b128 v[188:191], v26 offset:4096
  ds_read_b128 v[192:195], v26 offset:8192
  ds_read_b64_tr_b16 v[220:221], v24 offset:4096
  v_mfma_f32_32x32x16_bf16 v[80:95], v[208:211], v[164:167], 0
  ds_read_b64_tr_b16 v[222:223], v24 offset:5120
  ds_read_b128 v[196:199], v27 offset:0
  v_mfma_f32_32x32x16_bf16 v[96:111], v[208:211], v[168:171], 0
  ds_read_b128 v[200:203], v27 offset:4096
  ds_read_b128 v[204:207], v27 offset:8192
  v_mfma_f32_32x32x16_bf16 v[64:79], v[212:215], v[172:175], v[64:79]
  v_mfma_f32_32x32x16_bf16 v[80:95], v[212:215], v[176:179], v[80:95]
  v_mfma_f32_32x32x16_bf16 v[96:111], v[212:215], v[180:183], v[96:111]
  s_add_u32 s83, s83, 16384
  s_cmp_eq_u32 s83, 163840
  s_cselect_b32 s83, 98304, s83
  s_xor_b32 s84, s84, 12288
  v_add_u32 v24, s83, v3
  v_add_u32 v26, s84, v4
  v_xor_b32 v27, 32, v26
  s_waitcnt lgkmcnt(0)
  s_mov_b32 s74, 8
at_qa_loop:
  s_barrier
  ds_read_b64_tr_b16 v[208:209], v24 offset:0
  ds_read_b64_tr_b16 v[210:211], v24 offset:1024
  ds_read_b128 v[160:163], v26 offset:0
  v_mfma_f32_32x32x16_bf16 v[64:79], v[216:219], v[184:187], v[64:79]
  ds_read_b128 v[164:167], v26 offset:4096
  ds_read_b128 v[168:171], v26 offset:8192
  ds_read_b64_tr_b16 v[212:213], v24 offset:4096
  v_mfma_f32_32x32x16_bf16 v[80:95], v[216:219], v[188:191], v[80:95]
  ds_read_b64_tr_b16 v[214:215], v24 offset:5120
  ds_read_b128 v[172:175], v27 offset:0
  v_mfma_f32_32x32x16_bf16 v[96:111], v[216:219], v[192:195], v[96:111]
  ds_read_b128 v[176:179], v27 offset:4096
  ds_read_b128 v[180:183], v27 offset:8192
  v_mfma_f32_32x32x16_bf16 v[64:79], v[220:223], v[196:199], v[64:79]
  v_mfma_f32_32x32x16_bf16 v[80:95], v[220:223], v[200:203], v[80:95]
  v_mfma_f32_32x32x16_bf16 v[96:111], v[220:223], v[204:207], v[96:111]
  s_add_u32 s83, s83, 16384
  s_cmp_eq_u32 s83, 163840
  s_cselect_b32 s83, 98304, s83
  v_add_u32 v24, s83, v3
  v_add_u32 v26, s84, v4
  v_xor_b32 v26, 64, v26
  v_xor_b32 v27, 32, v26
  s_waitcnt lgkmcnt(0)
  s_barrier
  ds_read_b64_tr_b16 v[216:217], v24 offset:0
  ds_read_b64_tr_b16 v[218:219], v24 offset:1024
  ds_read_b128 v[184:187], v26 offset:0
  v_mfma_f32_32x32x16_bf16 v[64:79], v[208:211], v[160:163], v[64:79]
  ds_read_b128 v[188:191], v26 offset:4096
  ds_read_b128 v[192:195], v26 offset:8192
  ds_read_b64_tr_b16 v[220:221], v24 offset:4096
  v_mfma_f32_32x32x16_bf16 v[80:95], v[208:211], v[164:167], v[80:95]
  ds_read_b64_tr_b16 v[222:223], v24 offset:5120
  ds_read_b128 v[196:199], v27 offset:0
  v_mfma_f32_32x32x16_bf16 v[96:111], v[208:211], v[168:171], v[96:111]
  ds_read_b128 v[200:203], v27 offset:4096
  ds_read_b128 v[204:207], v27 offset:8192
  v_mfma_f32_32x32x16_bf16 v[64:79], v[212:215], v[172:175], v[64:79]
  v_mfma_f32_32x32x16_bf16 v[80:95], v[212:215], v[176:179], v[80:95]
  v_mfma_f32_32x32x16_bf16 v[96:111], v[212:215], v[180:183], v[96:111]
  s_add_u32 s83, s83, 16384
  s_cmp_eq_u32 s83, 163840
  s_cselect_b32 s83, 98304, s83
  s_xor_b32 s84, s84, 12288
  v_add_u32 v24, s83, v3
  v_add_u32 v26, s84, v4
  v_xor_b32 v27, 32, v26
  s_sub_u32 s74, s74, 1
  s_cmp_lg_u32 s74, 0
  s_waitcnt lgkmcnt(0)
  s_cbranch_scc1 at_qa_loop
  s_and_b32 s9, s85, 3
  s_lshl_b32 s9, s9, 11
  v_add_u32 v24, s9, v5
  s_cmp_ge_u32 s85, 4
  s_cselect_b32 s9, 40960, 0
  s_cselect_b32 s10, 24576, 0
  s_add_u32 s9, s9, 98304
  v_add_u32 v25, s9, v24
  s_add_u32 s10, s10, 131072
  v_add_u32 v26, s10, v24
  v_mfma_f32_32x32x16_bf16 v[64:79], v[216:219], v[184:187], v[64:79]
  v_mfma_f32_32x32x16_bf16 v[64:79], v[220:223], v[196:199], v[64:79]
  v_mfma_f32_32x32x16_bf16 v[80:95], v[216:219], v[188:191], v[80:95]
  v_mfma_f32_32x32x16_bf16 v[80:95], v[220:223], v[200:203], v[80:95]
  s_nop 9
  v_pk_mul_f32 v[64:65], v[64:65], s[80:81]
  v_pk_mul_f32 v[66:67], v[66:67], s[80:81]
  v_pk_mul_f32 v[68:69], v[68:69], s[80:81]
  v_pk_mul_f32 v[70:71], v[70:71], s[80:81]
  v_pk_mul_f32 v[72:73], v[72:73], s[80:81]
  v_pk_mul_f32 v[74:75], v[74:75], s[80:81]
  v_pk_mul_f32 v[76:77], v[76:77], s[80:81]
  v_pk_mul_f32 v[78:79], v[78:79], s[80:81]
  v_cvt_pk_bf16_f32 v32, v64, v65
  v_cvt_pk_bf16_f32 v33, v66, v67
  v_cvt_pk_bf16_f32 v34, v68, v69
  v_cvt_pk_bf16_f32 v35, v70, v71
  v_cvt_pk_bf16_f32 v36, v72, v73
  v_cvt_pk_bf16_f32 v37, v74, v75
  v_cvt_pk_bf16_f32 v38, v76, v77
  v_cvt_pk_bf16_f32 v39, v78, v79
  ds_write_b128 v25, v[32:35] offset:0
  ds_write_b128 v25, v[36:39] offset:1024
  v_mfma_f32_32x32x16_bf16 v[96:111], v[216:219], v[192:195], v[96:111]
  v_mfma_f32_32x32x16_bf16 v[96:111], v[220:223], v[204:207], v[96:111]
  v_pk_mul_f32 v[80:81], v[80:81], s[80:81]
  v_pk_mul_f32 v[82:83], v[82:83], s[80:81]
  v_pk_mul_f32 v[84:85], v[84:85], s[80:81]
  v_pk_mul_f32 v[86:87], v[86:87], s[80:81]
  v_pk_mul_f32 v[88:89], v[88:89], s[80:81]
  v_pk_mul_f32 v[90:91], v[90:91], s[80:81]
  v_pk_mul_f32 v[92:93], v[92:93], s[80:81]
  v_pk_mul_f32 v[94:95], v[94:95], s[80:81]
  v_cvt_pk_bf16_f32 v40, v80, v81
  v_cvt_pk_bf16_f32 v41, v82, v83
  v_cvt_pk_bf16_f32 v42, v84, v85
  v_cvt_pk_bf16_f32 v43, v86, v87
  v_cvt_pk_bf16_f32 v44, v88, v89
  v_cvt_pk_bf16_f32 v45, v90, v91
  v_cvt_pk_bf16_f32 v46, v92, v93
  v_cvt_pk_bf16_f32 v47, v94, v95
  ds_write_b128 v25, v[40:43] offset:8192
  ds_write_b128 v25, v[44:47] offset:9216
  v_pk_mul_f32 v[96:97], v[96:97], s[80:81]
  v_pk_mul_f32 v[98:99], v[98:99], s[80:81]
  v_pk_mul_f32 v[100:101], v[100:101], s[80:81]
  v_pk_mul_f32 v[102:103], v[102:103], s[80:81]
  v_pk_mul_f32 v[104:105], v[104:105], s[80:81]
  v_pk_mul_f32 v[106:107], v[106:107], s[80:81]
  v_pk_mul_f32 v[108:109], v[108:109], s[80:81]
  v_pk_mul_f32 v[110:111], v[110:111], s[80:81]
  v_cvt_pk_bf16_f32 v48, v96, v97
  v_cvt_pk_bf16_f32 v49, v98, v99
  v_cvt_pk_bf16_f32 v50, v100, v101
  v_cvt_pk_bf16_f32 v51, v102, v103
  v_cvt_pk_bf16_f32 v52, v104, v105
  v_cvt_pk_bf16_f32 v53, v106, v107
  v_cvt_pk_bf16_f32 v54, v108, v109
  v_cvt_pk_bf16_f32 v55, v110, v111
  ds_write_b128 v26, v[48:51] offset:0
  ds_write_b128 v26, v[52:55] offset:1024
  s_waitcnt lgkmcnt(0)
  s_branch at_qdone
at_q2:
  v_add_u32 v24, s83, v3
  v_xor_b32 v25, 64, v24
  v_add_u32 v26, s84, v4
  v_xor_b32 v27, 32, v26
  s_barrier
  ds_read_b64_tr_b16 v[208:209], v24 offset:0
  ds_read_b64_tr_b16 v[210:211], v24 offset:1024
  ds_read_b64_tr_b16 v[212:213], v25 offset:0
  ds_read_b64_tr_b16 v[214:215], v25 offset:1024
  ds_read_b128 v[160:163], v26 offset:0
  ds_read_b128 v[164:167], v26 offset:4096
  ds_read_b128 v[168:171], v26 offset:8192
  ds_read_b64_tr_b16 v[216:217], v24 offset:4096
  ds_read_b64_tr_b16 v[218:219], v24 offset:5120
  ds_read_b64_tr_b16 v[220:221], v25 offset:4096
  ds_read_b64_tr_b16 v[222:223], v25 offset:5120
  ds_read_b128 v[172:175], v27 offset:0
  ds_read_b128 v[176:179], v27 offset:4096
  ds_read_b128 v[180:183], v27 offset:8192
  s_add_u32 s83, s83, 16384
  s_cmp_eq_u32 s83, 163840
  s_cselect_b32 s83, 98304, s83
  v_add_u32 v24, s83, v3
  v_xor_b32 v25, 64, v24
  v_add_u32 v26, s84, v4
  v_xor_b32 v26, 64, v26
  v_xor_b32 v27, 32, v26
  s_waitcnt lgkmcnt(0)
  s_barrier
  ds_read_b64_tr_b16 v[224:225], v24 offset:0
  ds_read_b64_tr_b16 v[226:227], v24 offset:1024
  v_mfma_f32_32x32x16_bf16 v[64:79], v[208:211], v[160:163], 0
  ds_read_b64_tr_b16 v[228:229], v25 offset:0
  ds_read_b64_tr_b16 v[230:231], v25 offset:1024
  v_mfma_f32_32x32x16_bf16 v[80:95], v[208:211], v[164:167], 0
  ds_read_b128 v[184:187], v26 offset:0
  ds_read_b128 v[188:191], v26 offset:4096
  v_mfma_f32_32x32x16_bf16 v[96:111], v[208:211], v[168:171], 0
  ds_read_b128 v[192:195], v26 offset:8192
  ds_read_b64_tr_b16 v[232:233], v24 offset:4096
  v_mfma_f32_32x32x16_bf16 v[112:127], v[212:215], v[160:163], 0
  ds_read_b64_tr_b16 v[234:235], v24 offset:5120
  v_mfma_f32_32x32x16_bf16 v[128:143], v[212:215], v[164:167], 0
  ds_read_b64_tr_b16 v[236:237], v25 offset:4096
  ds_read_b64_tr_b16 v[238:239], v25 offset:5120
  v_mfma_f32_32x32x16_bf16 v[144:159], v[212:215], v[168:171], 0
  ds_read_b128 v[196:199], v27 offset:0
  ds_read_b128 v[200:203], v27 offset:4096
  v_mfma_f32_32x32x16_bf16 v[64:79], v[216:219], v[172:175], v[64:79]
  ds_read_b128 v[204:207], v27 offset:8192
  v_mfma_f32_32x32x16_bf16 v[80:95], v[216:219], v[176:179], v[80:95]
  v_mfma_f32_32x32x16_bf16 v[96:111], v[216:219], v[180:183], v[96:111]
  v_mfma_f32_32x32x16_bf16 v[112:127], v[220:223], v[172:175], v[112:127]
  v_mfma_f32_32x32x16_bf16 v[128:143], v[220:223], v[176:179], v[128:143]
  v_mfma_f32_32x32x16_bf16 v[144:159], v[220:223], v[180:183], v[144:159]
  s_add_u32 s83, s83, 16384
  s_cmp_eq_u32 s83, 163840
  s_cselect_b32 s83, 98304, s83
  s_xor_b32 s84, s84, 12288
  v_add_u32 v24, s83, v3
  v_xor_b32 v25, 64, v24
  v_add_u32 v26, s84, v4
  v_xor_b32 v27, 32, v26
  s_waitcnt lgkmcnt(0)
  s_mov_b32 s74, 8
at_qb_loop:
  s_barrier
  ds_read_b64_tr_b16 v[208:209], v24 offset:0
  ds_read_b64_tr_b16 v[210:211], v24 offset:1024
  v_mfma_f32_32x32x16_bf16 v[64:79], v[224:227], v[184:187], v[64:79]
  ds_read_b64_tr_b16 v[212:213], v25 offset:0
  ds_read_b64_tr_b16 v[214:215], v25 offset:1024
  v_mfma_f32_32x32x16_bf16 v[80:95], v[224:227], v[188:191], v[80:95]
  ds_read_b128 v[160:163], v26 offset:0
  ds_read_b128 v[164:167], v26 offset:4096
  v_mfma_f32_32x32x16_bf16 v[96:111], v[224:227], v[192:195], v[96:111]
  ds_read_b128 v[168:171], v26 offset:8192
  ds_read_b64_tr_b16 v[216:217], v24 offset:4096
  v_mfma_f32_32x32x16_bf16 v[112:127], v[228:231], v[184:187], v[112:127]
  ds_read_b64_tr_b16 v[218:219], v24 offset:5120
  v_mfma_f32_32x32x16_bf16 v[128:143], v[228:231], v[188:191], v[128:143]
  ds_read_b64_tr_b16 v[220:221], v25 offset:4096
  ds_read_b64_tr_b16 v[222:223], v25 offset:5120
  v_mfma_f32_32x32x16_bf16 v[144:159], v[228:231], v[192:195], v[144:159]
  ds_read_b128 v[172:175], v27 offset:0
  ds_read_b128 v[176:179], v27 offset:4096
  v_mfma_f32_32x32x16_bf16 v[64:79], v[232:235], v[196:199], v[64:79]
  ds_read_b128 v[180:183], v27 offset:8192
  v_mfma_f32_32x32x16_bf16 v[80:95], v[232:235], v[200:203], v[80:95]
  v_mfma_f32_32x32x16_bf16 v[96:111], v[232:235], v[204:207], v[96:111]
  v_mfma_f32_32x32x16_bf16 v[112:127], v[236:239], v[196:199], v[112:127]
  v_mfma_f32_32x32x16_bf16 v[128:143], v[236:239], v[200:203], v[128:143]
  v_mfma_f32_32x32x16_bf16 v[144:159], v[236:239], v[204:207], v[144:159]
  s_add_u32 s83, s83, 16384
  s_cmp_eq_u32 s83, 163840
  s_cselect_b32 s83, 98304, s83
  v_add_u32 v24, s83, v3
  v_xor_b32 v25, 64, v24
  v_add_u32 v26, s84, v4
  v_xor_b32 v26, 64, v26
  v_xor_b32 v27, 32, v26
  s_waitcnt lgkmcnt(0)
  s_barrier
  ds_read_b64_tr_b16 v[224:225], v24 offset:0
  ds_read_b64_tr_b16 v[226:227], v24 offset:1024
  v_mfma_f32_32x32x16_bf16 v[64:79], v[208:211], v[160:163], v[64:79]
  ds_read_b64_tr_b16 v[228:229], v25 offset:0
  ds_read_b64_tr_b16 v[230:231], v25 offset:1024
  v_mfma_f32_32x32x16_bf16 v[80:95], v[208:211], v[164:167], v[80:95]
  ds_read_b128 v[184:187], v26 offset:0
  ds_read_b128 v[188:191], v26 offset:4096
  v_mfma_f32_32x32x16_bf16 v[96:111], v[208:211], v[168:171], v[96:111]
  ds_read_b128 v[192:195], v26 offset:8192
  ds_read_b64_tr_b16 v[232:233], v24 offset:4096
  v_mfma_f32_32x32x16_bf16 v[112:127], v[212:215], v[160:163], v[112:127]
  ds_read_b64_tr_b16 v[234:235], v24 offset:5120
  v_mfma_f32_32x32x16_bf16 v[128:143], v[212:215], v[164:167], v[128:143]
  ds_read_b64_tr_b16 v[236:237], v25 offset:4096
  ds_read_b64_tr_b16 v[238:239], v25 offset:5120
  v_mfma_f32_32x32x16_bf16 v[144:159], v[212:215], v[168:171], v[144:159]
  ds_read_b128 v[196:199], v27 offset:0
  ds_read_b128 v[200:203], v27 offset:4096
  v_mfma_f32_32x32x16_bf16 v[64:79], v[216:219], v[172:175], v[64:79]
  ds_read_b128 v[204:207], v27 offset:8192
  v_mfma_f32_32x32x16_bf16 v[80:95], v[216:219], v[176:179], v[80:95]
  v_mfma_f32_32x32x16_bf16 v[96:111], v[216:219], v[180:183], v[96:111]
  v_mfma_f32_32x32x16_bf16 v[112:127], v[220:223], v[172:175], v[112:127]
  v_mfma_f32_32x32x16_bf16 v[128:143], v[220:223], v[176:179], v[128:143]
  v_mfma_f32_32x32x16_bf16 v[144:159], v[220:223], v[180:183], v[144:159]
  s_add_u32 s83, s83, 16384
  s_cmp_eq_u32 s83, 163840
  s_cselect_b32 s83, 98304, s83
  s_xor_b32 s84, s84, 12288
  v_add_u32 v24, s83, v3
  v_xor_b32 v25, 64, v24
  v_add_u32 v26, s84, v4
  v_xor_b32 v27, 32, v26
  s_sub_u32 s74, s74, 1
  s_cmp_lg_u32 s74, 0
  s_waitcnt lgkmcnt(0)
  s_cbranch_scc1 at_qb_loop
  s_and_b32 s9, s85, 3
  s_lshl_b32 s9, s9, 11
  v_add_u32 v24, s9, v5
  s_cmp_ge_u32 s85, 4
  s_cselect_b32 s9, 40960, 0
  s_cselect_b32 s10, 24576, 0
  s_add_u32 s9, s9, 98304
  v_add_u32 v25, s9, v24
  s_add_u32 s10, s10, 131072
  v_add_u32 v26, s10, v24
  v_mfma_f32_32x32x16_bf16 v[64:79], v[224:227], v[184:187], v[64:79]
  v_mfma_f32_32x32x16_bf16 v[64:79], v[232:235], v[196:199], v[64:79]
  v_mfma_f32_32x32x16_bf16 v[80:95], v[224:227], v[188:191], v[80:95]
  v_mfma_f32_32x32x16_bf16 v[80:95], v[232:235], v[200:203], v[80:95]
  s_nop 9
  v_pk_mul_f32 v[64:65], v[64:65], s[80:81]
  v_pk_mul_f32 v[66:67], v[66:67], s[80:81]
  v_pk_mul_f32 v[68:69], v[68:69], s[80:81]
  v_pk_mul_f32 v[70:71], v[70:71], s[80:81]
  v_pk_mul_f32 v[72:73], v[72:73], s[80:81]
  v_pk_mul_f32 v[74:75], v[74:75], s[80:81]
  v_pk_mul_f32 v[76:77], v[76:77], s[80:81]
  v_pk_mul_f32 v[78:79], v[78:79], s[80:81]
  v_cvt_pk_bf16_f32 v32, v64, v65
  v_cvt_pk_bf16_f32 v33, v66, v67
  v_cvt_pk_bf16_f32 v34, v68, v69
  v_cvt_pk_bf16_f32 v35, v70, v71
  v_cvt_pk_bf16_f32 v36, v72, v73
  v_cvt_pk_bf16_f32 v37, v74, v75
  v_cvt_pk_bf16_f32 v38, v76, v77
  v_cvt_pk_bf16_f32 v39, v78, v79
  ds_write_b128 v25, v[32:35] offset:0
  ds_write_b128 v25, v[36:39] offset:1024
  v_mfma_f32_32x32x16_bf16 v[96:111], v[224:227], v[192:195], v[96:111]
  v_mfma_f32_32x32x16_bf16 v[96:111], v[232:235], v[204:207], v[96:111]
  v_pk_mul_f32 v[80:81], v[80:81], s[80:81]
  v_pk_mul_f32 v[82:83], v[82:83], s[80:81]
  v_pk_mul_f32 v[84:85], v[84:85], s[80:81]
  v_pk_mul_f32 v[86:87], v[86:87], s[80:81]
  v_pk_mul_f32 v[88:89], v[88:89], s[80:81]
  v_pk_mul_f32 v[90:91], v[90:91], s[80:81]
  v_pk_mul_f32 v[92:93], v[92:93], s[80:81]
  v_pk_mul_f32 v[94:95], v[94:95], s[80:81]
  v_cvt_pk_bf16_f32 v40, v80, v81
  v_cvt_pk_bf16_f32 v41, v82, v83
  v_cvt_pk_bf16_f32 v42, v84, v85
  v_cvt_pk_bf16_f32 v43, v86, v87
  v_cvt_pk_bf16_f32 v44, v88, v89
  v_cvt_pk_bf16_f32 v45, v90, v91
  v_cvt_pk_bf16_f32 v46, v92, v93
  v_cvt_pk_bf16_f32 v47, v94, v95
  ds_write_b128 v25, v[40:43] offset:8192
  ds_write_b128 v25, v[44:47] offset:9216
  v_mfma_f32_32x32x16_bf16 v[112:127], v[228:231], v[184:187], v[112:127]
  v_mfma_f32_32x32x16_bf16 v[112:127], v[236:239], v[196:199], v[112:127]
  v_pk_mul_f32 v[96:97], v[96:97], s[80:81]
  v_pk_mul_f32 v[98:99], v[98:99], s[80:81]
  v_pk_mul_f32 v[100:101], v[100:101], s[80:81]
  v_pk_mul_f32 v[102:103], v[102:103], s[80:81]
  v_pk_mul_f32 v[104:105], v[104:105], s[80:81]
  v_pk_mul_f32 v[106:107], v[106:107], s[80:81]
  v_pk_mul_f32 v[108:109], v[108:109], s[80:81]
  v_pk_mul_f32 v[110:111], v[110:111], s[80:81]
  v_cvt_pk_bf16_f32 v48, v96, v97
  v_cvt_pk_bf16_f32 v49, v98, v99
  v_cvt_pk_bf16_f32 v50, v100, v101
  v_cvt_pk_bf16_f32 v51, v102, v103
  v_cvt_pk_bf16_f32 v52, v104, v105
  v_cvt_pk_bf16_f32 v53, v106, v107
  v_cvt_pk_bf16_f32 v54, v108, v109
  v_cvt_pk_bf16_f32 v55, v110, v111
  ds_write_b128 v26, v[48:51] offset:0
  ds_write_b128 v26, v[52:55] offset:1024
  v_mfma_f32_32x32x16_bf16 v[128:143], v[228:231], v[188:191], v[128:143]
  v_mfma_f32_32x32x16_bf16 v[128:143], v[236:239], v[200:203], v[128:143]
  v_pk_mul_f32 v[112:113], v[112:113], s[80:81]
  v_pk_mul_f32 v[114:115], v[114:115], s[80:81]
  v_pk_mul_f32 v[116:117], v[116:117], s[80:81]
  v_pk_mul_f32 v[118:119], v[118:119], s[80:81]
  v_pk_mul_f32 v[120:121], v[120:121], s[80:81]
  v_pk_mul_f32 v[122:123], v[122:123], s[80:81]
  v_pk_mul_f32 v[124:125], v[124:125], s[80:81]
  v_pk_mul_f32 v[126:127], v[126:127], s[80:81]
  v_cvt_pk_bf16_f32 v56, v112, v113
  v_cvt_pk_bf16_f32 v57, v114, v115
  v_cvt_pk_bf16_f32 v58, v116, v117
  v_cvt_pk_bf16_f32 v59, v118, v119
  v_cvt_pk_bf16_f32 v60, v120, v121
  v_cvt_pk_bf16_f32 v61, v122, v123
  v_cvt_pk_bf16_f32 v62, v124, v125
  v_cvt_pk_bf16_f32 v63, v126, v127
  ds_write_b128 v25, v[56:59] offset:2048
  ds_write_b128 v25, v[60:63] offset:3072
  v_mfma_f32_32x32x16_bf16 v[144:159], v[228:231], v[192:195], v[144:159]
  v_mfma_f32_32x32x16_bf16 v[144:159], v[236:239], v[204:207], v[144:159]
  v_pk_mul_f32 v[128:129], v[128:129], s[80:81]
  v_pk_mul_f32 v[130:131], v[130:131], s[80:81]
  v_pk_mul_f32 v[132:133], v[132:133], s[80:81]
  v_pk_mul_f32 v[134:135], v[134:135], s[80:81]
  v_pk_mul_f32 v[136:137], v[136:137], s[80:81]
  v_pk_mul_f32 v[138:139], v[138:139], s[80:81]
  v_pk_mul_f32 v[140:141], v[140:141], s[80:81]
  v_pk_mul_f32 v[142:143], v[142:143], s[80:81]
  v_cvt_pk_bf16_f32 v32, v128, v129
  v_cvt_pk_bf16_f32 v33, v130, v131
  v_cvt_pk_bf16_f32 v34, v132, v133
  v_cvt_pk_bf16_f32 v35, v134, v135
  v_cvt_pk_bf16_f32 v36, v136, v137
  v_cvt_pk_bf16_f32 v37, v138, v139
  v_cvt_pk_bf16_f32 v38, v140, v141
  v_cvt_pk_bf16_f32 v39, v142, v143
  ds_write_b128 v25, v[32:35] offset:10240
  ds_write_b128 v25, v[36:39] offset:11264
  v_pk_mul_f32 v[144:145], v[144:145], s[80:81]
  v_pk_mul_f32 v[146:147], v[146:147], s[80:81]
  v_pk_mul_f32 v[148:149], v[148:149], s[80:81]
  v_pk_mul_f32 v[150:151], v[150:151], s[80:81]
  v_pk_mul_f32 v[152:153], v[152:153], s[80:81]
  v_pk_mul_f32 v[154:155], v[154:155], s[80:81]
  v_pk_mul_f32 v[156:157], v[156:157], s[80:81]
  v_pk_mul_f32 v[158:159], v[158:159], s[80:81]
  v_cvt_pk_bf16_f32 v40, v144, v145
  v_cvt_pk_bf16_f32 v41, v146, v147
  v_cvt_pk_bf16_f32 v42, v148, v149
  v_cvt_pk_bf16_f32 v43, v150, v151
  v_cvt_pk_bf16_f32 v44, v152, v153
  v_cvt_pk_bf16_f32 v45, v154, v155
  v_cvt_pk_bf16_f32 v46, v156, v157
  v_cvt_pk_bf16_f32 v47, v158, v159
  ds_write_b128 v26, v[40:43] offset:2048
  ds_write_b128 v26, v[44:47] offset:3072
  s_waitcnt lgkmcnt(0)
at_qdone:
  v_add_u32 v24, s73, v1
  v_xor_b32 v25, 32, v24
  v_xor_b32 v26, 64, v24
  v_xor_b32 v27, 96, v24
  v_xor_b32 v28, 128, v24
  v_xor_b32 v29, 160, v24
  v_xor_b32 v30, 192, v24
  v_xor_b32 v31, 224, v24
  v_add_u32 v232, s73, v2
  v_xor_b32 v233, 64, v232
  v_xor_b32 v234, 128, v232
  v_xor_b32 v235, 192, v232
  s_barrier
  ds_read_b128 v[128:131], v6 offset:0
  ds_read_b128 v[132:135], v6 offset:1024
  ds_read_b128 v[136:139], v6 offset:2048
  ds_read_b128 v[140:143], v6 offset:3072
  ds_read_b128 v[144:147], v6 offset:4096
  ds_read_b128 v[148:151], v6 offset:5120
  ds_read_b128 v[152:155], v6 offset:6144
  ds_read_b128 v[156:159], v6 offset:7168
  s_and_b32 s87, s4, 1
  s_lshr_b32 s9, s4, 1
  s_cmp_eq_u32 s9, 2
  s_cselect_b32 s86, 2, 1
  s_cmp_eq_u32 s9, 1
  s_cselect_b32 s86, 0, s86
  v_lshrrev_b32 v16, 5, v0
  v_lshlrev_b32 v17, 10, v16
  v_lshlrev_b32 v18, 4, v16
  v_bfe_u32 v16, v0, 4, 1
  v_lshl_add_u32 v17, v16, 9, v17
  v_lshl_add_u32 v18, v16, 2, v18
  v_and_b32 v16, 15, v0
  v_lshl_add_u32 v17, v16, 4, v17
  s_add_u32 s9, s86, 0
  s_cmp_ge_u32 s9, 3
  s_cselect_b32 s12, 3, 0
  s_sub_u32 s9, s9, s12
  s_mul_i32 s10, s87, 3
  s_add_u32 s9, s9, s10
  s_lshr_b32 s10, s9, 1
  s_lshl_b32 s10, s10, 13
  s_and_b32 s9, s9, 1
  s_lshl_b32 s9, s9, 8
  s_add_u32 s9, s9, s10
  v_add_u32 v3, s9, v17
  s_add_u32 s9, s86, 1
  s_cmp_ge_u32 s9, 3
  s_cselect_b32 s12, 3, 0
  s_sub_u32 s9, s9, s12
  s_mul_i32 s10, s87, 3
  s_add_u32 s9, s9, s10
  s_lshr_b32 s10, s9, 1
  s_lshl_b32 s10, s10, 13
  s_and_b32 s9, s9, 1
  s_lshl_b32 s9, s9, 8
  s_add_u32 s9, s9, s10
  v_add_u32 v4, s9, v17
  s_add_u32 s9, s86, 2
  s_cmp_ge_u32 s9, 3
  s_cselect_b32 s12, 3, 0
  s_sub_u32 s9, s9, s12
  s_mul_i32 s10, s87, 3
  s_add_u32 s9, s9, s10
  s_lshr_b32 s10, s9, 1
  s_lshl_b32 s10, s10, 13
  s_and_b32 s9, s9, 1
  s_lshl_b32 s9, s9, 8
  s_add_u32 s9, s9, s10
  v_add_u32 v6, s9, v17
  v_bfe_u32 v16, v0, 2, 2
  v_add_u32 v18, v18, v16
  v_mul_u32_u24 v18, 288, v18
  v_and_b32 v16, 3, v0
  v_lshl_add_u32 v252, v16, 3, v18
  v_add_u32 v253, 65536, v252
  v_add_u32 v254, 121856, v252
  s_lshl_b32 s88, s13, 11
  s_add_u32 s88, s88, 20447232
  s_lshl_b32 s9, s4, 7
  s_add_u32 s101, s88, s9
  s_lshl_b32 s9, s4, 2
  s_add_u32 s88, s88, s9
  s_cmp_lg_u32 s4, 0
  s_cbranch_scc1 at_nomark
  s_waitcnt vmcnt(0)
  v_mov_b32 v15, 1
  s_mov_b64 exec, 1
  buffer_store_byte v15, off, s[16:19], s13 sc1
  s_mov_b64 exec, -1
at_nomark:
  s_waitcnt lgkmcnt(0)
at_round:
  ds_read_b128 v[200:203], v24
  ds_read_b128 v[204:207], v25
  ds_read_b128 v[208:211], v26
  ds_read_b128 v[212:215], v27
  ds_read_b128 v[216:219], v28
  ds_read_b128 v[220:223], v29
  ds_read_b128 v[224:227], v30
  ds_read_b128 v[228:231], v31
  s_waitcnt lgkmcnt(7)
  v_mfma_f32_32x32x16_bf16 v[176:191], v[200:203], v[128:131], 0
  s_waitcnt lgkmcnt(6)
  v_mfma_f32_32x32x16_bf16 v[176:191], v[204:207], v[132:135], v[176:191]
  s_waitcnt lgkmcnt(5)
  v_mfma_f32_32x32x16_bf16 v[176:191], v[208:211], v[136:139], v[176:191]
  ds_read_b64_tr_b16 v[32:33], v232 offset:0
  ds_read_b64_tr_b16 v[34:35], v232 offset:2048
  s_waitcnt lgkmcnt(6)
  v_mfma_f32_32x32x16_bf16 v[176:191], v[212:215], v[140:143], v[176:191]
  ds_read_b64_tr_b16 v[36:37], v233 offset:0
  ds_read_b64_tr_b16 v[38:39], v233 offset:2048
  s_waitcnt lgkmcnt(7)
  v_mfma_f32_32x32x16_bf16 v[176:191], v[216:219], v[144:147], v[176:191]
  ds_read_b64_tr_b16 v[40:41], v234 offset:0
  ds_read_b64_tr_b16 v[42:43], v234 offset:2048
  s_waitcnt lgkmcnt(8)
  v_mfma_f32_32x32x16_bf16 v[176:191], v[220:223], v[148:151], v[176:191]
  ds_read_b64_tr_b16 v[44:45], v235 offset:0
  ds_read_b64_tr_b16 v[46:47], v235 offset:2048
  s_waitcnt lgkmcnt(9)
  v_mfma_f32_32x32x16_bf16 v[176:191], v[224:227], v[152:155], v[176:191]
  ds_read_b64_tr_b16 v[48:49], v232 offset:4096
  ds_read_b64_tr_b16 v[50:51], v232 offset:6144
  s_waitcnt lgkmcnt(10)
  v_mfma_f32_32x32x16_bf16 v[176:191], v[228:231], v[156:159], v[176:191]
  ds_read_b64_tr_b16 v[52:53], v233 offset:4096
  ds_read_b64_tr_b16 v[54:55], v233 offset:6144
  ds_read_b64_tr_b16 v[56:57], v234 offset:4096
  ds_read_b64_tr_b16 v[58:59], v234 offset:6144
  ds_read_b64_tr_b16 v[60:61], v235 offset:4096
  ds_read_b64_tr_b16 v[62:63], v235 offset:6144
  s_nop 5
  v_max3_f32 v20, v176, v177, v178
  v_max3_f32 v20, v20, v179, v180
  v_max3_f32 v20, v20, v181, v182
  v_max3_f32 v20, v20, v183, v184
  v_max3_f32 v20, v20, v185, v186
  v_max3_f32 v20, v20, v187, v188
  v_max3_f32 v20, v20, v189, v190
  v_max_f32 v20, v20, v191
  v_mov_b32 v21, v20
  s_nop 1
  v_permlane32_swap_b32 v20, v21
  s_nop 1
  v_max_f32 v20, v20, v21
  v_sub_f32 v176, v176, v20
  v_sub_f32 v177, v177, v20
  v_sub_f32 v178, v178, v20
  v_sub_f32 v179, v179, v20
  v_sub_f32 v180, v180, v20
  v_sub_f32 v181, v181, v20
  v_sub_f32 v182, v182, v20
  v_sub_f32 v183, v183, v20
  v_sub_f32 v184, v184, v20
  v_sub_f32 v185, v185, v20
  v_sub_f32 v186, v186, v20
  v_sub_f32 v187, v187, v20
  v_sub_f32 v188, v188, v20
  v_sub_f32 v189, v189, v20
  v_sub_f32 v190, v190, v20
  v_sub_f32 v191, v191, v20
  v_sub_f32 v160, 0, v20
  v_mov_b32 v161, v160
  v_mov_b32 v162, v160
  v_mov_b32 v163, v160
  v_mov_b32 v164, v160
  v_mov_b32 v165, v160
  v_mov_b32 v166, v160
  v_mov_b32 v167, v160
  v_mov_b32 v168, v160
  v_mov_b32 v169, v160
  v_mov_b32 v170, v160
  v_mov_b32 v171, v160
  v_mov_b32 v172, v160
  v_mov_b32 v173, v160
  v_mov_b32 v174, v160
  v_mov_b32 v175, v160
  v_exp_f32 v16, v176
  v_exp_f32 v17, v177
  v_exp_f32 v18, v178
  v_exp_f32 v19, v179
  v_mov_b32 v13, v16
  v_mov_b32 v14, v17
  v_cvt_pk_bf16_f32 v192, v16, v17
  v_exp_f32 v16, v180
  v_exp_f32 v17, v181
  v_add_f32 v13, v13, v18
  v_add_f32 v14, v14, v19
  v_cvt_pk_bf16_f32 v193, v18, v19
  v_exp_f32 v18, v182
  v_exp_f32 v19, v183
  v_add_f32 v13, v13, v16
  v_add_f32 v14, v14, v17
  v_cvt_pk_bf16_f32 v194, v16, v17
  v_exp_f32 v16, v184
  v_exp_f32 v17, v185
  v_add_f32 v13, v13, v18
  v_add_f32 v14, v14, v19
  v_cvt_pk_bf16_f32 v195, v18, v19
  v_exp_f32 v18, v186
  v_exp_f32 v19, v187
  v_add_f32 v13, v13, v16
  v_add_f32 v14, v14, v17
  v_cvt_pk_bf16_f32 v196, v16, v17
  v_exp_f32 v16, v188
  v_exp_f32 v17, v189
  v_add_f32 v13, v13, v18
  v_add_f32 v14, v14, v19
  v_cvt_pk_bf16_f32 v197, v18, v19
  v_exp_f32 v18, v190
  v_exp_f32 v19, v191
  v_add_f32 v13, v13, v16
  v_add_f32 v14, v14, v17
  v_cvt_pk_bf16_f32 v198, v16, v17
  s_nop 0
  v_add_f32 v13, v13, v18
  v_add_f32 v14, v14, v19
  v_cvt_pk_bf16_f32 v199, v18, v19
  v_add_f32 v13, v13, v14
  v_mov_b32 v12, v13
  s_nop 0
  s_waitcnt lgkmcnt(14)
  v_mfma_f32_32x32x16_bf16 v[64:79], v[32:35], v[192:195], 0
  s_waitcnt lgkmcnt(12)
  v_mfma_f32_32x32x16_bf16 v[80:95], v[36:39], v[192:195], 0
  s_waitcnt lgkmcnt(10)
  v_mfma_f32_32x32x16_bf16 v[96:111], v[40:43], v[192:195], 0
  s_waitcnt lgkmcnt(8)
  v_mfma_f32_32x32x16_bf16 v[112:127], v[44:47], v[192:195], 0
  s_waitcnt lgkmcnt(6)
  v_mfma_f32_32x32x16_bf16 v[64:79], v[48:51], v[196:199], v[64:79]
  s_waitcnt lgkmcnt(4)
  v_mfma_f32_32x32x16_bf16 v[80:95], v[52:55], v[196:199], v[80:95]
  s_waitcnt lgkmcnt(2)
  v_mfma_f32_32x32x16_bf16 v[96:111], v[56:59], v[196:199], v[96:111]
  s_waitcnt lgkmcnt(0)
  v_mfma_f32_32x32x16_bf16 v[112:127], v[60:63], v[196:199], v[112:127]
  s_add_u32 s73, s73, 32768
  s_cmp_eq_u32 s73, 98304
  s_cselect_b32 s73, 0, s73
  v_add_u32 v24, s73, v1
  v_xor_b32 v25, 32, v24
  v_xor_b32 v26, 64, v24
  v_xor_b32 v27, 96, v24
  v_xor_b32 v28, 128, v24
  v_xor_b32 v29, 160, v24
  v_xor_b32 v30, 192, v24
  v_xor_b32 v31, 224, v24
  v_add_u32 v232, s73, v2
  v_xor_b32 v233, 64, v232
  v_xor_b32 v234, 128, v232
  v_xor_b32 v235, 192, v232
  s_mov_b32 s74, 15
  s_cmp_eq_u32 s75, 0
  s_cbranch_scc1 at_kvloop
  buffer_store_dwordx4 v[236:239], v11, s[60:63], s98 offen offset:0 sc1
  buffer_store_dwordx4 v[240:243], v11, s[60:63], s98 offen offset:1024 sc1
  buffer_store_dwordx4 v[244:247], v11, s[60:63], s98 offen offset:2048 sc1
  buffer_store_dwordx4 v[248:251], v11, s[60:63], s98 offen offset:3072 sc1
at_kvloop:
  s_barrier
  ds_read_b128 v[200:203], v24
  ds_read_b128 v[204:207], v25
  ds_read_b128 v[208:211], v26
  ds_read_b128 v[212:215], v27
  ds_read_b128 v[216:219], v28
  ds_read_b128 v[220:223], v29
  ds_read_b128 v[224:227], v30
  ds_read_b128 v[228:231], v31
  s_waitcnt lgkmcnt(7)
  v_mfma_f32_32x32x16_bf16 v[176:191], v[200:203], v[128:131], v[160:175]
  s_waitcnt lgkmcnt(6)
  v_mfma_f32_32x32x16_bf16 v[176:191], v[204:207], v[132:135], v[176:191]
  s_waitcnt lgkmcnt(5)
  v_mfma_f32_32x32x16_bf16 v[176:191], v[208:211], v[136:139], v[176:191]
  ds_read_b64_tr_b16 v[32:33], v232 offset:0
  ds_read_b64_tr_b16 v[34:35], v232 offset:2048
  s_waitcnt lgkmcnt(6)
  v_mfma_f32_32x32x16_bf16 v[176:191], v[212:215], v[140:143], v[176:191]
  ds_read_b64_tr_b16 v[36:37], v233 offset:0
  ds_read_b64_tr_b16 v[38:39], v233 offset:2048
  s_waitcnt lgkmcnt(7)
  v_mfma_f32_32x32x16_bf16 v[176:191], v[216:219], v[144:147], v[176:191]
  ds_read_b64_tr_b16 v[40:41], v234 offset:0
  ds_read_b64_tr_b16 v[42:43], v234 offset:2048
  s_waitcnt lgkmcnt(8)
  v_mfma_f32_32x32x16_bf16 v[176:191], v[220:223], v[148:151], v[176:191]
  ds_read_b64_tr_b16 v[44:45], v235 offset:0
  ds_read_b64_tr_b16 v[46:47], v235 offset:2048
  s_waitcnt lgkmcnt(9)
  v_mfma_f32_32x32x16_bf16 v[176:191], v[224:227], v[152:155], v[176:191]
  ds_read_b64_tr_b16 v[48:49], v232 offset:4096
  ds_read_b64_tr_b16 v[50:51], v232 offset:6144
  s_waitcnt lgkmcnt(10)
  v_mfma_f32_32x32x16_bf16 v[176:191], v[228:231], v[156:159], v[176:191]
  ds_read_b64_tr_b16 v[52:53], v233 offset:4096
  ds_read_b64_tr_b16 v[54:55], v233 offset:6144
  ds_read_b64_tr_b16 v[56:57], v234 offset:4096
  ds_read_b64_tr_b16 v[58:59], v234 offset:6144
  ds_read_b64_tr_b16 v[60:61], v235 offset:4096
  ds_read_b64_tr_b16 v[62:63], v235 offset:6144
  s_nop 5
  v_exp_f32 v16, v176
  v_exp_f32 v17, v177
  v_exp_f32 v18, v178
  v_exp_f32 v19, v179
  v_mov_b32 v13, v16
  v_mov_b32 v14, v17
  v_cvt_pk_bf16_f32 v192, v16, v17
  v_exp_f32 v16, v180
  v_exp_f32 v17, v181
  v_add_f32 v13, v13, v18
  v_add_f32 v14, v14, v19
  v_cvt_pk_bf16_f32 v193, v18, v19
  v_exp_f32 v18, v182
  v_exp_f32 v19, v183
  v_add_f32 v13, v13, v16
  v_add_f32 v14, v14, v17
  v_cvt_pk_bf16_f32 v194, v16, v17
  v_exp_f32 v16, v184
  v_exp_f32 v17, v185
  v_add_f32 v13, v13, v18
  v_add_f32 v14, v14, v19
  v_cvt_pk_bf16_f32 v195, v18, v19
  v_exp_f32 v18, v186
  v_exp_f32 v19, v187
  v_add_f32 v13, v13, v16
  v_add_f32 v14, v14, v17
  v_cvt_pk_bf16_f32 v196, v16, v17
  v_exp_f32 v16, v188
  v_exp_f32 v17, v189
  v_add_f32 v13, v13, v18
  v_add_f32 v14, v14, v19
  v_cvt_pk_bf16_f32 v197, v18, v19
  v_exp_f32 v18, v190
  v_exp_f32 v19, v191
  v_add_f32 v13, v13, v16
  v_add_f32 v14, v14, v17
  v_cvt_pk_bf16_f32 v198, v16, v17
  s_nop 0
  v_add_f32 v13, v13, v18
  v_add_f32 v14, v14, v19
  v_cvt_pk_bf16_f32 v199, v18, v19
  v_add_f32 v13, v13, v14
  v_cmp_nge_f32 vcc, s79, v13
  s_cbranch_vccnz ats_rare
ats_back:
  v_add_f32 v12, v12, v13
  s_nop 0
  s_waitcnt lgkmcnt(14)
  v_mfma_f32_32x32x16_bf16 v[64:79], v[32:35], v[192:195], v[64:79]
  s_waitcnt lgkmcnt(12)
  v_mfma_f32_32x32x16_bf16 v[80:95], v[36:39], v[192:195], v[80:95]
  s_waitcnt lgkmcnt(10)
  v_mfma_f32_32x32x16_bf16 v[96:111], v[40:43], v[192:195], v[96:111]
  s_waitcnt lgkmcnt(8)
  v_mfma_f32_32x32x16_bf16 v[112:127], v[44:47], v[192:195], v[112:127]
  s_waitcnt lgkmcnt(6)
  v_mfma_f32_32x32x16_bf16 v[64:79], v[48:51], v[196:199], v[64:79]
  s_waitcnt lgkmcnt(4)
  v_mfma_f32_32x32x16_bf16 v[80:95], v[52:55], v[196:199], v[80:95]
  s_waitcnt lgkmcnt(2)
  v_mfma_f32_32x32x16_bf16 v[96:111], v[56:59], v[196:199], v[96:111]
  s_waitcnt lgkmcnt(0)
  v_mfma_f32_32x32x16_bf16 v[112:127], v[60:63], v[196:199], v[112:127]
  s_add_u32 s73, s73, 32768
  s_cmp_eq_u32 s73, 98304
  s_cselect_b32 s73, 0, s73
  v_add_u32 v24, s73, v1
  v_xor_b32 v25, 32, v24
  v_xor_b32 v26, 64, v24
  v_xor_b32 v27, 96, v24
  v_xor_b32 v28, 128, v24
  v_xor_b32 v29, 160, v24
  v_xor_b32 v30, 192, v24
  v_xor_b32 v31, 224, v24
  v_add_u32 v232, s73, v2
  v_xor_b32 v233, 64, v232
  v_xor_b32 v234, 128, v232
  v_xor_b32 v235, 192, v232
  s_cmp_eq_u32 s74, 8
  s_cbranch_scc1 at_mid
at_midback:
  s_sub_u32 s74, s74, 1
  s_cmp_lg_u32 s74, 0
  s_cbranch_scc1 at_kvloop
  s_cmp_lg_u32 s75, 0
  s_cbranch_scc1 at_last
  s_lshl_b32 s9, s76, 13
  s_add_u32 s9, s9, 139264
  v_add_u32 v15, s9, v5
  ds_read_b128 v[128:131], v15 offset:0
  ds_read_b128 v[132:135], v15 offset:1024
  ds_read_b128 v[136:139], v15 offset:2048
  ds_read_b128 v[140:143], v15 offset:3072
  ds_read_b128 v[144:147], v15 offset:4096
  ds_read_b128 v[148:151], v15 offset:5120
  ds_read_b128 v[152:155], v15 offset:6144
  ds_read_b128 v[156:159], v15 offset:7168
  v_mov_b32 v16, v12
  v_mov_b32 v17, v12
  s_nop 1
  v_permlane32_swap_b32 v16, v17
  s_nop 1
  v_add_f32 v12, v16, v17
  v_rcp_f32 v16, v12
  v_mov_b32 v18, v160
  v_mov_b32 v19, v12
  v_mov_b32 v17, v16
  ds_write_b64 v9, v[18:19]
  v_pk_mul_f32 v[96:97], v[96:97], v[16:17]
  v_pk_mul_f32 v[98:99], v[98:99], v[16:17]
  v_pk_mul_f32 v[100:101], v[100:101], v[16:17]
  v_pk_mul_f32 v[102:103], v[102:103], v[16:17]
  v_cvt_pk_bf16_f32 v216, v96, v97
  v_cvt_pk_bf16_f32 v217, v98, v99
  v_cvt_pk_bf16_f32 v218, v100, v101
  v_cvt_pk_bf16_f32 v219, v102, v103
  ds_write_b128 v7, v[216:219] offset:0
  v_pk_mul_f32 v[104:105], v[104:105], v[16:17]
  v_pk_mul_f32 v[106:107], v[106:107], v[16:17]
  v_pk_mul_f32 v[108:109], v[108:109], v[16:17]
  v_pk_mul_f32 v[110:111], v[110:111], v[16:17]
  v_cvt_pk_bf16_f32 v220, v104, v105
  v_cvt_pk_bf16_f32 v221, v106, v107
  v_cvt_pk_bf16_f32 v222, v108, v109
  v_cvt_pk_bf16_f32 v223, v110, v111
  ds_write_b128 v7, v[220:223] offset:1024
  v_pk_mul_f32 v[112:113], v[112:113], v[16:17]
  v_pk_mul_f32 v[114:115], v[114:115], v[16:17]
  v_pk_mul_f32 v[116:117], v[116:117], v[16:17]
  v_pk_mul_f32 v[118:119], v[118:119], v[16:17]
  v_cvt_pk_bf16_f32 v224, v112, v113
  v_cvt_pk_bf16_f32 v225, v114, v115
  v_cvt_pk_bf16_f32 v226, v116, v117
  v_cvt_pk_bf16_f32 v227, v118, v119
  ds_write_b128 v7, v[224:227] offset:2048
  v_pk_mul_f32 v[120:121], v[120:121], v[16:17]
  v_pk_mul_f32 v[122:123], v[122:123], v[16:17]
  v_pk_mul_f32 v[124:125], v[124:125], v[16:17]
  v_pk_mul_f32 v[126:127], v[126:127], v[16:17]
  v_cvt_pk_bf16_f32 v228, v120, v121
  v_cvt_pk_bf16_f32 v229, v122, v123
  v_cvt_pk_bf16_f32 v230, v124, v125
  v_cvt_pk_bf16_f32 v231, v126, v127
  ds_write_b128 v7, v[228:231] offset:3072
  s_waitcnt lgkmcnt(0)
  s_barrier
  ds_read_b64 v[16:17], v10
  ds_read_b128 v[200:203], v8 offset:0
  ds_read_b128 v[204:207], v8 offset:1024
  ds_read_b128 v[208:211], v8 offset:2048
  ds_read_b128 v[212:215], v8 offset:3072
  s_waitcnt lgkmcnt(4)
  v_min_f32 v18, v16, v160
  v_sub_f32 v19, v18, v160
  v_sub_f32 v20, v18, v16
  v_exp_f32 v19, v19
  v_exp_f32 v20, v20
  s_nop 0
  v_mul_f32 v20, v20, v17
  v_fma_f32 v21, v12, v19, v20
  v_rcp_f32 v21, v21
  s_nop 0
  v_mul_f32 v16, v19, v21
  v_mul_f32 v18, v20, v21
  v_mov_b32 v17, v16
  v_mov_b32 v19, v18
  s_waitcnt lgkmcnt(3)
  v_lshlrev_b32 v20, 16, v200
  v_and_b32 v21, 0xffff0000, v200
  v_pk_mul_f32 v[64:65], v[64:65], v[16:17]
  v_pk_fma_f32 v[64:65], v[20:21], v[18:19], v[64:65]
  v_cvt_pk_bf16_f32 v236, v64, v65
  v_lshlrev_b32 v22, 16, v201
  v_and_b32 v23, 0xffff0000, v201
  v_pk_mul_f32 v[66:67], v[66:67], v[16:17]
  v_pk_fma_f32 v[66:67], v[22:23], v[18:19], v[66:67]
  v_cvt_pk_bf16_f32 v237, v66, v67
  v_lshlrev_b32 v20, 16, v202
  v_and_b32 v21, 0xffff0000, v202
  v_pk_mul_f32 v[68:69], v[68:69], v[16:17]
  v_pk_fma_f32 v[68:69], v[20:21], v[18:19], v[68:69]
  v_cvt_pk_bf16_f32 v238, v68, v69
  v_lshlrev_b32 v22, 16, v203
  v_and_b32 v23, 0xffff0000, v203
  v_pk_mul_f32 v[70:71], v[70:71], v[16:17]
  v_pk_fma_f32 v[70:71], v[22:23], v[18:19], v[70:71]
  v_cvt_pk_bf16_f32 v239, v70, v71
  s_waitcnt lgkmcnt(2)
  v_lshlrev_b32 v20, 16, v204
  v_and_b32 v21, 0xffff0000, v204
  v_pk_mul_f32 v[72:73], v[72:73], v[16:17]
  v_pk_fma_f32 v[72:73], v[20:21], v[18:19], v[72:73]
  v_cvt_pk_bf16_f32 v240, v72, v73
  v_lshlrev_b32 v22, 16, v205
  v_and_b32 v23, 0xffff0000, v205
  v_pk_mul_f32 v[74:75], v[74:75], v[16:17]
  v_pk_fma_f32 v[74:75], v[22:23], v[18:19], v[74:75]
  v_cvt_pk_bf16_f32 v241, v74, v75
  v_lshlrev_b32 v20, 16, v206
  v_and_b32 v21, 0xffff0000, v206
  v_pk_mul_f32 v[76:77], v[76:77], v[16:17]
  v_pk_fma_f32 v[76:77], v[20:21], v[18:19], v[76:77]
  v_cvt_pk_bf16_f32 v242, v76, v77
  v_lshlrev_b32 v22, 16, v207
  v_and_b32 v23, 0xffff0000, v207
  v_pk_mul_f32 v[78:79], v[78:79], v[16:17]
  v_pk_fma_f32 v[78:79], v[22:23], v[18:19], v[78:79]
  v_cvt_pk_bf16_f32 v243, v78, v79
  s_waitcnt lgkmcnt(1)
  v_lshlrev_b32 v20, 16, v208
  v_and_b32 v21, 0xffff0000, v208
  v_pk_mul_f32 v[80:81], v[80:81], v[16:17]
  v_pk_fma_f32 v[80:81], v[20:21], v[18:19], v[80:81]
  v_cvt_pk_bf16_f32 v244, v80, v81
  v_lshlrev_b32 v22, 16, v209
  v_and_b32 v23, 0xffff0000, v209
  v_pk_mul_f32 v[82:83], v[82:83], v[16:17]
  v_pk_fma_f32 v[82:83], v[22:23], v[18:19], v[82:83]
  v_cvt_pk_bf16_f32 v245, v82, v83
  v_lshlrev_b32 v20, 16, v210
  v_and_b32 v21, 0xffff0000, v210
  v_pk_mul_f32 v[84:85], v[84:85], v[16:17]
  v_pk_fma_f32 v[84:85], v[20:21], v[18:19], v[84:85]
  v_cvt_pk_bf16_f32 v246, v84, v85
  v_lshlrev_b32 v22, 16, v211
  v_and_b32 v23, 0xffff0000, v211
  v_pk_mul_f32 v[86:87], v[86:87], v[16:17]
  v_pk_fma_f32 v[86:87], v[22:23], v[18:19], v[86:87]
  v_cvt_pk_bf16_f32 v247, v86, v87
  s_waitcnt lgkmcnt(0)
  v_lshlrev_b32 v20, 16, v212
  v_and_b32 v21, 0xffff0000, v212
  v_pk_mul_f32 v[88:89], v[88:89], v[16:17]
  v_pk_fma_f32 v[88:89], v[20:21], v[18:19], v[88:89]
  v_cvt_pk_bf16_f32 v248, v88, v89
  v_lshlrev_b32 v22, 16, v213
  v_and_b32 v23, 0xffff0000, v213
  v_pk_mul_f32 v[90:91], v[90:91], v[16:17]
  v_pk_fma_f32 v[90:91], v[22:23], v[18:19], v[90:91]
  v_cvt_pk_bf16_f32 v249, v90, v91
  v_lshlrev_b32 v20, 16, v214
  v_and_b32 v21, 0xffff0000, v214
  v_pk_mul_f32 v[92:93], v[92:93], v[16:17]
  v_pk_fma_f32 v[92:93], v[20:21], v[18:19], v[92:93]
  v_cvt_pk_bf16_f32 v250, v92, v93
  v_lshlrev_b32 v22, 16, v215
  v_and_b32 v23, 0xffff0000, v215
  v_pk_mul_f32 v[94:95], v[94:95], v[16:17]
  v_pk_fma_f32 v[94:95], v[22:23], v[18:19], v[94:95]
  v_cvt_pk_bf16_f32 v251, v94, v95
  s_mov_b32 s75, 1
  s_add_u32 s11, s4, 3
  s_cmp_ge_u32 s11, 6
  s_cselect_b32 s10, 6, 0
  s_sub_u32 s11, s11, s10
  s_lshl_b32 s9, s4, 12
  s_add_u32 s9, s9, 0
  v_add_u32 v7, s9, v5
  s_lshl_b32 s9, s4, 9
  s_add_u32 s9, s9, 24576
  v_lshrrev_b32 v9, 1, v5
  v_add_u32 v9, s9, v9
  s_lshl_b32 s9, s11, 12
  s_add_u32 s9, s9, 0
  v_add_u32 v8, s9, v5
  s_lshl_b32 s9, s11, 9
  s_add_u32 s9, s9, 24576
  v_lshrrev_b32 v10, 1, v5
  v_add_u32 v10, s9, v10
  s_branch at_round
at_last:
  s_mul_i32 s98, s100, 24576
  s_add_u32 s98, s98, s93
  v_mov_b32 v16, v12
  v_mov_b32 v17, v12
  s_nop 1
  v_permlane32_swap_b32 v16, v17
  s_nop 1
  v_add_f32 v12, v16, v17
  v_rcp_f32 v16, v12
  v_mov_b32 v18, v160
  v_mov_b32 v19, v12
  v_mov_b32 v17, v16
  ds_write_b64 v9, v[18:19]
  v_pk_mul_f32 v[96:97], v[96:97], v[16:17]
  v_pk_mul_f32 v[98:99], v[98:99], v[16:17]
  v_pk_mul_f32 v[100:101], v[100:101], v[16:17]
  v_pk_mul_f32 v[102:103], v[102:103], v[16:17]
  v_cvt_pk_bf16_f32 v216, v96, v97
  v_cvt_pk_bf16_f32 v217, v98, v99
  v_cvt_pk_bf16_f32 v218, v100, v101
  v_cvt_pk_bf16_f32 v219, v102, v103
  ds_write_b128 v7, v[216:219] offset:0
  v_pk_mul_f32 v[104:105], v[104:105], v[16:17]
  v_pk_mul_f32 v[106:107], v[106:107], v[16:17]
  v_pk_mul_f32 v[108:109], v[108:109], v[16:17]
  v_pk_mul_f32 v[110:111], v[110:111], v[16:17]
  v_cvt_pk_bf16_f32 v220, v104, v105
  v_cvt_pk_bf16_f32 v221, v106, v107
  v_cvt_pk_bf16_f32 v222, v108, v109
  v_cvt_pk_bf16_f32 v223, v110, v111
  ds_write_b128 v7, v[220:223] offset:1024
  v_pk_mul_f32 v[112:113], v[112:113], v[16:17]
  v_pk_mul_f32 v[114:115], v[114:115], v[16:17]
  v_pk_mul_f32 v[116:117], v[116:117], v[16:17]
  v_pk_mul_f32 v[118:119], v[118:119], v[16:17]
  v_cvt_pk_bf16_f32 v224, v112, v113
  v_cvt_pk_bf16_f32 v225, v114, v115
  v_cvt_pk_bf16_f32 v226, v116, v117
  v_cvt_pk_bf16_f32 v227, v118, v119
  ds_write_b128 v7, v[224:227] offset:2048
  v_pk_mul_f32 v[120:121], v[120:121], v[16:17]
  v_pk_mul_f32 v[122:123], v[122:123], v[16:17]
  v_pk_mul_f32 v[124:125], v[124:125], v[16:17]
  v_pk_mul_f32 v[126:127], v[126:127], v[16:17]
  v_cvt_pk_bf16_f32 v228, v120, v121
  v_cvt_pk_bf16_f32 v229, v122, v123
  v_cvt_pk_bf16_f32 v230, v124, v125
  v_cvt_pk_bf16_f32 v231, v126, v127
  ds_write_b128 v7, v[228:231] offset:3072
  s_add_u32 s12, s8, s86
  s_and_b32 s12, s12, 3
  s_mul_i32 s11, s12, 24576
  s_add_u32 s11, s11, s42
  buffer_load_dwordx4 v[24:27], v3, s[60:63], s11 offen offset:0 sc1
  buffer_load_dwordx4 v[28:31], v4, s[60:63], s11 offen offset:0 sc1
  buffer_load_dwordx4 v[32:35], v6, s[60:63], s11 offen offset:0 sc1
  buffer_load_dwordx4 v[36:39], v3, s[60:63], s11 offen offset:2048 sc1
  buffer_load_dwordx4 v[40:43], v4, s[60:63], s11 offen offset:2048 sc1
  buffer_load_dwordx4 v[44:47], v6, s[60:63], s11 offen offset:2048 sc1
  s_add_u32 s11, s11, 4096
  buffer_load_dwordx4 v[48:51], v3, s[60:63], s11 offen offset:0 sc1
  buffer_load_dwordx4 v[52:55], v4, s[60:63], s11 offen offset:0 sc1
  buffer_load_dwordx4 v[56:59], v6, s[60:63], s11 offen offset:0 sc1
  buffer_load_dwordx4 v[60:63], v3, s[60:63], s11 offen offset:2048 sc1
  buffer_load_dwordx4 v[172:175], v4, s[60:63], s11 offen offset:2048 sc1
  buffer_load_dwordx4 v[176:179], v6, s[60:63], s11 offen offset:2048 sc1
  v_and_b32 v1, 3, v0
  v_lshrrev_b32 v2, 1, v1
  v_add_u32 v1, v1, v2
  v_add_u32 v1, s87, v1
  v_lshlrev_b32 v1, 7, v1
  s_add_u32 s9, s8, s86
  s_add_u32 s9, s9, 1
  s_and_b32 s9, s9, 3
  s_lshl_b32 s9, s9, 14
  v_add_u32 v1, s9, v1
  s_and_b32 s9, s13, 0xe7
  s_lshl_b32 s9, s9, 11
  s_add_u32 s9, s9, 20447360
  v_add_u32 v1, s9, v1
  v_mov_b32 v2, 1
  s_waitcnt lgkmcnt(0)
  s_barrier
  ds_read_b64 v[16:17], v10
  ds_read_b128 v[200:203], v8 offset:0
  ds_read_b128 v[204:207], v8 offset:1024
  ds_read_b128 v[208:211], v8 offset:2048
  ds_read_b128 v[212:215], v8 offset:3072
  s_waitcnt lgkmcnt(4)
  v_min_f32 v18, v16, v160
  v_sub_f32 v19, v18, v160
  v_sub_f32 v20, v18, v16
  v_exp_f32 v19, v19
  v_exp_f32 v20, v20
  s_nop 0
  v_mul_f32 v20, v20, v17
  v_fma_f32 v21, v12, v19, v20
  v_rcp_f32 v21, v21
  s_nop 0
  v_mul_f32 v16, v19, v21
  v_mul_f32 v18, v20, v21
  v_mov_b32 v17, v16
  v_mov_b32 v19, v18
  s_waitcnt lgkmcnt(3)
  v_lshlrev_b32 v20, 16, v200
  v_and_b32 v21, 0xffff0000, v200
  v_pk_mul_f32 v[64:65], v[64:65], v[16:17]
  v_pk_fma_f32 v[64:65], v[20:21], v[18:19], v[64:65]
  v_cvt_pk_bf16_f32 v236, v64, v65
  v_lshlrev_b32 v22, 16, v201
  v_and_b32 v23, 0xffff0000, v201
  v_pk_mul_f32 v[66:67], v[66:67], v[16:17]
  v_pk_fma_f32 v[66:67], v[22:23], v[18:19], v[66:67]
  v_cvt_pk_bf16_f32 v237, v66, v67
  v_lshlrev_b32 v20, 16, v202
  v_and_b32 v21, 0xffff0000, v202
  v_pk_mul_f32 v[68:69], v[68:69], v[16:17]
  v_pk_fma_f32 v[68:69], v[20:21], v[18:19], v[68:69]
  v_cvt_pk_bf16_f32 v238, v68, v69
  v_lshlrev_b32 v22, 16, v203
  v_and_b32 v23, 0xffff0000, v203
  v_pk_mul_f32 v[70:71], v[70:71], v[16:17]
  v_pk_fma_f32 v[70:71], v[22:23], v[18:19], v[70:71]
  v_cvt_pk_bf16_f32 v239, v70, v71
  buffer_store_dwordx4 v[236:239], v11, s[60:63], s98 offen offset:0 sc1
  s_waitcnt lgkmcnt(2)
  v_lshlrev_b32 v20, 16, v204
  v_and_b32 v21, 0xffff0000, v204
  v_pk_mul_f32 v[72:73], v[72:73], v[16:17]
  v_pk_fma_f32 v[72:73], v[20:21], v[18:19], v[72:73]
  v_cvt_pk_bf16_f32 v240, v72, v73
  v_lshlrev_b32 v22, 16, v205
  v_and_b32 v23, 0xffff0000, v205
  v_pk_mul_f32 v[74:75], v[74:75], v[16:17]
  v_pk_fma_f32 v[74:75], v[22:23], v[18:19], v[74:75]
  v_cvt_pk_bf16_f32 v241, v74, v75
  v_lshlrev_b32 v20, 16, v206
  v_and_b32 v21, 0xffff0000, v206
  v_pk_mul_f32 v[76:77], v[76:77], v[16:17]
  v_pk_fma_f32 v[76:77], v[20:21], v[18:19], v[76:77]
  v_cvt_pk_bf16_f32 v242, v76, v77
  v_lshlrev_b32 v22, 16, v207
  v_and_b32 v23, 0xffff0000, v207
  v_pk_mul_f32 v[78:79], v[78:79], v[16:17]
  v_pk_fma_f32 v[78:79], v[22:23], v[18:19], v[78:79]
  v_cvt_pk_bf16_f32 v243, v78, v79
  buffer_store_dwordx4 v[240:243], v11, s[60:63], s98 offen offset:1024 sc1
  s_waitcnt lgkmcnt(1)
  v_lshlrev_b32 v20, 16, v208
  v_and_b32 v21, 0xffff0000, v208
  v_pk_mul_f32 v[80:81], v[80:81], v[16:17]
  v_pk_fma_f32 v[80:81], v[20:21], v[18:19], v[80:81]
  v_cvt_pk_bf16_f32 v244, v80, v81
  v_lshlrev_b32 v22, 16, v209
  v_and_b32 v23, 0xffff0000, v209
  v_pk_mul_f32 v[82:83], v[82:83], v[16:17]
  v_pk_fma_f32 v[82:83], v[22:23], v[18:19], v[82:83]
  v_cvt_pk_bf16_f32 v245, v82, v83
  v_lshlrev_b32 v20, 16, v210
  v_and_b32 v21, 0xffff0000, v210
  v_pk_mul_f32 v[84:85], v[84:85], v[16:17]
  v_pk_fma_f32 v[84:85], v[20:21], v[18:19], v[84:85]
  v_cvt_pk_bf16_f32 v246, v84, v85
  v_lshlrev_b32 v22, 16, v211
  v_and_b32 v23, 0xffff0000, v211
  v_pk_mul_f32 v[86:87], v[86:87], v[16:17]
  v_pk_fma_f32 v[86:87], v[22:23], v[18:19], v[86:87]
  v_cvt_pk_bf16_f32 v247, v86, v87
  buffer_store_dwordx4 v[244:247], v11, s[60:63], s98 offen offset:2048 sc1
  s_waitcnt lgkmcnt(0)
  v_lshlrev_b32 v20, 16, v212
  v_and_b32 v21, 0xffff0000, v212
  v_pk_mul_f32 v[88:89], v[88:89], v[16:17]
  v_pk_fma_f32 v[88:89], v[20:21], v[18:19], v[88:89]
  v_cvt_pk_bf16_f32 v248, v88, v89
  v_lshlrev_b32 v22, 16, v213
  v_and_b32 v23, 0xffff0000, v213
  v_pk_mul_f32 v[90:91], v[90:91], v[16:17]
  v_pk_fma_f32 v[90:91], v[22:23], v[18:19], v[90:91]
  v_cvt_pk_bf16_f32 v249, v90, v91
  v_lshlrev_b32 v20, 16, v214
  v_and_b32 v21, 0xffff0000, v214
  v_pk_mul_f32 v[92:93], v[92:93], v[16:17]
  v_pk_fma_f32 v[92:93], v[20:21], v[18:19], v[92:93]
  v_cvt_pk_bf16_f32 v250, v92, v93
  v_lshlrev_b32 v22, 16, v215
  v_and_b32 v23, 0xffff0000, v215
  v_pk_mul_f32 v[94:95], v[94:95], v[16:17]
  v_pk_fma_f32 v[94:95], v[22:23], v[18:19], v[94:95]
  v_cvt_pk_bf16_f32 v251, v94, v95
  buffer_store_dwordx4 v[248:251], v11, s[60:63], s98 offen offset:3072 sc1
  s_mul_i32 s9, s87, 3
  s_add_u32 s10, s86, 1
  s_cmp_ge_u32 s10, 3
  s_cselect_b32 s12, 3, 0
  s_sub_u32 s10, s10, s12
  s_add_u32 s10, s10, s9
  s_lshl_b32 s10, s10, 1
  s_mul_i32 s11, s10, 5120
  s_cmp_ge_u32 s10, 10
  s_cselect_b32 s12, 4294892544, 0
  s_add_u32 s11, s11, s12
  s_add_u32 s11, s11, 98304
  v_add_u32 v8, s11, v5
  s_add_u32 s10, s86, 2
  s_cmp_ge_u32 s10, 3
  s_cselect_b32 s12, 3, 0
  s_sub_u32 s10, s10, s12
  s_add_u32 s10, s10, s9
  s_lshl_b32 s10, s10, 1
  s_add_u32 s10, s10, 1
  s_mul_i32 s11, s10, 5120
  s_cmp_ge_u32 s10, 10
  s_cselect_b32 s12, 4294892544, 0
  s_add_u32 s11, s11, s12
  s_add_u32 s11, s11, 98304
  v_add_u32 v9, s11, v5
  s_add_u32 s9, s9, s86
  s_mov_b32 s84, s9
  s_lshl_b32 s10, s9, 1
  s_mul_i32 s11, s10, 5120
  s_cmp_ge_u32 s10, 10
  s_cselect_b32 s12, 4294892544, 0
  s_add_u32 s11, s11, s12
  s_add_u32 s11, s11, 98304
  v_add_u32 v7, s11, v5
  s_mul_i32 s10, s9, 5120
  s_mul_i32 s9, s13, 30720
  s_add_u32 s9, s9, s10
  s_add_u32 s85, s9, 12582912
  s_cmp_eq_u32 s86, 1
  s_cbranch_scc1 at_r1
  s_cmp_eq_u32 s86, 2
  s_cbranch_scc1 at_r2
  s_add_u32 s12, s8, 3
  s_and_b32 s12, s12, 3
  s_mul_i32 s11, s12, 24576
  s_add_u32 s11, s11, s42
  buffer_load_dwordx4 v[180:183], v3, s[60:63], s11 offen offset:0 sc1
  buffer_load_dwordx4 v[184:187], v4, s[60:63], s11 offen offset:0 sc1
  buffer_load_dwordx4 v[188:191], v6, s[60:63], s11 offen offset:0 sc1
  buffer_load_dwordx4 v[192:195], v3, s[60:63], s11 offen offset:2048 sc1
  buffer_load_dwordx4 v[196:199], v4, s[60:63], s11 offen offset:2048 sc1
  buffer_load_dwordx4 v[200:203], v6, s[60:63], s11 offen offset:2048 sc1
  s_add_u32 s11, s11, 4096
  buffer_load_dwordx4 v[204:207], v3, s[60:63], s11 offen offset:0 sc1
  buffer_load_dwordx4 v[208:211], v4, s[60:63], s11 offen offset:0 sc1
  buffer_load_dwordx4 v[212:215], v6, s[60:63], s11 offen offset:0 sc1
  buffer_load_dwordx4 v[216:219], v3, s[60:63], s11 offen offset:2048 sc1
  buffer_load_dwordx4 v[220:223], v4, s[60:63], s11 offen offset:2048 sc1
  buffer_load_dwordx4 v[224:227], v6, s[60:63], s11 offen offset:2048 sc1
  ds_read_b64_tr_b16 v[12:13], v253 offset:32768
  ds_read_b64_tr_b16 v[14:15], v253 offset:35072
  ds_read_b64_tr_b16 v[16:17], v253 offset:32800
  ds_read_b64_tr_b16 v[18:19], v253 offset:35104
  ds_read_b64_tr_b16 v[20:21], v253 offset:32832
  ds_read_b64_tr_b16 v[22:23], v253 offset:35136
  ds_read_b64_tr_b16 v[228:229], v253 offset:32864
  ds_read_b64_tr_b16 v[230:231], v253 offset:35168
  s_waitcnt vmcnt(25)
  s_waitcnt lgkmcnt(6)
  v_mfma_f32_16x16x32_bf16 v[64:67], v[12:15], v[24:27], 0
  ds_read_b64_tr_b16 v[232:233], v253 offset:32896
  v_mfma_f32_16x16x32_bf16 v[100:103], v[12:15], v[28:31], 0
  ds_read_b64_tr_b16 v[234:235], v253 offset:35200
  v_mfma_f32_16x16x32_bf16 v[136:139], v[12:15], v[32:35], 0
  s_waitcnt lgkmcnt(6)
  v_mfma_f32_16x16x32_bf16 v[68:71], v[16:19], v[24:27], 0
  ds_read_b64_tr_b16 v[12:13], v253 offset:32928
  v_mfma_f32_16x16x32_bf16 v[104:107], v[16:19], v[28:31], 0
  ds_read_b64_tr_b16 v[14:15], v253 offset:35232
  v_mfma_f32_16x16x32_bf16 v[140:143], v[16:19], v[32:35], 0
  s_waitcnt lgkmcnt(6)
  v_mfma_f32_16x16x32_bf16 v[72:75], v[20:23], v[24:27], 0
  ds_read_b64_tr_b16 v[16:17], v253 offset:32960
  v_mfma_f32_16x16x32_bf16 v[108:111], v[20:23], v[28:31], 0
  ds_read_b64_tr_b16 v[18:19], v253 offset:35264
  v_mfma_f32_16x16x32_bf16 v[144:147], v[20:23], v[32:35], 0
  s_waitcnt lgkmcnt(6)
  v_mfma_f32_16x16x32_bf16 v[76:79], v[228:231], v[24:27], 0
  ds_read_b64_tr_b16 v[20:21], v253 offset:32992
  v_mfma_f32_16x16x32_bf16 v[112:115], v[228:231], v[28:31], 0
  ds_read_b64_tr_b16 v[22:23], v253 offset:35296
  v_mfma_f32_16x16x32_bf16 v[148:151], v[228:231], v[32:35], 0
  s_waitcnt lgkmcnt(6)
  v_mfma_f32_16x16x32_bf16 v[80:83], v[232:235], v[24:27], 0
  ds_read_b64_tr_b16 v[228:229], v253 offset:33024
  v_mfma_f32_16x16x32_bf16 v[116:119], v[232:235], v[28:31], 0
  ds_read_b64_tr_b16 v[230:231], v253 offset:35328
  v_mfma_f32_16x16x32_bf16 v[152:155], v[232:235], v[32:35], 0
  s_waitcnt lgkmcnt(6)
  v_mfma_f32_16x16x32_bf16 v[84:87], v[12:15], v[24:27], 0
  ds_read_b64_tr_b16 v[232:233], v253 offset:41984
  v_mfma_f32_16x16x32_bf16 v[120:123], v[12:15], v[28:31], 0
  ds_read_b64_tr_b16 v[234:235], v253 offset:44288
  v_mfma_f32_16x16x32_bf16 v[156:159], v[12:15], v[32:35], 0
  s_waitcnt lgkmcnt(6)
  v_mfma_f32_16x16x32_bf16 v[88:91], v[16:19], v[24:27], 0
  ds_read_b64_tr_b16 v[12:13], v253 offset:42016
  v_mfma_f32_16x16x32_bf16 v[124:127], v[16:19], v[28:31], 0
  ds_read_b64_tr_b16 v[14:15], v253 offset:44320
  v_mfma_f32_16x16x32_bf16 v[160:163], v[16:19], v[32:35], 0
  s_waitcnt lgkmcnt(6)
  v_mfma_f32_16x16x32_bf16 v[92:95], v[20:23], v[24:27], 0
  ds_read_b64_tr_b16 v[16:17], v253 offset:42048
  v_mfma_f32_16x16x32_bf16 v[128:131], v[20:23], v[28:31], 0
  ds_read_b64_tr_b16 v[18:19], v253 offset:44352
  v_mfma_f32_16x16x32_bf16 v[164:167], v[20:23], v[32:35], 0
  s_waitcnt lgkmcnt(6)
  v_mfma_f32_16x16x32_bf16 v[96:99], v[228:231], v[24:27], 0
  ds_read_b64_tr_b16 v[20:21], v253 offset:42080
  v_mfma_f32_16x16x32_bf16 v[132:135], v[228:231], v[28:31], 0
  ds_read_b64_tr_b16 v[22:23], v253 offset:44384
  v_mfma_f32_16x16x32_bf16 v[168:171], v[228:231], v[32:35], 0
  s_waitcnt vmcnt(22)
  s_waitcnt lgkmcnt(6)
  v_mfma_f32_16x16x32_bf16 v[64:67], v[232:235], v[36:39], v[64:67]
  ds_read_b64_tr_b16 v[228:229], v253 offset:42112
  v_mfma_f32_16x16x32_bf16 v[100:103], v[232:235], v[40:43], v[100:103]
  ds_read_b64_tr_b16 v[230:231], v253 offset:44416
  v_mfma_f32_16x16x32_bf16 v[136:139], v[232:235], v[44:47], v[136:139]
  s_waitcnt lgkmcnt(6)
  v_mfma_f32_16x16x32_bf16 v[68:71], v[12:15], v[36:39], v[68:71]
  ds_read_b64_tr_b16 v[232:233], v253 offset:42144
  v_mfma_f32_16x16x32_bf16 v[104:107], v[12:15], v[40:43], v[104:107]
  ds_read_b64_tr_b16 v[234:235], v253 offset:44448
  v_mfma_f32_16x16x32_bf16 v[140:143], v[12:15], v[44:47], v[140:143]
  s_waitcnt lgkmcnt(6)
  v_mfma_f32_16x16x32_bf16 v[72:75], v[16:19], v[36:39], v[72:75]
  ds_read_b64_tr_b16 v[12:13], v253 offset:42176
  v_mfma_f32_16x16x32_bf16 v[108:111], v[16:19], v[40:43], v[108:111]
  ds_read_b64_tr_b16 v[14:15], v253 offset:44480
  v_mfma_f32_16x16x32_bf16 v[144:147], v[16:19], v[44:47], v[144:147]
  s_waitcnt lgkmcnt(6)
  v_mfma_f32_16x16x32_bf16 v[76:79], v[20:23], v[36:39], v[76:79]
  ds_read_b64_tr_b16 v[16:17], v253 offset:42208
  v_mfma_f32_16x16x32_bf16 v[112:115], v[20:23], v[40:43], v[112:115]
  ds_read_b64_tr_b16 v[18:19], v253 offset:44512
  v_mfma_f32_16x16x32_bf16 v[148:151], v[20:23], v[44:47], v[148:151]
  s_waitcnt lgkmcnt(6)
  v_mfma_f32_16x16x32_bf16 v[80:83], v[228:231], v[36:39], v[80:83]
  ds_read_b64_tr_b16 v[20:21], v253 offset:42240
  v_mfma_f32_16x16x32_bf16 v[116:119], v[228:231], v[40:43], v[116:119]
  ds_read_b64_tr_b16 v[22:23], v253 offset:44544
  v_mfma_f32_16x16x32_bf16 v[152:155], v[228:231], v[44:47], v[152:155]
  s_waitcnt lgkmcnt(6)
  v_mfma_f32_16x16x32_bf16 v[84:87], v[232:235], v[36:39], v[84:87]
  ds_read_b64_tr_b16 v[228:229], v253 offset:51200
  v_mfma_f32_16x16x32_bf16 v[120:123], v[232:235], v[40:43], v[120:123]
  ds_read_b64_tr_b16 v[230:231], v253 offset:53504
  v_mfma_f32_16x16x32_bf16 v[156:159], v[232:235], v[44:47], v[156:159]
  s_waitcnt lgkmcnt(6)
  v_mfma_f32_16x16x32_bf16 v[88:91], v[12:15], v[36:39], v[88:91]
  ds_read_b64_tr_b16 v[232:233], v253 offset:51232
  v_mfma_f32_16x16x32_bf16 v[124:127], v[12:15], v[40:43], v[124:127]
  ds_read_b64_tr_b16 v[234:235], v253 offset:53536
  v_mfma_f32_16x16x32_bf16 v[160:163], v[12:15], v[44:47], v[160:163]
  s_waitcnt lgkmcnt(6)
  v_mfma_f32_16x16x32_bf16 v[92:95], v[16:19], v[36:39], v[92:95]
  ds_read_b64_tr_b16 v[12:13], v253 offset:51264
  v_mfma_f32_16x16x32_bf16 v[128:131], v[16:19], v[40:43], v[128:131]
  ds_read_b64_tr_b16 v[14:15], v253 offset:53568
  v_mfma_f32_16x16x32_bf16 v[164:167], v[16:19], v[44:47], v[164:167]
  s_waitcnt lgkmcnt(6)
  v_mfma_f32_16x16x32_bf16 v[96:99], v[20:23], v[36:39], v[96:99]
  ds_read_b64_tr_b16 v[16:17], v253 offset:51296
  v_mfma_f32_16x16x32_bf16 v[132:135], v[20:23], v[40:43], v[132:135]
  ds_read_b64_tr_b16 v[18:19], v253 offset:53600
  v_mfma_f32_16x16x32_bf16 v[168:171], v[20:23], v[44:47], v[168:171]
  s_barrier
  s_waitcnt vmcnt(19)
  s_waitcnt lgkmcnt(6)
  v_mfma_f32_16x16x32_bf16 v[64:67], v[228:231], v[48:51], v[64:67]
  ds_read_b64_tr_b16 v[20:21], v253 offset:51328
  v_mfma_f32_16x16x32_bf16 v[100:103], v[228:231], v[52:55], v[100:103]
  ds_read_b64_tr_b16 v[22:23], v253 offset:53632
  v_mfma_f32_16x16x32_bf16 v[136:139], v[228:231], v[56:59], v[136:139]
  s_waitcnt lgkmcnt(6)
  v_mfma_f32_16x16x32_bf16 v[68:71], v[232:235], v[48:51], v[68:71]
  ds_read_b64_tr_b16 v[228:229], v253 offset:51360
  v_mfma_f32_16x16x32_bf16 v[104:107], v[232:235], v[52:55], v[104:107]
  ds_read_b64_tr_b16 v[230:231], v253 offset:53664
  v_mfma_f32_16x16x32_bf16 v[140:143], v[232:235], v[56:59], v[140:143]
  s_waitcnt lgkmcnt(6)
  v_mfma_f32_16x16x32_bf16 v[72:75], v[12:15], v[48:51], v[72:75]
  ds_read_b64_tr_b16 v[232:233], v253 offset:51392
  v_mfma_f32_16x16x32_bf16 v[108:111], v[12:15], v[52:55], v[108:111]
  ds_read_b64_tr_b16 v[234:235], v253 offset:53696
  v_mfma_f32_16x16x32_bf16 v[144:147], v[12:15], v[56:59], v[144:147]
  s_waitcnt lgkmcnt(6)
  v_mfma_f32_16x16x32_bf16 v[76:79], v[16:19], v[48:51], v[76:79]
  ds_read_b64_tr_b16 v[12:13], v253 offset:51424
  v_mfma_f32_16x16x32_bf16 v[112:115], v[16:19], v[52:55], v[112:115]
  ds_read_b64_tr_b16 v[14:15], v253 offset:53728
  v_mfma_f32_16x16x32_bf16 v[148:151], v[16:19], v[56:59], v[148:151]
  s_waitcnt lgkmcnt(6)
  v_mfma_f32_16x16x32_bf16 v[80:83], v[20:23], v[48:51], v[80:83]
  ds_read_b64_tr_b16 v[16:17], v253 offset:51456
  v_mfma_f32_16x16x32_bf16 v[116:119], v[20:23], v[52:55], v[116:119]
  ds_read_b64_tr_b16 v[18:19], v253 offset:53760
  v_mfma_f32_16x16x32_bf16 v[152:155], v[20:23], v[56:59], v[152:155]
  s_waitcnt lgkmcnt(6)
  v_mfma_f32_16x16x32_bf16 v[84:87], v[228:231], v[48:51], v[84:87]
  ds_read_b64_tr_b16 v[20:21], v254 offset:4096
  v_mfma_f32_16x16x32_bf16 v[120:123], v[228:231], v[52:55], v[120:123]
  ds_read_b64_tr_b16 v[22:23], v254 offset:6400
  v_mfma_f32_16x16x32_bf16 v[156:159], v[228:231], v[56:59], v[156:159]
  s_waitcnt lgkmcnt(6)
  v_mfma_f32_16x16x32_bf16 v[88:91], v[232:235], v[48:51], v[88:91]
  ds_read_b64_tr_b16 v[228:229], v254 offset:4128
  v_mfma_f32_16x16x32_bf16 v[124:127], v[232:235], v[52:55], v[124:127]
  ds_read_b64_tr_b16 v[230:231], v254 offset:6432
  v_mfma_f32_16x16x32_bf16 v[160:163], v[232:235], v[56:59], v[160:163]
  s_waitcnt lgkmcnt(6)
  v_mfma_f32_16x16x32_bf16 v[92:95], v[12:15], v[48:51], v[92:95]
  ds_read_b64_tr_b16 v[232:233], v254 offset:4160
  v_mfma_f32_16x16x32_bf16 v[128:131], v[12:15], v[52:55], v[128:131]
  ds_read_b64_tr_b16 v[234:235], v254 offset:6464
  v_mfma_f32_16x16x32_bf16 v[164:167], v[12:15], v[56:59], v[164:167]
  s_waitcnt lgkmcnt(6)
  v_mfma_f32_16x16x32_bf16 v[96:99], v[16:19], v[48:51], v[96:99]
  ds_read_b64_tr_b16 v[12:13], v254 offset:4192
  v_mfma_f32_16x16x32_bf16 v[132:135], v[16:19], v[52:55], v[132:135]
  ds_read_b64_tr_b16 v[14:15], v254 offset:6496
  v_mfma_f32_16x16x32_bf16 v[168:171], v[16:19], v[56:59], v[168:171]
  s_waitcnt vmcnt(16)
  s_waitcnt lgkmcnt(6)
  v_mfma_f32_16x16x32_bf16 v[64:67], v[20:23], v[60:63], v[64:67]
  ds_read_b64_tr_b16 v[16:17], v254 offset:4224
  v_mfma_f32_16x16x32_bf16 v[100:103], v[20:23], v[172:175], v[100:103]
  ds_read_b64_tr_b16 v[18:19], v254 offset:6528
  v_mfma_f32_16x16x32_bf16 v[136:139], v[20:23], v[176:179], v[136:139]
  s_waitcnt lgkmcnt(6)
  v_mfma_f32_16x16x32_bf16 v[68:71], v[228:231], v[60:63], v[68:71]
  ds_read_b64_tr_b16 v[20:21], v254 offset:4256
  v_mfma_f32_16x16x32_bf16 v[104:107], v[228:231], v[172:175], v[104:107]
  ds_read_b64_tr_b16 v[22:23], v254 offset:6560
  v_mfma_f32_16x16x32_bf16 v[140:143], v[228:231], v[176:179], v[140:143]
  s_waitcnt lgkmcnt(6)
  v_mfma_f32_16x16x32_bf16 v[72:75], v[232:235], v[60:63], v[72:75]
  ds_read_b64_tr_b16 v[228:229], v254 offset:4288
  v_mfma_f32_16x16x32_bf16 v[108:111], v[232:235], v[172:175], v[108:111]
  ds_read_b64_tr_b16 v[230:231], v254 offset:6592
  v_mfma_f32_16x16x32_bf16 v[144:147], v[232:235], v[176:179], v[144:147]
  s_waitcnt lgkmcnt(6)
  v_mfma_f32_16x16x32_bf16 v[76:79], v[12:15], v[60:63], v[76:79]
  ds_read_b64_tr_b16 v[232:233], v254 offset:4320
  v_mfma_f32_16x16x32_bf16 v[112:115], v[12:15], v[172:175], v[112:115]
  ds_read_b64_tr_b16 v[234:235], v254 offset:6624
  v_mfma_f32_16x16x32_bf16 v[148:151], v[12:15], v[176:179], v[148:151]
  s_waitcnt lgkmcnt(6)
  v_mfma_f32_16x16x32_bf16 v[80:83], v[16:19], v[60:63], v[80:83]
  ds_read_b64_tr_b16 v[12:13], v254 offset:4352
  v_mfma_f32_16x16x32_bf16 v[116:119], v[16:19], v[172:175], v[116:119]
  ds_read_b64_tr_b16 v[14:15], v254 offset:6656
  v_mfma_f32_16x16x32_bf16 v[152:155], v[16:19], v[176:179], v[152:155]
  s_waitcnt lgkmcnt(6)
  v_mfma_f32_16x16x32_bf16 v[84:87], v[20:23], v[60:63], v[84:87]
  v_mfma_f32_16x16x32_bf16 v[120:123], v[20:23], v[172:175], v[120:123]
  v_mfma_f32_16x16x32_bf16 v[156:159], v[20:23], v[176:179], v[156:159]
  s_waitcnt lgkmcnt(4)
  v_mfma_f32_16x16x32_bf16 v[88:91], v[228:231], v[60:63], v[88:91]
  v_mfma_f32_16x16x32_bf16 v[124:127], v[228:231], v[172:175], v[124:127]
  v_mfma_f32_16x16x32_bf16 v[160:163], v[228:231], v[176:179], v[160:163]
  s_waitcnt lgkmcnt(2)
  v_mfma_f32_16x16x32_bf16 v[92:95], v[232:235], v[60:63], v[92:95]
  v_mfma_f32_16x16x32_bf16 v[128:131], v[232:235], v[172:175], v[128:131]
  v_mfma_f32_16x16x32_bf16 v[164:167], v[232:235], v[176:179], v[164:167]
  s_waitcnt lgkmcnt(0)
  v_mfma_f32_16x16x32_bf16 v[96:99], v[12:15], v[60:63], v[96:99]
  v_mfma_f32_16x16x32_bf16 v[132:135], v[12:15], v[172:175], v[132:135]
  v_mfma_f32_16x16x32_bf16 v[168:171], v[12:15], v[176:179], v[168:171]
  s_waitcnt vmcnt(12)
  s_mov_b64 exec, 1
  buffer_store_dword v2, off, s[60:63], s101 offset:128 sc1
  s_mov_b64 exec, -1
  s_barrier
  s_add_u32 s12, s100, 0
  s_and_b32 s12, s12, 3
  s_mul_i32 s11, s12, 24576
  s_add_u32 s11, s11, s93
  buffer_load_dwordx4 v[24:27], v3, s[60:63], s11 offen offset:0 sc1
  buffer_load_dwordx4 v[28:31], v4, s[60:63], s11 offen offset:0 sc1
  buffer_load_dwordx4 v[32:35], v6, s[60:63], s11 offen offset:0 sc1
  buffer_load_dwordx4 v[36:39], v3, s[60:63], s11 offen offset:2048 sc1
  buffer_load_dwordx4 v[40:43], v4, s[60:63], s11 offen offset:2048 sc1
  buffer_load_dwordx4 v[44:47], v6, s[60:63], s11 offen offset:2048 sc1
  s_add_u32 s11, s11, 4096
  buffer_load_dwordx4 v[48:51], v3, s[60:63], s11 offen offset:0 sc1
  buffer_load_dwordx4 v[52:55], v4, s[60:63], s11 offen offset:0 sc1
  buffer_load_dwordx4 v[56:59], v6, s[60:63], s11 offen offset:0 sc1
  buffer_load_dwordx4 v[60:63], v3, s[60:63], s11 offen offset:2048 sc1
  buffer_load_dwordx4 v[172:175], v4, s[60:63], s11 offen offset:2048 sc1
  buffer_load_dwordx4 v[176:179], v6, s[60:63], s11 offen offset:2048 sc1
  buffer_load_dword v11, v1, s[60:63], 0 offen sc1
  ds_read_b64_tr_b16 v[12:13], v252 offset:18432
  ds_read_b64_tr_b16 v[14:15], v252 offset:20736
  ds_read_b64_tr_b16 v[16:17], v252 offset:18464
  ds_read_b64_tr_b16 v[18:19], v252 offset:20768
  ds_read_b64_tr_b16 v[20:21], v252 offset:18496
  ds_read_b64_tr_b16 v[22:23], v252 offset:20800
  ds_read_b64_tr_b16 v[228:229], v252 offset:18528
  ds_read_b64_tr_b16 v[230:231], v252 offset:20832
  ds_read_b64_tr_b16 v[232:233], v252 offset:18560
  ds_read_b64_tr_b16 v[234:235], v252 offset:20864
  ds_read_b64_tr_b16 v[236:237], v252 offset:18592
  ds_read_b64_tr_b16 v[238:239], v252 offset:20896
  s_waitcnt vmcnt(22)
  s_waitcnt lgkmcnt(10)
  v_mfma_f32_16x16x32_bf16 v[64:67], v[12:15], v[180:183], v[64:67]
  ds_read_b64_tr_b16 v[240:241], v252 offset:18624
  v_mfma_f32_16x16x32_bf16 v[100:103], v[12:15], v[184:187], v[100:103]
  ds_read_b64_tr_b16 v[242:243], v252 offset:20928
  v_mfma_f32_16x16x32_bf16 v[136:139], v[12:15], v[188:191], v[136:139]
  s_waitcnt lgkmcnt(10)
  v_mfma_f32_16x16x32_bf16 v[68:71], v[16:19], v[180:183], v[68:71]
  ds_read_b64_tr_b16 v[12:13], v252 offset:18656
  v_mfma_f32_16x16x32_bf16 v[104:107], v[16:19], v[184:187], v[104:107]
  ds_read_b64_tr_b16 v[14:15], v252 offset:20960
  v_mfma_f32_16x16x32_bf16 v[140:143], v[16:19], v[188:191], v[140:143]
  s_waitcnt lgkmcnt(10)
  v_mfma_f32_16x16x32_bf16 v[72:75], v[20:23], v[180:183], v[72:75]
  ds_read_b64_tr_b16 v[16:17], v252 offset:18688
  v_mfma_f32_16x16x32_bf16 v[108:111], v[20:23], v[184:187], v[108:111]
  ds_read_b64_tr_b16 v[18:19], v252 offset:20992
  v_mfma_f32_16x16x32_bf16 v[144:147], v[20:23], v[188:191], v[144:147]
  s_waitcnt lgkmcnt(10)
  v_mfma_f32_16x16x32_bf16 v[76:79], v[228:231], v[180:183], v[76:79]
  ds_read_b64_tr_b16 v[20:21], v252 offset:32768
  v_mfma_f32_16x16x32_bf16 v[112:115], v[228:231], v[184:187], v[112:115]
  ds_read_b64_tr_b16 v[22:23], v252 offset:35072
  v_mfma_f32_16x16x32_bf16 v[148:151], v[228:231], v[188:191], v[148:151]
  s_waitcnt lgkmcnt(10)
  v_mfma_f32_16x16x32_bf16 v[80:83], v[232:235], v[180:183], v[80:83]
  ds_read_b64_tr_b16 v[228:229], v252 offset:32800
  v_mfma_f32_16x16x32_bf16 v[116:119], v[232:235], v[184:187], v[116:119]
  ds_read_b64_tr_b16 v[230:231], v252 offset:35104
  v_mfma_f32_16x16x32_bf16 v[152:155], v[232:235], v[188:191], v[152:155]
  s_waitcnt lgkmcnt(10)
  v_mfma_f32_16x16x32_bf16 v[84:87], v[236:239], v[180:183], v[84:87]
  ds_read_b64_tr_b16 v[232:233], v252 offset:32832
  v_mfma_f32_16x16x32_bf16 v[120:123], v[236:239], v[184:187], v[120:123]
  ds_read_b64_tr_b16 v[234:235], v252 offset:35136
  v_mfma_f32_16x16x32_bf16 v[156:159], v[236:239], v[188:191], v[156:159]
  s_waitcnt lgkmcnt(10)
  v_mfma_f32_16x16x32_bf16 v[88:91], v[240:243], v[180:183], v[88:91]
  ds_read_b64_tr_b16 v[236:237], v252 offset:32864
  v_mfma_f32_16x16x32_bf16 v[124:127], v[240:243], v[184:187], v[124:127]
  ds_read_b64_tr_b16 v[238:239], v252 offset:35168
  v_mfma_f32_16x16x32_bf16 v[160:163], v[240:243], v[188:191], v[160:163]
  s_waitcnt lgkmcnt(10)
  v_mfma_f32_16x16x32_bf16 v[92:95], v[12:15], v[180:183], v[92:95]
  ds_read_b64_tr_b16 v[240:241], v252 offset:32896
  v_mfma_f32_16x16x32_bf16 v[128:131], v[12:15], v[184:187], v[128:131]
  ds_read_b64_tr_b16 v[242:243], v252 offset:35200
  v_mfma_f32_16x16x32_bf16 v[164:167], v[12:15], v[188:191], v[164:167]
  s_waitcnt lgkmcnt(10)
  v_mfma_f32_16x16x32_bf16 v[96:99], v[16:19], v[180:183], v[96:99]
  ds_read_b64_tr_b16 v[12:13], v252 offset:32928
  v_mfma_f32_16x16x32_bf16 v[132:135], v[16:19], v[184:187], v[132:135]
  ds_read_b64_tr_b16 v[14:15], v252 offset:35232
  v_mfma_f32_16x16x32_bf16 v[168:171], v[16:19], v[188:191], v[168:171]
  s_waitcnt vmcnt(19)
  s_waitcnt lgkmcnt(10)
  v_mfma_f32_16x16x32_bf16 v[64:67], v[20:23], v[192:195], v[64:67]
  ds_read_b64_tr_b16 v[16:17], v252 offset:32960
  v_mfma_f32_16x16x32_bf16 v[100:103], v[20:23], v[196:199], v[100:103]
  ds_read_b64_tr_b16 v[18:19], v252 offset:35264
  v_mfma_f32_16x16x32_bf16 v[136:139], v[20:23], v[200:203], v[136:139]
  s_waitcnt lgkmcnt(10)
  v_mfma_f32_16x16x32_bf16 v[68:71], v[228:231], v[192:195], v[68:71]
  ds_read_b64_tr_b16 v[20:21], v252 offset:32992
  v_mfma_f32_16x16x32_bf16 v[104:107], v[228:231], v[196:199], v[104:107]
  ds_read_b64_tr_b16 v[22:23], v252 offset:35296
  v_mfma_f32_16x16x32_bf16 v[140:143], v[228:231], v[200:203], v[140:143]
  s_waitcnt lgkmcnt(10)
  v_mfma_f32_16x16x32_bf16 v[72:75], v[232:235], v[192:195], v[72:75]
  ds_read_b64_tr_b16 v[228:229], v252 offset:33024
  v_mfma_f32_16x16x32_bf16 v[108:111], v[232:235], v[196:199], v[108:111]
  ds_read_b64_tr_b16 v[230:231], v252 offset:35328
  v_mfma_f32_16x16x32_bf16 v[144:147], v[232:235], v[200:203], v[144:147]
  s_waitcnt lgkmcnt(10)
  v_mfma_f32_16x16x32_bf16 v[76:79], v[236:239], v[192:195], v[76:79]
  ds_read_b64_tr_b16 v[232:233], v252 offset:41984
  v_mfma_f32_16x16x32_bf16 v[112:115], v[236:239], v[196:199], v[112:115]
  ds_read_b64_tr_b16 v[234:235], v252 offset:44288
  v_mfma_f32_16x16x32_bf16 v[148:151], v[236:239], v[200:203], v[148:151]
  s_waitcnt lgkmcnt(10)
  v_mfma_f32_16x16x32_bf16 v[80:83], v[240:243], v[192:195], v[80:83]
  ds_read_b64_tr_b16 v[236:237], v252 offset:42016
  v_mfma_f32_16x16x32_bf16 v[116:119], v[240:243], v[196:199], v[116:119]
  ds_read_b64_tr_b16 v[238:239], v252 offset:44320
  v_mfma_f32_16x16x32_bf16 v[152:155], v[240:243], v[200:203], v[152:155]
  s_waitcnt lgkmcnt(10)
  v_mfma_f32_16x16x32_bf16 v[84:87], v[12:15], v[192:195], v[84:87]
  ds_read_b64_tr_b16 v[240:241], v252 offset:42048
  v_mfma_f32_16x16x32_bf16 v[120:123], v[12:15], v[196:199], v[120:123]
  ds_read_b64_tr_b16 v[242:243], v252 offset:44352
  v_mfma_f32_16x16x32_bf16 v[156:159], v[12:15], v[200:203], v[156:159]
  s_waitcnt lgkmcnt(10)
  v_mfma_f32_16x16x32_bf16 v[88:91], v[16:19], v[192:195], v[88:91]
  ds_read_b64_tr_b16 v[12:13], v252 offset:42080
  v_mfma_f32_16x16x32_bf16 v[124:127], v[16:19], v[196:199], v[124:127]
  ds_read_b64_tr_b16 v[14:15], v252 offset:44384
  v_mfma_f32_16x16x32_bf16 v[160:163], v[16:19], v[200:203], v[160:163]
  s_waitcnt lgkmcnt(10)
  v_mfma_f32_16x16x32_bf16 v[92:95], v[20:23], v[192:195], v[92:95]
  ds_read_b64_tr_b16 v[16:17], v252 offset:42112
  v_mfma_f32_16x16x32_bf16 v[128:131], v[20:23], v[196:199], v[128:131]
  ds_read_b64_tr_b16 v[18:19], v252 offset:44416
  v_mfma_f32_16x16x32_bf16 v[164:167], v[20:23], v[200:203], v[164:167]
  s_waitcnt lgkmcnt(10)
  v_mfma_f32_16x16x32_bf16 v[96:99], v[228:231], v[192:195], v[96:99]
  ds_read_b64_tr_b16 v[20:21], v252 offset:42144
  v_mfma_f32_16x16x32_bf16 v[132:135], v[228:231], v[196:199], v[132:135]
  ds_read_b64_tr_b16 v[22:23], v252 offset:44448
  v_mfma_f32_16x16x32_bf16 v[168:171], v[228:231], v[200:203], v[168:171]
  s_waitcnt vmcnt(16)
  s_waitcnt lgkmcnt(10)
  v_mfma_f32_16x16x32_bf16 v[64:67], v[232:235], v[204:207], v[64:67]
  ds_read_b64_tr_b16 v[228:229], v252 offset:42176
  v_mfma_f32_16x16x32_bf16 v[100:103], v[232:235], v[208:211], v[100:103]
  ds_read_b64_tr_b16 v[230:231], v252 offset:44480
  v_mfma_f32_16x16x32_bf16 v[136:139], v[232:235], v[212:215], v[136:139]
  s_waitcnt lgkmcnt(10)
  v_mfma_f32_16x16x32_bf16 v[68:71], v[236:239], v[204:207], v[68:71]
  ds_read_b64_tr_b16 v[232:233], v252 offset:42208
  v_mfma_f32_16x16x32_bf16 v[104:107], v[236:239], v[208:211], v[104:107]
  ds_read_b64_tr_b16 v[234:235], v252 offset:44512
  v_mfma_f32_16x16x32_bf16 v[140:143], v[236:239], v[212:215], v[140:143]
  s_waitcnt lgkmcnt(10)
  v_mfma_f32_16x16x32_bf16 v[72:75], v[240:243], v[204:207], v[72:75]
  ds_read_b64_tr_b16 v[236:237], v252 offset:42240
  v_mfma_f32_16x16x32_bf16 v[108:111], v[240:243], v[208:211], v[108:111]
  ds_read_b64_tr_b16 v[238:239], v252 offset:44544
  v_mfma_f32_16x16x32_bf16 v[144:147], v[240:243], v[212:215], v[144:147]
  s_waitcnt lgkmcnt(10)
  v_mfma_f32_16x16x32_bf16 v[76:79], v[12:15], v[204:207], v[76:79]
  ds_read_b64_tr_b16 v[240:241], v252 offset:51200
  v_mfma_f32_16x16x32_bf16 v[112:115], v[12:15], v[208:211], v[112:115]
  ds_read_b64_tr_b16 v[242:243], v252 offset:53504
  v_mfma_f32_16x16x32_bf16 v[148:151], v[12:15], v[212:215], v[148:151]
  s_waitcnt lgkmcnt(10)
  v_mfma_f32_16x16x32_bf16 v[80:83], v[16:19], v[204:207], v[80:83]
  ds_read_b64_tr_b16 v[12:13], v252 offset:51232
  v_mfma_f32_16x16x32_bf16 v[116:119], v[16:19], v[208:211], v[116:119]
  ds_read_b64_tr_b16 v[14:15], v252 offset:53536
  v_mfma_f32_16x16x32_bf16 v[152:155], v[16:19], v[212:215], v[152:155]
  s_waitcnt lgkmcnt(10)
  v_mfma_f32_16x16x32_bf16 v[84:87], v[20:23], v[204:207], v[84:87]
  ds_read_b64_tr_b16 v[16:17], v252 offset:51264
  v_mfma_f32_16x16x32_bf16 v[120:123], v[20:23], v[208:211], v[120:123]
  ds_read_b64_tr_b16 v[18:19], v252 offset:53568
  v_mfma_f32_16x16x32_bf16 v[156:159], v[20:23], v[212:215], v[156:159]
  s_waitcnt lgkmcnt(10)
  v_mfma_f32_16x16x32_bf16 v[88:91], v[228:231], v[204:207], v[88:91]
  ds_read_b64_tr_b16 v[20:21], v252 offset:51296
  v_mfma_f32_16x16x32_bf16 v[124:127], v[228:231], v[208:211], v[124:127]
  ds_read_b64_tr_b16 v[22:23], v252 offset:53600
  v_mfma_f32_16x16x32_bf16 v[160:163], v[228:231], v[212:215], v[160:163]
  s_waitcnt lgkmcnt(10)
  v_mfma_f32_16x16x32_bf16 v[92:95], v[232:235], v[204:207], v[92:95]
  ds_read_b64_tr_b16 v[228:229], v252 offset:51328
  v_mfma_f32_16x16x32_bf16 v[128:131], v[232:235], v[208:211], v[128:131]
  ds_read_b64_tr_b16 v[230:231], v252 offset:53632
  v_mfma_f32_16x16x32_bf16 v[164:167], v[232:235], v[212:215], v[164:167]
  s_waitcnt lgkmcnt(10)
  v_mfma_f32_16x16x32_bf16 v[96:99], v[236:239], v[204:207], v[96:99]
  ds_read_b64_tr_b16 v[232:233], v252 offset:51360
  v_mfma_f32_16x16x32_bf16 v[132:135], v[236:239], v[208:211], v[132:135]
  ds_read_b64_tr_b16 v[234:235], v252 offset:53664
  v_mfma_f32_16x16x32_bf16 v[168:171], v[236:239], v[212:215], v[168:171]
  s_waitcnt vmcnt(13)
  s_waitcnt lgkmcnt(10)
  v_mfma_f32_16x16x32_bf16 v[64:67], v[240:243], v[216:219], v[64:67]
  ds_read_b64_tr_b16 v[236:237], v252 offset:51392
  v_mfma_f32_16x16x32_bf16 v[100:103], v[240:243], v[220:223], v[100:103]
  ds_read_b64_tr_b16 v[238:239], v252 offset:53696
  v_mfma_f32_16x16x32_bf16 v[136:139], v[240:243], v[224:227], v[136:139]
  s_waitcnt lgkmcnt(10)
  v_mfma_f32_16x16x32_bf16 v[68:71], v[12:15], v[216:219], v[68:71]
  ds_read_b64_tr_b16 v[240:241], v252 offset:51424
  v_mfma_f32_16x16x32_bf16 v[104:107], v[12:15], v[220:223], v[104:107]
  ds_read_b64_tr_b16 v[242:243], v252 offset:53728
  v_mfma_f32_16x16x32_bf16 v[140:143], v[12:15], v[224:227], v[140:143]
  s_waitcnt lgkmcnt(10)
  v_mfma_f32_16x16x32_bf16 v[72:75], v[16:19], v[216:219], v[72:75]
  ds_read_b64_tr_b16 v[12:13], v252 offset:51456
  v_mfma_f32_16x16x32_bf16 v[108:111], v[16:19], v[220:223], v[108:111]
  ds_read_b64_tr_b16 v[14:15], v252 offset:53760
  v_mfma_f32_16x16x32_bf16 v[144:147], v[16:19], v[224:227], v[144:147]
  s_waitcnt lgkmcnt(10)
  v_mfma_f32_16x16x32_bf16 v[76:79], v[20:23], v[216:219], v[76:79]
  v_mfma_f32_16x16x32_bf16 v[112:115], v[20:23], v[220:223], v[112:115]
  v_mfma_f32_16x16x32_bf16 v[148:151], v[20:23], v[224:227], v[148:151]
  s_waitcnt lgkmcnt(8)
  v_mfma_f32_16x16x32_bf16 v[80:83], v[228:231], v[216:219], v[80:83]
  v_mfma_f32_16x16x32_bf16 v[116:119], v[228:231], v[220:223], v[116:119]
  v_mfma_f32_16x16x32_bf16 v[152:155], v[228:231], v[224:227], v[152:155]
  s_waitcnt lgkmcnt(6)
  v_mfma_f32_16x16x32_bf16 v[84:87], v[232:235], v[216:219], v[84:87]
  v_mfma_f32_16x16x32_bf16 v[120:123], v[232:235], v[220:223], v[120:123]
  v_mfma_f32_16x16x32_bf16 v[156:159], v[232:235], v[224:227], v[156:159]
  s_waitcnt lgkmcnt(4)
  v_mfma_f32_16x16x32_bf16 v[88:91], v[236:239], v[216:219], v[88:91]
  v_mfma_f32_16x16x32_bf16 v[124:127], v[236:239], v[220:223], v[124:127]
  v_mfma_f32_16x16x32_bf16 v[160:163], v[236:239], v[224:227], v[160:163]
  s_waitcnt lgkmcnt(2)
  v_mfma_f32_16x16x32_bf16 v[92:95], v[240:243], v[216:219], v[92:95]
  v_mfma_f32_16x16x32_bf16 v[128:131], v[240:243], v[220:223], v[128:131]
  v_mfma_f32_16x16x32_bf16 v[164:167], v[240:243], v[224:227], v[164:167]
  s_waitcnt lgkmcnt(0)
  v_mfma_f32_16x16x32_bf16 v[96:99], v[12:15], v[216:219], v[96:99]
  v_mfma_f32_16x16x32_bf16 v[132:135], v[12:15], v[220:223], v[132:135]
  v_mfma_f32_16x16x32_bf16 v[168:171], v[12:15], v[224:227], v[168:171]
  s_waitcnt vmcnt(0)
  v_cmp_ne_u32 vcc, 1, v11
  s_cmp_eq_u64 vcc, 0
  s_cselect_b32 s89, 1, 0
  s_barrier
  s_cmp_eq_u32 s89, 0
  s_cbranch_scc1 tl0_n1
  s_add_u32 s12, s100, 1
  s_and_b32 s12, s12, 3
  s_mul_i32 s11, s12, 24576
  s_add_u32 s11, s11, s93
  buffer_load_dwordx4 v[180:183], v3, s[60:63], s11 offen offset:0 sc1
  buffer_load_dwordx4 v[184:187], v4, s[60:63], s11 offen offset:0 sc1
  buffer_load_dwordx4 v[188:191], v6, s[60:63], s11 offen offset:0 sc1
  buffer_load_dwordx4 v[192:195], v3, s[60:63], s11 offen offset:2048 sc1
  buffer_load_dwordx4 v[196:199], v4, s[60:63], s11 offen offset:2048 sc1
  buffer_load_dwordx4 v[200:203], v6, s[60:63], s11 offen offset:2048 sc1
  s_add_u32 s11, s11, 4096
  buffer_load_dwordx4 v[204:207], v3, s[60:63], s11 offen offset:0 sc1
  buffer_load_dwordx4 v[208:211], v4, s[60:63], s11 offen offset:0 sc1
  buffer_load_dwordx4 v[212:215], v6, s[60:63], s11 offen offset:0 sc1
  buffer_load_dwordx4 v[216:219], v3, s[60:63], s11 offen offset:2048 sc1
  buffer_load_dwordx4 v[220:223], v4, s[60:63], s11 offen offset:2048 sc1
  buffer_load_dwordx4 v[224:227], v6, s[60:63], s11 offen offset:2048 sc1
tl0_n1:
  ds_read_b64_tr_b16 v[12:13], v253 offset:32768
  ds_read_b64_tr_b16 v[14:15], v253 offset:35072
  ds_read_b64_tr_b16 v[16:17], v253 offset:32800
  ds_read_b64_tr_b16 v[18:19], v253 offset:35104
  ds_read_b64_tr_b16 v[20:21], v253 offset:32832
  ds_read_b64_tr_b16 v[22:23], v253 offset:35136
  ds_read_b64_tr_b16 v[228:229], v253 offset:32864
  ds_read_b64_tr_b16 v[230:231], v253 offset:35168
  ds_read_b64_tr_b16 v[232:233], v253 offset:32896
  ds_read_b64_tr_b16 v[234:235], v253 offset:35200
  ds_read_b64_tr_b16 v[236:237], v253 offset:32928
  ds_read_b64_tr_b16 v[238:239], v253 offset:35232
  s_waitcnt lgkmcnt(10)
  v_mfma_f32_16x16x32_bf16 v[64:67], v[12:15], v[24:27], v[64:67]
  ds_read_b64_tr_b16 v[240:241], v253 offset:32960
  v_mfma_f32_16x16x32_bf16 v[100:103], v[12:15], v[28:31], v[100:103]
  ds_read_b64_tr_b16 v[242:243], v253 offset:35264
  v_mfma_f32_16x16x32_bf16 v[136:139], v[12:15], v[32:35], v[136:139]
  s_waitcnt lgkmcnt(10)
  v_mfma_f32_16x16x32_bf16 v[68:71], v[16:19], v[24:27], v[68:71]
  ds_read_b64_tr_b16 v[12:13], v253 offset:32992
  v_mfma_f32_16x16x32_bf16 v[104:107], v[16:19], v[28:31], v[104:107]
  ds_read_b64_tr_b16 v[14:15], v253 offset:35296
  v_mfma_f32_16x16x32_bf16 v[140:143], v[16:19], v[32:35], v[140:143]
  s_waitcnt lgkmcnt(10)
  v_mfma_f32_16x16x32_bf16 v[72:75], v[20:23], v[24:27], v[72:75]
  ds_read_b64_tr_b16 v[16:17], v253 offset:33024
  v_mfma_f32_16x16x32_bf16 v[108:111], v[20:23], v[28:31], v[108:111]
  ds_read_b64_tr_b16 v[18:19], v253 offset:35328
  v_mfma_f32_16x16x32_bf16 v[144:147], v[20:23], v[32:35], v[144:147]
  s_waitcnt lgkmcnt(10)
  v_mfma_f32_16x16x32_bf16 v[76:79], v[228:231], v[24:27], v[76:79]
  ds_read_b64_tr_b16 v[20:21], v253 offset:41984
  v_mfma_f32_16x16x32_bf16 v[112:115], v[228:231], v[28:31], v[112:115]
  ds_read_b64_tr_b16 v[22:23], v253 offset:44288
  v_mfma_f32_16x16x32_bf16 v[148:151], v[228:231], v[32:35], v[148:151]
  s_waitcnt lgkmcnt(10)
  v_mfma_f32_16x16x32_bf16 v[80:83], v[232:235], v[24:27], v[80:83]
  ds_read_b64_tr_b16 v[228:229], v253 offset:42016
  v_mfma_f32_16x16x32_bf16 v[116:119], v[232:235], v[28:31], v[116:119]
  ds_read_b64_tr_b16 v[230:231], v253 offset:44320
  v_mfma_f32_16x16x32_bf16 v[152:155], v[232:235], v[32:35], v[152:155]
  s_waitcnt lgkmcnt(10)
  v_mfma_f32_16x16x32_bf16 v[84:87], v[236:239], v[24:27], v[84:87]
  ds_read_b64_tr_b16 v[232:233], v253 offset:42048
  v_mfma_f32_16x16x32_bf16 v[120:123], v[236:239], v[28:31], v[120:123]
  ds_read_b64_tr_b16 v[234:235], v253 offset:44352
  v_mfma_f32_16x16x32_bf16 v[156:159], v[236:239], v[32:35], v[156:159]
  s_waitcnt lgkmcnt(10)
  v_mfma_f32_16x16x32_bf16 v[88:91], v[240:243], v[24:27], v[88:91]
  ds_read_b64_tr_b16 v[236:237], v253 offset:42080
  v_mfma_f32_16x16x32_bf16 v[124:127], v[240:243], v[28:31], v[124:127]
  ds_read_b64_tr_b16 v[238:239], v253 offset:44384
  v_mfma_f32_16x16x32_bf16 v[160:163], v[240:243], v[32:35], v[160:163]
  s_waitcnt lgkmcnt(10)
  v_mfma_f32_16x16x32_bf16 v[92:95], v[12:15], v[24:27], v[92:95]
  ds_read_b64_tr_b16 v[240:241], v253 offset:42112
  v_mfma_f32_16x16x32_bf16 v[128:131], v[12:15], v[28:31], v[128:131]
  ds_read_b64_tr_b16 v[242:243], v253 offset:44416
  v_mfma_f32_16x16x32_bf16 v[164:167], v[12:15], v[32:35], v[164:167]
  s_waitcnt lgkmcnt(10)
  v_mfma_f32_16x16x32_bf16 v[96:99], v[16:19], v[24:27], v[96:99]
  ds_read_b64_tr_b16 v[12:13], v253 offset:42144
  v_mfma_f32_16x16x32_bf16 v[132:135], v[16:19], v[28:31], v[132:135]
  ds_read_b64_tr_b16 v[14:15], v253 offset:44448
  v_mfma_f32_16x16x32_bf16 v[168:171], v[16:19], v[32:35], v[168:171]
  s_waitcnt lgkmcnt(10)
  v_mfma_f32_16x16x32_bf16 v[64:67], v[20:23], v[36:39], v[64:67]
  ds_read_b64_tr_b16 v[16:17], v253 offset:42176
  v_mfma_f32_16x16x32_bf16 v[100:103], v[20:23], v[40:43], v[100:103]
  ds_read_b64_tr_b16 v[18:19], v253 offset:44480
  v_mfma_f32_16x16x32_bf16 v[136:139], v[20:23], v[44:47], v[136:139]
  s_waitcnt lgkmcnt(10)
  v_mfma_f32_16x16x32_bf16 v[68:71], v[228:231], v[36:39], v[68:71]
  ds_read_b64_tr_b16 v[20:21], v253 offset:42208
  v_mfma_f32_16x16x32_bf16 v[104:107], v[228:231], v[40:43], v[104:107]
  ds_read_b64_tr_b16 v[22:23], v253 offset:44512
  v_mfma_f32_16x16x32_bf16 v[140:143], v[228:231], v[44:47], v[140:143]
  s_waitcnt lgkmcnt(10)
  v_mfma_f32_16x16x32_bf16 v[72:75], v[232:235], v[36:39], v[72:75]
  ds_read_b64_tr_b16 v[228:229], v253 offset:42240
  v_mfma_f32_16x16x32_bf16 v[108:111], v[232:235], v[40:43], v[108:111]
  ds_read_b64_tr_b16 v[230:231], v253 offset:44544
  v_mfma_f32_16x16x32_bf16 v[144:147], v[232:235], v[44:47], v[144:147]
  s_waitcnt lgkmcnt(10)
  v_mfma_f32_16x16x32_bf16 v[76:79], v[236:239], v[36:39], v[76:79]
  ds_read_b64_tr_b16 v[232:233], v253 offset:51200
  v_mfma_f32_16x16x32_bf16 v[112:115], v[236:239], v[40:43], v[112:115]
  ds_read_b64_tr_b16 v[234:235], v253 offset:53504
  v_mfma_f32_16x16x32_bf16 v[148:151], v[236:239], v[44:47], v[148:151]
  s_waitcnt lgkmcnt(10)
  v_mfma_f32_16x16x32_bf16 v[80:83], v[240:243], v[36:39], v[80:83]
  ds_read_b64_tr_b16 v[236:237], v253 offset:51232
  v_mfma_f32_16x16x32_bf16 v[116:119], v[240:243], v[40:43], v[116:119]
  ds_read_b64_tr_b16 v[238:239], v253 offset:53536
  v_mfma_f32_16x16x32_bf16 v[152:155], v[240:243], v[44:47], v[152:155]
  s_waitcnt lgkmcnt(10)
  v_mfma_f32_16x16x32_bf16 v[84:87], v[12:15], v[36:39], v[84:87]
  ds_read_b64_tr_b16 v[240:241], v253 offset:51264
  v_mfma_f32_16x16x32_bf16 v[120:123], v[12:15], v[40:43], v[120:123]
  ds_read_b64_tr_b16 v[242:243], v253 offset:53568
  v_mfma_f32_16x16x32_bf16 v[156:159], v[12:15], v[44:47], v[156:159]
  s_waitcnt lgkmcnt(10)
  v_mfma_f32_16x16x32_bf16 v[88:91], v[16:19], v[36:39], v[88:91]
  ds_read_b64_tr_b16 v[12:13], v253 offset:51296
  v_mfma_f32_16x16x32_bf16 v[124:127], v[16:19], v[40:43], v[124:127]
  ds_read_b64_tr_b16 v[14:15], v253 offset:53600
  v_mfma_f32_16x16x32_bf16 v[160:163], v[16:19], v[44:47], v[160:163]
  s_waitcnt lgkmcnt(10)
  v_mfma_f32_16x16x32_bf16 v[92:95], v[20:23], v[36:39], v[92:95]
  ds_read_b64_tr_b16 v[16:17], v253 offset:51328
  v_mfma_f32_16x16x32_bf16 v[128:131], v[20:23], v[40:43], v[128:131]
  ds_read_b64_tr_b16 v[18:19], v253 offset:53632
  v_mfma_f32_16x16x32_bf16 v[164:167], v[20:23], v[44:47], v[164:167]
  s_waitcnt lgkmcnt(10)
  v_mfma_f32_16x16x32_bf16 v[96:99], v[228:231], v[36:39], v[96:99]
  ds_read_b64_tr_b16 v[20:21], v253 offset:51360
  v_mfma_f32_16x16x32_bf16 v[132:135], v[228:231], v[40:43], v[132:135]
  ds_read_b64_tr_b16 v[22:23], v253 offset:53664
  v_mfma_f32_16x16x32_bf16 v[168:171], v[228:231], v[44:47], v[168:171]
  s_waitcnt lgkmcnt(10)
  v_mfma_f32_16x16x32_bf16 v[64:67], v[232:235], v[48:51], v[64:67]
  ds_read_b64_tr_b16 v[228:229], v253 offset:51392
  v_mfma_f32_16x16x32_bf16 v[100:103], v[232:235], v[52:55], v[100:103]
  ds_read_b64_tr_b16 v[230:231], v253 offset:53696
  v_mfma_f32_16x16x32_bf16 v[136:139], v[232:235], v[56:59], v[136:139]
  s_waitcnt lgkmcnt(10)
  v_mfma_f32_16x16x32_bf16 v[68:71], v[236:239], v[48:51], v[68:71]
  ds_read_b64_tr_b16 v[232:233], v253 offset:51424
  v_mfma_f32_16x16x32_bf16 v[104:107], v[236:239], v[52:55], v[104:107]
  ds_read_b64_tr_b16 v[234:235], v253 offset:53728
  v_mfma_f32_16x16x32_bf16 v[140:143], v[236:239], v[56:59], v[140:143]
  s_waitcnt lgkmcnt(10)
  v_mfma_f32_16x16x32_bf16 v[72:75], v[240:243], v[48:51], v[72:75]
  ds_read_b64_tr_b16 v[236:237], v253 offset:51456
  v_mfma_f32_16x16x32_bf16 v[108:111], v[240:243], v[52:55], v[108:111]
  ds_read_b64_tr_b16 v[238:239], v253 offset:53760
  v_mfma_f32_16x16x32_bf16 v[144:147], v[240:243], v[56:59], v[144:147]
  s_waitcnt lgkmcnt(10)
  v_mfma_f32_16x16x32_bf16 v[76:79], v[12:15], v[48:51], v[76:79]
  ds_read_b64_tr_b16 v[240:241], v254 offset:4096
  v_mfma_f32_16x16x32_bf16 v[112:115], v[12:15], v[52:55], v[112:115]
  ds_read_b64_tr_b16 v[242:243], v254 offset:6400
  v_mfma_f32_16x16x32_bf16 v[148:151], v[12:15], v[56:59], v[148:151]
  s_waitcnt lgkmcnt(10)
  v_mfma_f32_16x16x32_bf16 v[80:83], v[16:19], v[48:51], v[80:83]
  ds_read_b64_tr_b16 v[12:13], v254 offset:4128
  v_mfma_f32_16x16x32_bf16 v[116:119], v[16:19], v[52:55], v[116:119]
  ds_read_b64_tr_b16 v[14:15], v254 offset:6432
  v_mfma_f32_16x16x32_bf16 v[152:155], v[16:19], v[56:59], v[152:155]
  s_waitcnt lgkmcnt(10)
  v_mfma_f32_16x16x32_bf16 v[84:87], v[20:23], v[48:51], v[84:87]
  ds_read_b64_tr_b16 v[16:17], v254 offset:4160
  v_mfma_f32_16x16x32_bf16 v[120:123], v[20:23], v[52:55], v[120:123]
  ds_read_b64_tr_b16 v[18:19], v254 offset:6464
  v_mfma_f32_16x16x32_bf16 v[156:159], v[20:23], v[56:59], v[156:159]
  s_waitcnt lgkmcnt(10)
  v_mfma_f32_16x16x32_bf16 v[88:91], v[228:231], v[48:51], v[88:91]
  ds_read_b64_tr_b16 v[20:21], v254 offset:4192
  v_mfma_f32_16x16x32_bf16 v[124:127], v[228:231], v[52:55], v[124:127]
  ds_read_b64_tr_b16 v[22:23], v254 offset:6496
  v_mfma_f32_16x16x32_bf16 v[160:163], v[228:231], v[56:59], v[160:163]
  s_waitcnt lgkmcnt(10)
  v_mfma_f32_16x16x32_bf16 v[92:95], v[232:235], v[48:51], v[92:95]
  ds_read_b64_tr_b16 v[228:229], v254 offset:4224
  v_mfma_f32_16x16x32_bf16 v[128:131], v[232:235], v[52:55], v[128:131]
  ds_read_b64_tr_b16 v[230:231], v254 offset:6528
  v_mfma_f32_16x16x32_bf16 v[164:167], v[232:235], v[56:59], v[164:167]
  s_waitcnt lgkmcnt(10)
  v_mfma_f32_16x16x32_bf16 v[96:99], v[236:239], v[48:51], v[96:99]
  ds_read_b64_tr_b16 v[232:233], v254 offset:4256
  v_mfma_f32_16x16x32_bf16 v[132:135], v[236:239], v[52:55], v[132:135]
  ds_read_b64_tr_b16 v[234:235], v254 offset:6560
  v_mfma_f32_16x16x32_bf16 v[168:171], v[236:239], v[56:59], v[168:171]
  s_waitcnt lgkmcnt(10)
  v_mfma_f32_16x16x32_bf16 v[64:67], v[240:243], v[60:63], v[64:67]
  ds_read_b64_tr_b16 v[236:237], v254 offset:4288
  v_mfma_f32_16x16x32_bf16 v[100:103], v[240:243], v[172:175], v[100:103]
  ds_read_b64_tr_b16 v[238:239], v254 offset:6592
  v_mfma_f32_16x16x32_bf16 v[136:139], v[240:243], v[176:179], v[136:139]
  s_waitcnt lgkmcnt(10)
  v_mfma_f32_16x16x32_bf16 v[68:71], v[12:15], v[60:63], v[68:71]
  ds_read_b64_tr_b16 v[240:241], v254 offset:4320
  v_mfma_f32_16x16x32_bf16 v[104:107], v[12:15], v[172:175], v[104:107]
  ds_read_b64_tr_b16 v[242:243], v254 offset:6624
  v_mfma_f32_16x16x32_bf16 v[140:143], v[12:15], v[176:179], v[140:143]
  s_waitcnt lgkmcnt(10)
  v_mfma_f32_16x16x32_bf16 v[72:75], v[16:19], v[60:63], v[72:75]
  ds_read_b64_tr_b16 v[12:13], v254 offset:4352
  v_mfma_f32_16x16x32_bf16 v[108:111], v[16:19], v[172:175], v[108:111]
  ds_read_b64_tr_b16 v[14:15], v254 offset:6656
  v_mfma_f32_16x16x32_bf16 v[144:147], v[16:19], v[176:179], v[144:147]
  s_waitcnt lgkmcnt(10)
  v_mfma_f32_16x16x32_bf16 v[76:79], v[20:23], v[60:63], v[76:79]
  v_mfma_f32_16x16x32_bf16 v[112:115], v[20:23], v[172:175], v[112:115]
  v_mfma_f32_16x16x32_bf16 v[148:151], v[20:23], v[176:179], v[148:151]
  s_waitcnt lgkmcnt(8)
  v_mfma_f32_16x16x32_bf16 v[80:83], v[228:231], v[60:63], v[80:83]
  v_mfma_f32_16x16x32_bf16 v[116:119], v[228:231], v[172:175], v[116:119]
  v_mfma_f32_16x16x32_bf16 v[152:155], v[228:231], v[176:179], v[152:155]
  s_waitcnt lgkmcnt(6)
  v_mfma_f32_16x16x32_bf16 v[84:87], v[232:235], v[60:63], v[84:87]
  v_mfma_f32_16x16x32_bf16 v[120:123], v[232:235], v[172:175], v[120:123]
  v_mfma_f32_16x16x32_bf16 v[156:159], v[232:235], v[176:179], v[156:159]
  s_waitcnt lgkmcnt(4)
  v_mfma_f32_16x16x32_bf16 v[88:91], v[236:239], v[60:63], v[88:91]
  v_mfma_f32_16x16x32_bf16 v[124:127], v[236:239], v[172:175], v[124:127]
  v_mfma_f32_16x16x32_bf16 v[160:163], v[236:239], v[176:179], v[160:163]
  s_waitcnt lgkmcnt(2)
  v_mfma_f32_16x16x32_bf16 v[92:95], v[240:243], v[60:63], v[92:95]
  v_mfma_f32_16x16x32_bf16 v[128:131], v[240:243], v[172:175], v[128:131]
  v_mfma_f32_16x16x32_bf16 v[164:167], v[240:243], v[176:179], v[164:167]
  s_waitcnt lgkmcnt(0)
  v_mfma_f32_16x16x32_bf16 v[96:99], v[12:15], v[60:63], v[96:99]
  v_mfma_f32_16x16x32_bf16 v[132:135], v[12:15], v[172:175], v[132:135]
  v_mfma_f32_16x16x32_bf16 v[168:171], v[12:15], v[176:179], v[168:171]
  s_barrier
  s_cmp_lg_u32 s89, 0
  s_cbranch_scc1 tl0_y
  s_mov_b32 s43, 0
tl0_f2_spin:
  buffer_load_dword v11, v1, s[60:63], 0 offen sc1
  s_waitcnt vmcnt(0)
  v_cmp_ne_u32 vcc, 1, v11
  s_cbranch_vccz tl0_f2_ok
  s_add_u32 s43, s43, 1
  s_cmp_lt_u32 s43, 65536
  s_cbranch_scc1 tl0_f2_spin
tl0_f2_ok:
  s_add_u32 s12, s100, 1
  s_and_b32 s12, s12, 3
  s_mul_i32 s11, s12, 24576
  s_add_u32 s11, s11, s93
  buffer_load_dwordx4 v[180:183], v3, s[60:63], s11 offen offset:0 sc1
  buffer_load_dwordx4 v[184:187], v4, s[60:63], s11 offen offset:0 sc1
  buffer_load_dwordx4 v[188:191], v6, s[60:63], s11 offen offset:0 sc1
  buffer_load_dwordx4 v[192:195], v3, s[60:63], s11 offen offset:2048 sc1
  buffer_load_dwordx4 v[196:199], v4, s[60:63], s11 offen offset:2048 sc1
  buffer_load_dwordx4 v[200:203], v6, s[60:63], s11 offen offset:2048 sc1
  s_add_u32 s11, s11, 4096
  buffer_load_dwordx4 v[204:207], v3, s[60:63], s11 offen offset:0 sc1
  buffer_load_dwordx4 v[208:211], v4, s[60:63], s11 offen offset:0 sc1
  buffer_load_dwordx4 v[212:215], v6, s[60:63], s11 offen offset:0 sc1
  buffer_load_dwordx4 v[216:219], v3, s[60:63], s11 offen offset:2048 sc1
  buffer_load_dwordx4 v[220:223], v4, s[60:63], s11 offen offset:2048 sc1
  buffer_load_dwordx4 v[224:227], v6, s[60:63], s11 offen offset:2048 sc1
tl0_y:
  ds_read_b64_tr_b16 v[12:13], v252 offset:18432
  ds_read_b64_tr_b16 v[14:15], v252 offset:20736
  ds_read_b64_tr_b16 v[16:17], v252 offset:18464
  ds_read_b64_tr_b16 v[18:19], v252 offset:20768
  ds_read_b64_tr_b16 v[20:21], v252 offset:18496
  ds_read_b64_tr_b16 v[22:23], v252 offset:20800
  ds_read_b64_tr_b16 v[228:229], v252 offset:18528
  ds_read_b64_tr_b16 v[230:231], v252 offset:20832
  ds_read_b64_tr_b16 v[232:233], v252 offset:18560
  ds_read_b64_tr_b16 v[234:235], v252 offset:20864
  ds_read_b64_tr_b16 v[236:237], v252 offset:18592
  ds_read_b64_tr_b16 v[238:239], v252 offset:20896
  s_waitcnt vmcnt(9)
  s_waitcnt lgkmcnt(10)
  v_mfma_f32_16x16x32_bf16 v[64:67], v[12:15], v[180:183], v[64:67]
  ds_read_b64_tr_b16 v[240:241], v252 offset:18624
  v_mfma_f32_16x16x32_bf16 v[100:103], v[12:15], v[184:187], v[100:103]
  ds_read_b64_tr_b16 v[242:243], v252 offset:20928
  v_mfma_f32_16x16x32_bf16 v[136:139], v[12:15], v[188:191], v[136:139]
  s_waitcnt lgkmcnt(10)
  v_mfma_f32_16x16x32_bf16 v[68:71], v[16:19], v[180:183], v[68:71]
  ds_read_b64_tr_b16 v[12:13], v252 offset:18656
  v_mfma_f32_16x16x32_bf16 v[104:107], v[16:19], v[184:187], v[104:107]
  ds_read_b64_tr_b16 v[14:15], v252 offset:20960
  v_mfma_f32_16x16x32_bf16 v[140:143], v[16:19], v[188:191], v[140:143]
  s_waitcnt lgkmcnt(10)
  v_mfma_f32_16x16x32_bf16 v[72:75], v[20:23], v[180:183], v[72:75]
  ds_read_b64_tr_b16 v[16:17], v252 offset:18688
  v_mfma_f32_16x16x32_bf16 v[108:111], v[20:23], v[184:187], v[108:111]
  ds_read_b64_tr_b16 v[18:19], v252 offset:20992
  v_mfma_f32_16x16x32_bf16 v[144:147], v[20:23], v[188:191], v[144:147]
  s_waitcnt lgkmcnt(10)
  v_mfma_f32_16x16x32_bf16 v[76:79], v[228:231], v[180:183], v[76:79]
  ds_read_b64_tr_b16 v[20:21], v252 offset:32768
  v_mfma_f32_16x16x32_bf16 v[112:115], v[228:231], v[184:187], v[112:115]
  ds_read_b64_tr_b16 v[22:23], v252 offset:35072
  v_mfma_f32_16x16x32_bf16 v[148:151], v[228:231], v[188:191], v[148:151]
  s_waitcnt lgkmcnt(10)
  v_mfma_f32_16x16x32_bf16 v[80:83], v[232:235], v[180:183], v[80:83]
  ds_read_b64_tr_b16 v[228:229], v252 offset:32800
  v_mfma_f32_16x16x32_bf16 v[116:119], v[232:235], v[184:187], v[116:119]
  ds_read_b64_tr_b16 v[230:231], v252 offset:35104
  v_mfma_f32_16x16x32_bf16 v[152:155], v[232:235], v[188:191], v[152:155]
  s_waitcnt lgkmcnt(10)
  v_mfma_f32_16x16x32_bf16 v[84:87], v[236:239], v[180:183], v[84:87]
  ds_read_b64_tr_b16 v[232:233], v252 offset:32832
  v_mfma_f32_16x16x32_bf16 v[120:123], v[236:239], v[184:187], v[120:123]
  ds_read_b64_tr_b16 v[234:235], v252 offset:35136
  v_mfma_f32_16x16x32_bf16 v[156:159], v[236:239], v[188:191], v[156:159]
  s_waitcnt lgkmcnt(10)
  v_mfma_f32_16x16x32_bf16 v[88:91], v[240:243], v[180:183], v[88:91]
  ds_read_b64_tr_b16 v[236:237], v252 offset:32864
  v_mfma_f32_16x16x32_bf16 v[124:127], v[240:243], v[184:187], v[124:127]
  ds_read_b64_tr_b16 v[238:239], v252 offset:35168
  v_mfma_f32_16x16x32_bf16 v[160:163], v[240:243], v[188:191], v[160:163]
  s_waitcnt lgkmcnt(10)
  v_mfma_f32_16x16x32_bf16 v[92:95], v[12:15], v[180:183], v[92:95]
  ds_read_b64_tr_b16 v[240:241], v252 offset:32896
  v_mfma_f32_16x16x32_bf16 v[128:131], v[12:15], v[184:187], v[128:131]
  ds_read_b64_tr_b16 v[242:243], v252 offset:35200
  v_mfma_f32_16x16x32_bf16 v[164:167], v[12:15], v[188:191], v[164:167]
  s_waitcnt lgkmcnt(10)
  v_mfma_f32_16x16x32_bf16 v[96:99], v[16:19], v[180:183], v[96:99]
  ds_read_b64_tr_b16 v[12:13], v252 offset:32928
  v_mfma_f32_16x16x32_bf16 v[132:135], v[16:19], v[184:187], v[132:135]
  ds_read_b64_tr_b16 v[14:15], v252 offset:35232
  v_mfma_f32_16x16x32_bf16 v[168:171], v[16:19], v[188:191], v[168:171]
  s_waitcnt vmcnt(6)
  s_waitcnt lgkmcnt(10)
  v_mfma_f32_16x16x32_bf16 v[64:67], v[20:23], v[192:195], v[64:67]
  ds_read_b64_tr_b16 v[16:17], v252 offset:32960
  v_mfma_f32_16x16x32_bf16 v[100:103], v[20:23], v[196:199], v[100:103]
  ds_read_b64_tr_b16 v[18:19], v252 offset:35264
  v_mfma_f32_16x16x32_bf16 v[136:139], v[20:23], v[200:203], v[136:139]
  s_waitcnt lgkmcnt(10)
  v_mfma_f32_16x16x32_bf16 v[68:71], v[228:231], v[192:195], v[68:71]
  ds_read_b64_tr_b16 v[20:21], v252 offset:32992
  v_mfma_f32_16x16x32_bf16 v[104:107], v[228:231], v[196:199], v[104:107]
  ds_read_b64_tr_b16 v[22:23], v252 offset:35296
  v_mfma_f32_16x16x32_bf16 v[140:143], v[228:231], v[200:203], v[140:143]
  s_waitcnt lgkmcnt(10)
  v_mfma_f32_16x16x32_bf16 v[72:75], v[232:235], v[192:195], v[72:75]
  ds_read_b64_tr_b16 v[228:229], v252 offset:33024
  v_mfma_f32_16x16x32_bf16 v[108:111], v[232:235], v[196:199], v[108:111]
  ds_read_b64_tr_b16 v[230:231], v252 offset:35328
  v_mfma_f32_16x16x32_bf16 v[144:147], v[232:235], v[200:203], v[144:147]
  s_waitcnt lgkmcnt(10)
  v_mfma_f32_16x16x32_bf16 v[76:79], v[236:239], v[192:195], v[76:79]
  ds_read_b64_tr_b16 v[232:233], v252 offset:41984
  v_mfma_f32_16x16x32_bf16 v[112:115], v[236:239], v[196:199], v[112:115]
  ds_read_b64_tr_b16 v[234:235], v252 offset:44288
  v_mfma_f32_16x16x32_bf16 v[148:151], v[236:239], v[200:203], v[148:151]
  s_waitcnt lgkmcnt(10)
  v_mfma_f32_16x16x32_bf16 v[80:83], v[240:243], v[192:195], v[80:83]
  ds_read_b64_tr_b16 v[236:237], v252 offset:42016
  v_mfma_f32_16x16x32_bf16 v[116:119], v[240:243], v[196:199], v[116:119]
  ds_read_b64_tr_b16 v[238:239], v252 offset:44320
  v_mfma_f32_16x16x32_bf16 v[152:155], v[240:243], v[200:203], v[152:155]
  s_waitcnt lgkmcnt(10)
  v_mfma_f32_16x16x32_bf16 v[84:87], v[12:15], v[192:195], v[84:87]
  ds_read_b64_tr_b16 v[240:241], v252 offset:42048
  v_mfma_f32_16x16x32_bf16 v[120:123], v[12:15], v[196:199], v[120:123]
  ds_read_b64_tr_b16 v[242:243], v252 offset:44352
  v_mfma_f32_16x16x32_bf16 v[156:159], v[12:15], v[200:203], v[156:159]
  s_waitcnt lgkmcnt(10)
  v_mfma_f32_16x16x32_bf16 v[88:91], v[16:19], v[192:195], v[88:91]
  ds_read_b64_tr_b16 v[12:13], v252 offset:42080
  v_mfma_f32_16x16x32_bf16 v[124:127], v[16:19], v[196:199], v[124:127]
  ds_read_b64_tr_b16 v[14:15], v252 offset:44384
  v_mfma_f32_16x16x32_bf16 v[160:163], v[16:19], v[200:203], v[160:163]
  s_waitcnt lgkmcnt(10)
  v_mfma_f32_16x16x32_bf16 v[92:95], v[20:23], v[192:195], v[92:95]
  ds_read_b64_tr_b16 v[16:17], v252 offset:42112
  v_mfma_f32_16x16x32_bf16 v[128:131], v[20:23], v[196:199], v[128:131]
  ds_read_b64_tr_b16 v[18:19], v252 offset:44416
  v_mfma_f32_16x16x32_bf16 v[164:167], v[20:23], v[200:203], v[164:167]
  s_waitcnt lgkmcnt(10)
  v_mfma_f32_16x16x32_bf16 v[96:99], v[228:231], v[192:195], v[96:99]
  ds_read_b64_tr_b16 v[20:21], v252 offset:42144
  v_mfma_f32_16x16x32_bf16 v[132:135], v[228:231], v[196:199], v[132:135]
  ds_read_b64_tr_b16 v[22:23], v252 offset:44448
  v_mfma_f32_16x16x32_bf16 v[168:171], v[228:231], v[200:203], v[168:171]
  s_waitcnt vmcnt(3)
  s_waitcnt lgkmcnt(10)
  v_mfma_f32_16x16x32_bf16 v[64:67], v[232:235], v[204:207], v[64:67]
  ds_read_b64_tr_b16 v[228:229], v252 offset:42176
  v_mfma_f32_16x16x32_bf16 v[100:103], v[232:235], v[208:211], v[100:103]
  ds_read_b64_tr_b16 v[230:231], v252 offset:44480
  v_mfma_f32_16x16x32_bf16 v[136:139], v[232:235], v[212:215], v[136:139]
  s_waitcnt lgkmcnt(10)
  v_mfma_f32_16x16x32_bf16 v[68:71], v[236:239], v[204:207], v[68:71]
  ds_read_b64_tr_b16 v[232:233], v252 offset:42208
  v_mfma_f32_16x16x32_bf16 v[104:107], v[236:239], v[208:211], v[104:107]
  ds_read_b64_tr_b16 v[234:235], v252 offset:44512
  v_mfma_f32_16x16x32_bf16 v[140:143], v[236:239], v[212:215], v[140:143]
  s_waitcnt lgkmcnt(10)
  v_mfma_f32_16x16x32_bf16 v[72:75], v[240:243], v[204:207], v[72:75]
  ds_read_b64_tr_b16 v[236:237], v252 offset:42240
  v_mfma_f32_16x16x32_bf16 v[108:111], v[240:243], v[208:211], v[108:111]
  ds_read_b64_tr_b16 v[238:239], v252 offset:44544
  v_mfma_f32_16x16x32_bf16 v[144:147], v[240:243], v[212:215], v[144:147]
  s_waitcnt lgkmcnt(10)
  v_mfma_f32_16x16x32_bf16 v[76:79], v[12:15], v[204:207], v[76:79]
  ds_read_b64_tr_b16 v[240:241], v252 offset:51200
  v_mfma_f32_16x16x32_bf16 v[112:115], v[12:15], v[208:211], v[112:115]
  ds_read_b64_tr_b16 v[242:243], v252 offset:53504
  v_mfma_f32_16x16x32_bf16 v[148:151], v[12:15], v[212:215], v[148:151]
  s_waitcnt lgkmcnt(10)
  v_mfma_f32_16x16x32_bf16 v[80:83], v[16:19], v[204:207], v[80:83]
  ds_read_b64_tr_b16 v[12:13], v252 offset:51232
  v_mfma_f32_16x16x32_bf16 v[116:119], v[16:19], v[208:211], v[116:119]
  ds_read_b64_tr_b16 v[14:15], v252 offset:53536
  v_mfma_f32_16x16x32_bf16 v[152:155], v[16:19], v[212:215], v[152:155]
  s_waitcnt lgkmcnt(10)
  v_mfma_f32_16x16x32_bf16 v[84:87], v[20:23], v[204:207], v[84:87]
  ds_read_b64_tr_b16 v[16:17], v252 offset:51264
  v_mfma_f32_16x16x32_bf16 v[120:123], v[20:23], v[208:211], v[120:123]
  ds_read_b64_tr_b16 v[18:19], v252 offset:53568
  v_mfma_f32_16x16x32_bf16 v[156:159], v[20:23], v[212:215], v[156:159]
  s_waitcnt lgkmcnt(10)
  v_mfma_f32_16x16x32_bf16 v[88:91], v[228:231], v[204:207], v[88:91]
  ds_read_b64_tr_b16 v[20:21], v252 offset:51296
  v_mfma_f32_16x16x32_bf16 v[124:127], v[228:231], v[208:211], v[124:127]
  ds_read_b64_tr_b16 v[22:23], v252 offset:53600
  v_mfma_f32_16x16x32_bf16 v[160:163], v[228:231], v[212:215], v[160:163]
  s_waitcnt lgkmcnt(10)
  v_mfma_f32_16x16x32_bf16 v[92:95], v[232:235], v[204:207], v[92:95]
  ds_read_b64_tr_b16 v[228:229], v252 offset:51328
  v_mfma_f32_16x16x32_bf16 v[128:131], v[232:235], v[208:211], v[128:131]
  ds_read_b64_tr_b16 v[230:231], v252 offset:53632
  v_mfma_f32_16x16x32_bf16 v[164:167], v[232:235], v[212:215], v[164:167]
  s_waitcnt lgkmcnt(10)
  v_mfma_f32_16x16x32_bf16 v[96:99], v[236:239], v[204:207], v[96:99]
  ds_read_b64_tr_b16 v[232:233], v252 offset:51360
  v_mfma_f32_16x16x32_bf16 v[132:135], v[236:239], v[208:211], v[132:135]
  ds_read_b64_tr_b16 v[234:235], v252 offset:53664
  v_mfma_f32_16x16x32_bf16 v[168:171], v[236:239], v[212:215], v[168:171]
  s_waitcnt vmcnt(0)
  s_waitcnt lgkmcnt(10)
  v_mfma_f32_16x16x32_bf16 v[100:103], v[240:243], v[220:223], v[100:103]
  ds_read_b64_tr_b16 v[238:239], v252 offset:53696
  v_mfma_f32_16x16x32_bf16 v[136:139], v[240:243], v[224:227], v[136:139]
  v_mfma_f32_16x16x32_bf16 v[64:67], v[240:243], v[216:219], v[64:67]
  ds_read_b64_tr_b16 v[236:237], v252 offset:51392
  s_waitcnt lgkmcnt(10)
  v_mfma_f32_16x16x32_bf16 v[104:107], v[12:15], v[220:223], v[104:107]
  ds_read_b64_tr_b16 v[242:243], v252 offset:53728
  v_mfma_f32_16x16x32_bf16 v[140:143], v[12:15], v[224:227], v[140:143]
  v_mfma_f32_16x16x32_bf16 v[68:71], v[12:15], v[216:219], v[68:71]
  ds_read_b64_tr_b16 v[240:241], v252 offset:51424
  s_waitcnt lgkmcnt(10)
  v_mfma_f32_16x16x32_bf16 v[108:111], v[16:19], v[220:223], v[108:111]
  ds_read_b64_tr_b16 v[14:15], v252 offset:53760
  v_mfma_f32_16x16x32_bf16 v[144:147], v[16:19], v[224:227], v[144:147]
  v_mfma_f32_16x16x32_bf16 v[72:75], v[16:19], v[216:219], v[72:75]
  ds_read_b64_tr_b16 v[12:13], v252 offset:51456
  v_cvt_pk_bf16_f32 v24, v100, v101
  v_cvt_pk_bf16_f32 v25, v102, v103
  v_cvt_pk_bf16_f32 v44, v136, v137
  v_cvt_pk_bf16_f32 v45, v138, v139
  s_waitcnt lgkmcnt(10)
  v_mfma_f32_16x16x32_bf16 v[112:115], v[20:23], v[220:223], v[112:115]
  v_mfma_f32_16x16x32_bf16 v[148:151], v[20:23], v[224:227], v[148:151]
  v_mfma_f32_16x16x32_bf16 v[76:79], v[20:23], v[216:219], v[76:79]
  v_cvt_pk_bf16_f32 v26, v104, v105
  v_cvt_pk_bf16_f32 v27, v106, v107
  v_cvt_pk_bf16_f32 v46, v140, v141
  v_cvt_pk_bf16_f32 v47, v142, v143
  ds_write_b128 v8, v[24:27] offset:0
  ds_write_b128 v9, v[44:47] offset:0
  s_waitcnt lgkmcnt(10)
  v_mfma_f32_16x16x32_bf16 v[116:119], v[228:231], v[220:223], v[116:119]
  v_mfma_f32_16x16x32_bf16 v[152:155], v[228:231], v[224:227], v[152:155]
  v_mfma_f32_16x16x32_bf16 v[80:83], v[228:231], v[216:219], v[80:83]
  v_cvt_pk_bf16_f32 v28, v108, v109
  v_cvt_pk_bf16_f32 v29, v110, v111
  v_cvt_pk_bf16_f32 v48, v144, v145
  v_cvt_pk_bf16_f32 v49, v146, v147
  s_waitcnt lgkmcnt(8)
  v_mfma_f32_16x16x32_bf16 v[120:123], v[232:235], v[220:223], v[120:123]
  v_mfma_f32_16x16x32_bf16 v[156:159], v[232:235], v[224:227], v[156:159]
  v_mfma_f32_16x16x32_bf16 v[84:87], v[232:235], v[216:219], v[84:87]
  v_cvt_pk_bf16_f32 v30, v112, v113
  v_cvt_pk_bf16_f32 v31, v114, v115
  v_cvt_pk_bf16_f32 v50, v148, v149
  v_cvt_pk_bf16_f32 v51, v150, v151
  ds_write_b128 v8, v[28:31] offset:1024
  ds_write_b128 v9, v[48:51] offset:1024
  s_waitcnt lgkmcnt(8)
  v_mfma_f32_16x16x32_bf16 v[124:127], v[236:239], v[220:223], v[124:127]
  v_mfma_f32_16x16x32_bf16 v[160:163], v[236:239], v[224:227], v[160:163]
  v_mfma_f32_16x16x32_bf16 v[88:91], v[236:239], v[216:219], v[88:91]
  v_cvt_pk_bf16_f32 v32, v116, v117
  v_cvt_pk_bf16_f32 v33, v118, v119
  v_cvt_pk_bf16_f32 v52, v152, v153
  v_cvt_pk_bf16_f32 v53, v154, v155
  s_waitcnt lgkmcnt(6)
  v_mfma_f32_16x16x32_bf16 v[128:131], v[240:243], v[220:223], v[128:131]
  v_mfma_f32_16x16x32_bf16 v[164:167], v[240:243], v[224:227], v[164:167]
  v_mfma_f32_16x16x32_bf16 v[92:95], v[240:243], v[216:219], v[92:95]
  v_cvt_pk_bf16_f32 v34, v120, v121
  v_cvt_pk_bf16_f32 v35, v122, v123
  v_cvt_pk_bf16_f32 v54, v156, v157
  v_cvt_pk_bf16_f32 v55, v158, v159
  ds_write_b128 v8, v[32:35] offset:2048
  ds_write_b128 v9, v[52:55] offset:2048
  s_waitcnt lgkmcnt(6)
  v_mfma_f32_16x16x32_bf16 v[132:135], v[12:15], v[220:223], v[132:135]
  v_mfma_f32_16x16x32_bf16 v[168:171], v[12:15], v[224:227], v[168:171]
  v_mfma_f32_16x16x32_bf16 v[96:99], v[12:15], v[216:219], v[96:99]
  v_cvt_pk_bf16_f32 v36, v124, v125
  v_cvt_pk_bf16_f32 v37, v126, v127
  v_cvt_pk_bf16_f32 v56, v160, v161
  v_cvt_pk_bf16_f32 v57, v162, v163
  v_cvt_pk_bf16_f32 v38, v128, v129
  v_cvt_pk_bf16_f32 v39, v130, v131
  v_cvt_pk_bf16_f32 v58, v164, v165
  v_cvt_pk_bf16_f32 v59, v166, v167
  ds_write_b128 v8, v[36:39] offset:3072
  ds_write_b128 v9, v[56:59] offset:3072
  s_nop 2
  v_cvt_pk_bf16_f32 v40, v132, v133
  v_cvt_pk_bf16_f32 v41, v134, v135
  v_cvt_pk_bf16_f32 v60, v168, v169
  v_cvt_pk_bf16_f32 v61, v170, v171
  ds_write_b128 v8, v[40:43] offset:4096
  ds_write_b128 v9, v[60:63] offset:4096
  s_branch at_xch
at_r1:
  buffer_load_dword v11, v1, s[60:63], 0 offen sc1
  ds_read_b64_tr_b16 v[12:13], v254 offset:13312
  ds_read_b64_tr_b16 v[14:15], v254 offset:15616
  ds_read_b64_tr_b16 v[16:17], v254 offset:13344
  ds_read_b64_tr_b16 v[18:19], v254 offset:15648
  ds_read_b64_tr_b16 v[20:21], v254 offset:13376
  ds_read_b64_tr_b16 v[22:23], v254 offset:15680
  ds_read_b64_tr_b16 v[228:229], v254 offset:13408
  ds_read_b64_tr_b16 v[230:231], v254 offset:15712
  s_waitcnt vmcnt(14)
  s_waitcnt lgkmcnt(6)
  v_mfma_f32_16x16x32_bf16 v[64:67], v[12:15], v[24:27], 0
  ds_read_b64_tr_b16 v[232:233], v254 offset:13440
  v_mfma_f32_16x16x32_bf16 v[100:103], v[12:15], v[28:31], 0
  ds_read_b64_tr_b16 v[234:235], v254 offset:15744
  v_mfma_f32_16x16x32_bf16 v[136:139], v[12:15], v[32:35], 0
  s_waitcnt lgkmcnt(6)
  v_mfma_f32_16x16x32_bf16 v[68:71], v[16:19], v[24:27], 0
  ds_read_b64_tr_b16 v[12:13], v254 offset:13472
  v_mfma_f32_16x16x32_bf16 v[104:107], v[16:19], v[28:31], 0
  ds_read_b64_tr_b16 v[14:15], v254 offset:15776
  v_mfma_f32_16x16x32_bf16 v[140:143], v[16:19], v[32:35], 0
  s_waitcnt lgkmcnt(6)
  v_mfma_f32_16x16x32_bf16 v[72:75], v[20:23], v[24:27], 0
  ds_read_b64_tr_b16 v[16:17], v254 offset:13504
  v_mfma_f32_16x16x32_bf16 v[108:111], v[20:23], v[28:31], 0
  ds_read_b64_tr_b16 v[18:19], v254 offset:15808
  v_mfma_f32_16x16x32_bf16 v[144:147], v[20:23], v[32:35], 0
  s_waitcnt lgkmcnt(6)
  v_mfma_f32_16x16x32_bf16 v[76:79], v[228:231], v[24:27], 0
  ds_read_b64_tr_b16 v[20:21], v254 offset:13536
  v_mfma_f32_16x16x32_bf16 v[112:115], v[228:231], v[28:31], 0
  ds_read_b64_tr_b16 v[22:23], v254 offset:15840
  v_mfma_f32_16x16x32_bf16 v[148:151], v[228:231], v[32:35], 0
  s_waitcnt lgkmcnt(6)
  v_mfma_f32_16x16x32_bf16 v[80:83], v[232:235], v[24:27], 0
  ds_read_b64_tr_b16 v[228:229], v254 offset:13568
  v_mfma_f32_16x16x32_bf16 v[116:119], v[232:235], v[28:31], 0
  ds_read_b64_tr_b16 v[230:231], v254 offset:15872
  v_mfma_f32_16x16x32_bf16 v[152:155], v[232:235], v[32:35], 0
  s_waitcnt lgkmcnt(6)
  v_mfma_f32_16x16x32_bf16 v[84:87], v[12:15], v[24:27], 0
  ds_read_b64_tr_b16 v[232:233], v254 offset:22528
  v_mfma_f32_16x16x32_bf16 v[120:123], v[12:15], v[28:31], 0
  ds_read_b64_tr_b16 v[234:235], v254 offset:24832
  v_mfma_f32_16x16x32_bf16 v[156:159], v[12:15], v[32:35], 0
  s_waitcnt lgkmcnt(6)
  v_mfma_f32_16x16x32_bf16 v[88:91], v[16:19], v[24:27], 0
  ds_read_b64_tr_b16 v[12:13], v254 offset:22560
  v_mfma_f32_16x16x32_bf16 v[124:127], v[16:19], v[28:31], 0
  ds_read_b64_tr_b16 v[14:15], v254 offset:24864
  v_mfma_f32_16x16x32_bf16 v[160:163], v[16:19], v[32:35], 0
  s_waitcnt lgkmcnt(6)
  v_mfma_f32_16x16x32_bf16 v[92:95], v[20:23], v[24:27], 0
  ds_read_b64_tr_b16 v[16:17], v254 offset:22592
  v_mfma_f32_16x16x32_bf16 v[128:131], v[20:23], v[28:31], 0
  ds_read_b64_tr_b16 v[18:19], v254 offset:24896
  v_mfma_f32_16x16x32_bf16 v[164:167], v[20:23], v[32:35], 0
  s_waitcnt lgkmcnt(6)
  v_mfma_f32_16x16x32_bf16 v[96:99], v[228:231], v[24:27], 0
  ds_read_b64_tr_b16 v[20:21], v254 offset:22624
  v_mfma_f32_16x16x32_bf16 v[132:135], v[228:231], v[28:31], 0
  ds_read_b64_tr_b16 v[22:23], v254 offset:24928
  v_mfma_f32_16x16x32_bf16 v[168:171], v[228:231], v[32:35], 0
  s_barrier
  s_waitcnt vmcnt(11)
  s_waitcnt lgkmcnt(6)
  v_mfma_f32_16x16x32_bf16 v[64:67], v[232:235], v[36:39], v[64:67]
  ds_read_b64_tr_b16 v[228:229], v254 offset:22656
  v_mfma_f32_16x16x32_bf16 v[100:103], v[232:235], v[40:43], v[100:103]
  ds_read_b64_tr_b16 v[230:231], v254 offset:24960
  v_mfma_f32_16x16x32_bf16 v[136:139], v[232:235], v[44:47], v[136:139]
  s_waitcnt lgkmcnt(6)
  v_mfma_f32_16x16x32_bf16 v[68:71], v[12:15], v[36:39], v[68:71]
  ds_read_b64_tr_b16 v[232:233], v254 offset:22688
  v_mfma_f32_16x16x32_bf16 v[104:107], v[12:15], v[40:43], v[104:107]
  ds_read_b64_tr_b16 v[234:235], v254 offset:24992
  v_mfma_f32_16x16x32_bf16 v[140:143], v[12:15], v[44:47], v[140:143]
  s_waitcnt lgkmcnt(6)
  v_mfma_f32_16x16x32_bf16 v[72:75], v[16:19], v[36:39], v[72:75]
  ds_read_b64_tr_b16 v[12:13], v254 offset:22720
  v_mfma_f32_16x16x32_bf16 v[108:111], v[16:19], v[40:43], v[108:111]
  ds_read_b64_tr_b16 v[14:15], v254 offset:25024
  v_mfma_f32_16x16x32_bf16 v[144:147], v[16:19], v[44:47], v[144:147]
  s_waitcnt lgkmcnt(6)
  v_mfma_f32_16x16x32_bf16 v[76:79], v[20:23], v[36:39], v[76:79]
  ds_read_b64_tr_b16 v[16:17], v254 offset:22752
  v_mfma_f32_16x16x32_bf16 v[112:115], v[20:23], v[40:43], v[112:115]
  ds_read_b64_tr_b16 v[18:19], v254 offset:25056
  v_mfma_f32_16x16x32_bf16 v[148:151], v[20:23], v[44:47], v[148:151]
  s_waitcnt lgkmcnt(6)
  v_mfma_f32_16x16x32_bf16 v[80:83], v[228:231], v[36:39], v[80:83]
  ds_read_b64_tr_b16 v[20:21], v254 offset:22784
  v_mfma_f32_16x16x32_bf16 v[116:119], v[228:231], v[40:43], v[116:119]
  ds_read_b64_tr_b16 v[22:23], v254 offset:25088
  v_mfma_f32_16x16x32_bf16 v[152:155], v[228:231], v[44:47], v[152:155]
  s_waitcnt lgkmcnt(6)
  v_mfma_f32_16x16x32_bf16 v[84:87], v[232:235], v[36:39], v[84:87]
  v_mfma_f32_16x16x32_bf16 v[120:123], v[232:235], v[40:43], v[120:123]
  v_mfma_f32_16x16x32_bf16 v[156:159], v[232:235], v[44:47], v[156:159]
  s_waitcnt lgkmcnt(4)
  v_mfma_f32_16x16x32_bf16 v[88:91], v[12:15], v[36:39], v[88:91]
  v_mfma_f32_16x16x32_bf16 v[124:127], v[12:15], v[40:43], v[124:127]
  v_mfma_f32_16x16x32_bf16 v[160:163], v[12:15], v[44:47], v[160:163]
  s_waitcnt lgkmcnt(2)
  v_mfma_f32_16x16x32_bf16 v[92:95], v[16:19], v[36:39], v[92:95]
  v_mfma_f32_16x16x32_bf16 v[128:131], v[16:19], v[40:43], v[128:131]
  v_mfma_f32_16x16x32_bf16 v[164:167], v[16:19], v[44:47], v[164:167]
  s_waitcnt lgkmcnt(0)
  v_mfma_f32_16x16x32_bf16 v[96:99], v[20:23], v[36:39], v[96:99]
  v_mfma_f32_16x16x32_bf16 v[132:135], v[20:23], v[40:43], v[132:135]
  v_mfma_f32_16x16x32_bf16 v[168:171], v[20:23], v[44:47], v[168:171]
  s_waitcnt vmcnt(0)
  s_mov_b64 exec, 1
  buffer_store_dword v2, off, s[60:63], s101 offset:128 sc1
  s_mov_b64 exec, -1
  v_cmp_ne_u32 vcc, 1, v11
  s_cmp_eq_u64 vcc, 0
  s_cselect_b32 s89, 1, 0
  s_barrier
  s_cmp_eq_u32 s89, 0
  s_cbranch_scc1 tl1_n1
  s_add_u32 s12, s100, 2
  s_and_b32 s12, s12, 3
  s_mul_i32 s11, s12, 24576
  s_add_u32 s11, s11, s93
  buffer_load_dwordx4 v[180:183], v3, s[60:63], s11 offen offset:0 sc1
  buffer_load_dwordx4 v[184:187], v4, s[60:63], s11 offen offset:0 sc1
  buffer_load_dwordx4 v[188:191], v6, s[60:63], s11 offen offset:0 sc1
  buffer_load_dwordx4 v[192:195], v3, s[60:63], s11 offen offset:2048 sc1
  buffer_load_dwordx4 v[196:199], v4, s[60:63], s11 offen offset:2048 sc1
  buffer_load_dwordx4 v[200:203], v6, s[60:63], s11 offen offset:2048 sc1
  s_add_u32 s11, s11, 4096
  buffer_load_dwordx4 v[204:207], v3, s[60:63], s11 offen offset:0 sc1
  buffer_load_dwordx4 v[208:211], v4, s[60:63], s11 offen offset:0 sc1
  buffer_load_dwordx4 v[212:215], v6, s[60:63], s11 offen offset:0 sc1
  buffer_load_dwordx4 v[216:219], v3, s[60:63], s11 offen offset:2048 sc1
  buffer_load_dwordx4 v[220:223], v4, s[60:63], s11 offen offset:2048 sc1
  buffer_load_dwordx4 v[224:227], v6, s[60:63], s11 offen offset:2048 sc1
tl1_n1:
  ds_read_b64_tr_b16 v[12:13], v254 offset:31744
  ds_read_b64_tr_b16 v[14:15], v254 offset:34048
  ds_read_b64_tr_b16 v[16:17], v254 offset:31776
  ds_read_b64_tr_b16 v[18:19], v254 offset:34080
  ds_read_b64_tr_b16 v[20:21], v254 offset:31808
  ds_read_b64_tr_b16 v[22:23], v254 offset:34112
  ds_read_b64_tr_b16 v[228:229], v254 offset:31840
  ds_read_b64_tr_b16 v[230:231], v254 offset:34144
  ds_read_b64_tr_b16 v[232:233], v254 offset:31872
  ds_read_b64_tr_b16 v[234:235], v254 offset:34176
  ds_read_b64_tr_b16 v[236:237], v254 offset:31904
  ds_read_b64_tr_b16 v[238:239], v254 offset:34208
  s_waitcnt lgkmcnt(10)
  v_mfma_f32_16x16x32_bf16 v[64:67], v[12:15], v[48:51], v[64:67]
  ds_read_b64_tr_b16 v[240:241], v254 offset:31936
  v_mfma_f32_16x16x32_bf16 v[100:103], v[12:15], v[52:55], v[100:103]
  ds_read_b64_tr_b16 v[242:243], v254 offset:34240
  v_mfma_f32_16x16x32_bf16 v[136:139], v[12:15], v[56:59], v[136:139]
  s_waitcnt lgkmcnt(10)
  v_mfma_f32_16x16x32_bf16 v[68:71], v[16:19], v[48:51], v[68:71]
  ds_read_b64_tr_b16 v[12:13], v254 offset:31968
  v_mfma_f32_16x16x32_bf16 v[104:107], v[16:19], v[52:55], v[104:107]
  ds_read_b64_tr_b16 v[14:15], v254 offset:34272
  v_mfma_f32_16x16x32_bf16 v[140:143], v[16:19], v[56:59], v[140:143]
  s_waitcnt lgkmcnt(10)
  v_mfma_f32_16x16x32_bf16 v[72:75], v[20:23], v[48:51], v[72:75]
  ds_read_b64_tr_b16 v[16:17], v254 offset:32000
  v_mfma_f32_16x16x32_bf16 v[108:111], v[20:23], v[52:55], v[108:111]
  ds_read_b64_tr_b16 v[18:19], v254 offset:34304
  v_mfma_f32_16x16x32_bf16 v[144:147], v[20:23], v[56:59], v[144:147]
  s_waitcnt lgkmcnt(10)
  v_mfma_f32_16x16x32_bf16 v[76:79], v[228:231], v[48:51], v[76:79]
  ds_read_b64_tr_b16 v[20:21], v253 offset:0
  v_mfma_f32_16x16x32_bf16 v[112:115], v[228:231], v[52:55], v[112:115]
  ds_read_b64_tr_b16 v[22:23], v253 offset:2304
  v_mfma_f32_16x16x32_bf16 v[148:151], v[228:231], v[56:59], v[148:151]
  s_waitcnt lgkmcnt(10)
  v_mfma_f32_16x16x32_bf16 v[80:83], v[232:235], v[48:51], v[80:83]
  ds_read_b64_tr_b16 v[228:229], v253 offset:32
  v_mfma_f32_16x16x32_bf16 v[116:119], v[232:235], v[52:55], v[116:119]
  ds_read_b64_tr_b16 v[230:231], v253 offset:2336
  v_mfma_f32_16x16x32_bf16 v[152:155], v[232:235], v[56:59], v[152:155]
  s_waitcnt lgkmcnt(10)
  v_mfma_f32_16x16x32_bf16 v[84:87], v[236:239], v[48:51], v[84:87]
  ds_read_b64_tr_b16 v[232:233], v253 offset:64
  v_mfma_f32_16x16x32_bf16 v[120:123], v[236:239], v[52:55], v[120:123]
  ds_read_b64_tr_b16 v[234:235], v253 offset:2368
  v_mfma_f32_16x16x32_bf16 v[156:159], v[236:239], v[56:59], v[156:159]
  s_waitcnt lgkmcnt(10)
  v_mfma_f32_16x16x32_bf16 v[88:91], v[240:243], v[48:51], v[88:91]
  ds_read_b64_tr_b16 v[236:237], v253 offset:96
  v_mfma_f32_16x16x32_bf16 v[124:127], v[240:243], v[52:55], v[124:127]
  ds_read_b64_tr_b16 v[238:239], v253 offset:2400
  v_mfma_f32_16x16x32_bf16 v[160:163], v[240:243], v[56:59], v[160:163]
  s_waitcnt lgkmcnt(10)
  v_mfma_f32_16x16x32_bf16 v[92:95], v[12:15], v[48:51], v[92:95]
  ds_read_b64_tr_b16 v[240:241], v253 offset:128
  v_mfma_f32_16x16x32_bf16 v[128:131], v[12:15], v[52:55], v[128:131]
  ds_read_b64_tr_b16 v[242:243], v253 offset:2432
  v_mfma_f32_16x16x32_bf16 v[164:167], v[12:15], v[56:59], v[164:167]
  s_waitcnt lgkmcnt(10)
  v_mfma_f32_16x16x32_bf16 v[96:99], v[16:19], v[48:51], v[96:99]
  ds_read_b64_tr_b16 v[12:13], v253 offset:160
  v_mfma_f32_16x16x32_bf16 v[132:135], v[16:19], v[52:55], v[132:135]
  ds_read_b64_tr_b16 v[14:15], v253 offset:2464
  v_mfma_f32_16x16x32_bf16 v[168:171], v[16:19], v[56:59], v[168:171]
  s_waitcnt lgkmcnt(10)
  v_mfma_f32_16x16x32_bf16 v[64:67], v[20:23], v[60:63], v[64:67]
  ds_read_b64_tr_b16 v[16:17], v253 offset:192
  v_mfma_f32_16x16x32_bf16 v[100:103], v[20:23], v[172:175], v[100:103]
  ds_read_b64_tr_b16 v[18:19], v253 offset:2496
  v_mfma_f32_16x16x32_bf16 v[136:139], v[20:23], v[176:179], v[136:139]
  s_waitcnt lgkmcnt(10)
  v_mfma_f32_16x16x32_bf16 v[68:71], v[228:231], v[60:63], v[68:71]
  ds_read_b64_tr_b16 v[20:21], v253 offset:224
  v_mfma_f32_16x16x32_bf16 v[104:107], v[228:231], v[172:175], v[104:107]
  ds_read_b64_tr_b16 v[22:23], v253 offset:2528
  v_mfma_f32_16x16x32_bf16 v[140:143], v[228:231], v[176:179], v[140:143]
  s_waitcnt lgkmcnt(10)
  v_mfma_f32_16x16x32_bf16 v[72:75], v[232:235], v[60:63], v[72:75]
  ds_read_b64_tr_b16 v[228:229], v253 offset:256
  v_mfma_f32_16x16x32_bf16 v[108:111], v[232:235], v[172:175], v[108:111]
  ds_read_b64_tr_b16 v[230:231], v253 offset:2560
  v_mfma_f32_16x16x32_bf16 v[144:147], v[232:235], v[176:179], v[144:147]
  s_waitcnt lgkmcnt(10)
  v_mfma_f32_16x16x32_bf16 v[76:79], v[236:239], v[60:63], v[76:79]
  v_mfma_f32_16x16x32_bf16 v[112:115], v[236:239], v[172:175], v[112:115]
  v_mfma_f32_16x16x32_bf16 v[148:151], v[236:239], v[176:179], v[148:151]
  s_waitcnt lgkmcnt(8)
  v_mfma_f32_16x16x32_bf16 v[80:83], v[240:243], v[60:63], v[80:83]
  v_mfma_f32_16x16x32_bf16 v[116:119], v[240:243], v[172:175], v[116:119]
  v_mfma_f32_16x16x32_bf16 v[152:155], v[240:243], v[176:179], v[152:155]
  s_waitcnt lgkmcnt(6)
  v_mfma_f32_16x16x32_bf16 v[84:87], v[12:15], v[60:63], v[84:87]
  v_mfma_f32_16x16x32_bf16 v[120:123], v[12:15], v[172:175], v[120:123]
  v_mfma_f32_16x16x32_bf16 v[156:159], v[12:15], v[176:179], v[156:159]
  s_waitcnt lgkmcnt(4)
  v_mfma_f32_16x16x32_bf16 v[88:91], v[16:19], v[60:63], v[88:91]
  v_mfma_f32_16x16x32_bf16 v[124:127], v[16:19], v[172:175], v[124:127]
  v_mfma_f32_16x16x32_bf16 v[160:163], v[16:19], v[176:179], v[160:163]
  s_waitcnt lgkmcnt(2)
  v_mfma_f32_16x16x32_bf16 v[92:95], v[20:23], v[60:63], v[92:95]
  v_mfma_f32_16x16x32_bf16 v[128:131], v[20:23], v[172:175], v[128:131]
  v_mfma_f32_16x16x32_bf16 v[164:167], v[20:23], v[176:179], v[164:167]
  s_waitcnt lgkmcnt(0)
  v_mfma_f32_16x16x32_bf16 v[96:99], v[228:231], v[60:63], v[96:99]
  v_mfma_f32_16x16x32_bf16 v[132:135], v[228:231], v[172:175], v[132:135]
  v_mfma_f32_16x16x32_bf16 v[168:171], v[228:231], v[176:179], v[168:171]
  s_barrier
  s_cmp_lg_u32 s89, 0
  s_cbranch_scc1 tl1_y
  s_mov_b32 s43, 0
tl1_f2_spin:
  buffer_load_dword v11, v1, s[60:63], 0 offen sc1
  s_waitcnt vmcnt(0)
  v_cmp_ne_u32 vcc, 1, v11
  s_cbranch_vccz tl1_f2_ok
  s_add_u32 s43, s43, 1
  s_cmp_lt_u32 s43, 65536
  s_cbranch_scc1 tl1_f2_spin
tl1_f2_ok:
  s_add_u32 s12, s100, 2
  s_and_b32 s12, s12, 3
  s_mul_i32 s11, s12, 24576
  s_add_u32 s11, s11, s93
  buffer_load_dwordx4 v[180:183], v3, s[60:63], s11 offen offset:0 sc1
  buffer_load_dwordx4 v[184:187], v4, s[60:63], s11 offen offset:0 sc1
  buffer_load_dwordx4 v[188:191], v6, s[60:63], s11 offen offset:0 sc1
  buffer_load_dwordx4 v[192:195], v3, s[60:63], s11 offen offset:2048 sc1
  buffer_load_dwordx4 v[196:199], v4, s[60:63], s11 offen offset:2048 sc1
  buffer_load_dwordx4 v[200:203], v6, s[60:63], s11 offen offset:2048 sc1
  s_add_u32 s11, s11, 4096
  buffer_load_dwordx4 v[204:207], v3, s[60:63], s11 offen offset:0 sc1
  buffer_load_dwordx4 v[208:211], v4, s[60:63], s11 offen offset:0 sc1
  buffer_load_dwordx4 v[212:215], v6, s[60:63], s11 offen offset:0 sc1
  buffer_load_dwordx4 v[216:219], v3, s[60:63], s11 offen offset:2048 sc1
  buffer_load_dwordx4 v[220:223], v4, s[60:63], s11 offen offset:2048 sc1
  buffer_load_dwordx4 v[224:227], v6, s[60:63], s11 offen offset:2048 sc1
tl1_y:
  ds_read_b64_tr_b16 v[12:13], v254 offset:13312
  ds_read_b64_tr_b16 v[14:15], v254 offset:15616
  ds_read_b64_tr_b16 v[16:17], v254 offset:13344
  ds_read_b64_tr_b16 v[18:19], v254 offset:15648
  ds_read_b64_tr_b16 v[20:21], v254 offset:13376
  ds_read_b64_tr_b16 v[22:23], v254 offset:15680
  ds_read_b64_tr_b16 v[228:229], v254 offset:13408
  ds_read_b64_tr_b16 v[230:231], v254 offset:15712
  ds_read_b64_tr_b16 v[232:233], v254 offset:13440
  ds_read_b64_tr_b16 v[234:235], v254 offset:15744
  ds_read_b64_tr_b16 v[236:237], v254 offset:13472
  ds_read_b64_tr_b16 v[238:239], v254 offset:15776
  s_waitcnt vmcnt(9)
  s_waitcnt lgkmcnt(10)
  v_mfma_f32_16x16x32_bf16 v[64:67], v[12:15], v[180:183], v[64:67]
  ds_read_b64_tr_b16 v[240:241], v254 offset:13504
  v_mfma_f32_16x16x32_bf16 v[100:103], v[12:15], v[184:187], v[100:103]
  ds_read_b64_tr_b16 v[242:243], v254 offset:15808
  v_mfma_f32_16x16x32_bf16 v[136:139], v[12:15], v[188:191], v[136:139]
  s_waitcnt lgkmcnt(10)
  v_mfma_f32_16x16x32_bf16 v[68:71], v[16:19], v[180:183], v[68:71]
  ds_read_b64_tr_b16 v[12:13], v254 offset:13536
  v_mfma_f32_16x16x32_bf16 v[104:107], v[16:19], v[184:187], v[104:107]
  ds_read_b64_tr_b16 v[14:15], v254 offset:15840
  v_mfma_f32_16x16x32_bf16 v[140:143], v[16:19], v[188:191], v[140:143]
  s_waitcnt lgkmcnt(10)
  v_mfma_f32_16x16x32_bf16 v[72:75], v[20:23], v[180:183], v[72:75]
  ds_read_b64_tr_b16 v[16:17], v254 offset:13568
  v_mfma_f32_16x16x32_bf16 v[108:111], v[20:23], v[184:187], v[108:111]
  ds_read_b64_tr_b16 v[18:19], v254 offset:15872
  v_mfma_f32_16x16x32_bf16 v[144:147], v[20:23], v[188:191], v[144:147]
  s_waitcnt lgkmcnt(10)
  v_mfma_f32_16x16x32_bf16 v[76:79], v[228:231], v[180:183], v[76:79]
  ds_read_b64_tr_b16 v[20:21], v254 offset:22528
  v_mfma_f32_16x16x32_bf16 v[112:115], v[228:231], v[184:187], v[112:115]
  ds_read_b64_tr_b16 v[22:23], v254 offset:24832
  v_mfma_f32_16x16x32_bf16 v[148:151], v[228:231], v[188:191], v[148:151]
  s_waitcnt lgkmcnt(10)
  v_mfma_f32_16x16x32_bf16 v[80:83], v[232:235], v[180:183], v[80:83]
  ds_read_b64_tr_b16 v[228:229], v254 offset:22560
  v_mfma_f32_16x16x32_bf16 v[116:119], v[232:235], v[184:187], v[116:119]
  ds_read_b64_tr_b16 v[230:231], v254 offset:24864
  v_mfma_f32_16x16x32_bf16 v[152:155], v[232:235], v[188:191], v[152:155]
  s_waitcnt lgkmcnt(10)
  v_mfma_f32_16x16x32_bf16 v[84:87], v[236:239], v[180:183], v[84:87]
  ds_read_b64_tr_b16 v[232:233], v254 offset:22592
  v_mfma_f32_16x16x32_bf16 v[120:123], v[236:239], v[184:187], v[120:123]
  ds_read_b64_tr_b16 v[234:235], v254 offset:24896
  v_mfma_f32_16x16x32_bf16 v[156:159], v[236:239], v[188:191], v[156:159]
  s_waitcnt lgkmcnt(10)
  v_mfma_f32_16x16x32_bf16 v[88:91], v[240:243], v[180:183], v[88:91]
  ds_read_b64_tr_b16 v[236:237], v254 offset:22624
  v_mfma_f32_16x16x32_bf16 v[124:127], v[240:243], v[184:187], v[124:127]
  ds_read_b64_tr_b16 v[238:239], v254 offset:24928
  v_mfma_f32_16x16x32_bf16 v[160:163], v[240:243], v[188:191], v[160:163]
  s_waitcnt lgkmcnt(10)
  v_mfma_f32_16x16x32_bf16 v[92:95], v[12:15], v[180:183], v[92:95]
  ds_read_b64_tr_b16 v[240:241], v254 offset:22656
  v_mfma_f32_16x16x32_bf16 v[128:131], v[12:15], v[184:187], v[128:131]
  ds_read_b64_tr_b16 v[242:243], v254 offset:24960
  v_mfma_f32_16x16x32_bf16 v[164:167], v[12:15], v[188:191], v[164:167]
  s_waitcnt lgkmcnt(10)
  v_mfma_f32_16x16x32_bf16 v[96:99], v[16:19], v[180:183], v[96:99]
  ds_read_b64_tr_b16 v[12:13], v254 offset:22688
  v_mfma_f32_16x16x32_bf16 v[132:135], v[16:19], v[184:187], v[132:135]
  ds_read_b64_tr_b16 v[14:15], v254 offset:24992
  v_mfma_f32_16x16x32_bf16 v[168:171], v[16:19], v[188:191], v[168:171]
  s_waitcnt vmcnt(6)
  s_waitcnt lgkmcnt(10)
  v_mfma_f32_16x16x32_bf16 v[64:67], v[20:23], v[192:195], v[64:67]
  ds_read_b64_tr_b16 v[16:17], v254 offset:22720
  v_mfma_f32_16x16x32_bf16 v[100:103], v[20:23], v[196:199], v[100:103]
  ds_read_b64_tr_b16 v[18:19], v254 offset:25024
  v_mfma_f32_16x16x32_bf16 v[136:139], v[20:23], v[200:203], v[136:139]
  s_waitcnt lgkmcnt(10)
  v_mfma_f32_16x16x32_bf16 v[68:71], v[228:231], v[192:195], v[68:71]
  ds_read_b64_tr_b16 v[20:21], v254 offset:22752
  v_mfma_f32_16x16x32_bf16 v[104:107], v[228:231], v[196:199], v[104:107]
  ds_read_b64_tr_b16 v[22:23], v254 offset:25056
  v_mfma_f32_16x16x32_bf16 v[140:143], v[228:231], v[200:203], v[140:143]
  s_waitcnt lgkmcnt(10)
  v_mfma_f32_16x16x32_bf16 v[72:75], v[232:235], v[192:195], v[72:75]
  ds_read_b64_tr_b16 v[228:229], v254 offset:22784
  v_mfma_f32_16x16x32_bf16 v[108:111], v[232:235], v[196:199], v[108:111]
  ds_read_b64_tr_b16 v[230:231], v254 offset:25088
  v_mfma_f32_16x16x32_bf16 v[144:147], v[232:235], v[200:203], v[144:147]
  s_waitcnt lgkmcnt(10)
  v_mfma_f32_16x16x32_bf16 v[76:79], v[236:239], v[192:195], v[76:79]
  v_mfma_f32_16x16x32_bf16 v[112:115], v[236:239], v[196:199], v[112:115]
  v_mfma_f32_16x16x32_bf16 v[148:151], v[236:239], v[200:203], v[148:151]
  s_waitcnt lgkmcnt(8)
  v_mfma_f32_16x16x32_bf16 v[80:83], v[240:243], v[192:195], v[80:83]
  v_mfma_f32_16x16x32_bf16 v[116:119], v[240:243], v[196:199], v[116:119]
  v_mfma_f32_16x16x32_bf16 v[152:155], v[240:243], v[200:203], v[152:155]
  s_waitcnt lgkmcnt(6)
  v_mfma_f32_16x16x32_bf16 v[84:87], v[12:15], v[192:195], v[84:87]
  v_mfma_f32_16x16x32_bf16 v[120:123], v[12:15], v[196:199], v[120:123]
  v_mfma_f32_16x16x32_bf16 v[156:159], v[12:15], v[200:203], v[156:159]
  s_waitcnt lgkmcnt(4)
  v_mfma_f32_16x16x32_bf16 v[88:91], v[16:19], v[192:195], v[88:91]
  v_mfma_f32_16x16x32_bf16 v[124:127], v[16:19], v[196:199], v[124:127]
  v_mfma_f32_16x16x32_bf16 v[160:163], v[16:19], v[200:203], v[160:163]
  s_waitcnt lgkmcnt(2)
  v_mfma_f32_16x16x32_bf16 v[92:95], v[20:23], v[192:195], v[92:95]
  v_mfma_f32_16x16x32_bf16 v[128:131], v[20:23], v[196:199], v[128:131]
  v_mfma_f32_16x16x32_bf16 v[164:167], v[20:23], v[200:203], v[164:167]
  s_waitcnt lgkmcnt(0)
  v_mfma_f32_16x16x32_bf16 v[96:99], v[228:231], v[192:195], v[96:99]
  v_mfma_f32_16x16x32_bf16 v[132:135], v[228:231], v[196:199], v[132:135]
  v_mfma_f32_16x16x32_bf16 v[168:171], v[228:231], v[200:203], v[168:171]
  s_barrier
  ds_read_b64_tr_b16 v[12:13], v254 offset:31744
  ds_read_b64_tr_b16 v[14:15], v254 offset:34048
  ds_read_b64_tr_b16 v[16:17], v254 offset:31776
  ds_read_b64_tr_b16 v[18:19], v254 offset:34080
  ds_read_b64_tr_b16 v[20:21], v254 offset:31808
  ds_read_b64_tr_b16 v[22:23], v254 offset:34112
  ds_read_b64_tr_b16 v[228:229], v254 offset:31840
  ds_read_b64_tr_b16 v[230:231], v254 offset:34144
  ds_read_b64_tr_b16 v[232:233], v254 offset:31872
  ds_read_b64_tr_b16 v[234:235], v254 offset:34176
  ds_read_b64_tr_b16 v[236:237], v254 offset:31904
  ds_read_b64_tr_b16 v[238:239], v254 offset:34208
  s_waitcnt vmcnt(3)
  s_waitcnt lgkmcnt(10)
  v_mfma_f32_16x16x32_bf16 v[64:67], v[12:15], v[204:207], v[64:67]
  ds_read_b64_tr_b16 v[240:241], v254 offset:31936
  v_mfma_f32_16x16x32_bf16 v[100:103], v[12:15], v[208:211], v[100:103]
  ds_read_b64_tr_b16 v[242:243], v254 offset:34240
  v_mfma_f32_16x16x32_bf16 v[136:139], v[12:15], v[212:215], v[136:139]
  s_waitcnt lgkmcnt(10)
  v_mfma_f32_16x16x32_bf16 v[68:71], v[16:19], v[204:207], v[68:71]
  ds_read_b64_tr_b16 v[12:13], v254 offset:31968
  v_mfma_f32_16x16x32_bf16 v[104:107], v[16:19], v[208:211], v[104:107]
  ds_read_b64_tr_b16 v[14:15], v254 offset:34272
  v_mfma_f32_16x16x32_bf16 v[140:143], v[16:19], v[212:215], v[140:143]
  s_waitcnt lgkmcnt(10)
  v_mfma_f32_16x16x32_bf16 v[72:75], v[20:23], v[204:207], v[72:75]
  ds_read_b64_tr_b16 v[16:17], v254 offset:32000
  v_mfma_f32_16x16x32_bf16 v[108:111], v[20:23], v[208:211], v[108:111]
  ds_read_b64_tr_b16 v[18:19], v254 offset:34304
  v_mfma_f32_16x16x32_bf16 v[144:147], v[20:23], v[212:215], v[144:147]
  s_waitcnt lgkmcnt(10)
  v_mfma_f32_16x16x32_bf16 v[76:79], v[228:231], v[204:207], v[76:79]
  ds_read_b64_tr_b16 v[20:21], v253 offset:0
  v_mfma_f32_16x16x32_bf16 v[112:115], v[228:231], v[208:211], v[112:115]
  ds_read_b64_tr_b16 v[22:23], v253 offset:2304
  v_mfma_f32_16x16x32_bf16 v[148:151], v[228:231], v[212:215], v[148:151]
  s_waitcnt lgkmcnt(10)
  v_mfma_f32_16x16x32_bf16 v[80:83], v[232:235], v[204:207], v[80:83]
  ds_read_b64_tr_b16 v[228:229], v253 offset:32
  v_mfma_f32_16x16x32_bf16 v[116:119], v[232:235], v[208:211], v[116:119]
  ds_read_b64_tr_b16 v[230:231], v253 offset:2336
  v_mfma_f32_16x16x32_bf16 v[152:155], v[232:235], v[212:215], v[152:155]
  s_waitcnt lgkmcnt(10)
  v_mfma_f32_16x16x32_bf16 v[84:87], v[236:239], v[204:207], v[84:87]
  ds_read_b64_tr_b16 v[232:233], v253 offset:64
  v_mfma_f32_16x16x32_bf16 v[120:123], v[236:239], v[208:211], v[120:123]
  ds_read_b64_tr_b16 v[234:235], v253 offset:2368
  v_mfma_f32_16x16x32_bf16 v[156:159], v[236:239], v[212:215], v[156:159]
  s_waitcnt lgkmcnt(10)
  v_mfma_f32_16x16x32_bf16 v[88:91], v[240:243], v[204:207], v[88:91]
  ds_read_b64_tr_b16 v[236:237], v253 offset:96
  v_mfma_f32_16x16x32_bf16 v[124:127], v[240:243], v[208:211], v[124:127]
  ds_read_b64_tr_b16 v[238:239], v253 offset:2400
  v_mfma_f32_16x16x32_bf16 v[160:163], v[240:243], v[212:215], v[160:163]
  s_waitcnt lgkmcnt(10)
  v_mfma_f32_16x16x32_bf16 v[92:95], v[12:15], v[204:207], v[92:95]
  ds_read_b64_tr_b16 v[240:241], v253 offset:128
  v_mfma_f32_16x16x32_bf16 v[128:131], v[12:15], v[208:211], v[128:131]
  ds_read_b64_tr_b16 v[242:243], v253 offset:2432
  v_mfma_f32_16x16x32_bf16 v[164:167], v[12:15], v[212:215], v[164:167]
  s_waitcnt lgkmcnt(10)
  v_mfma_f32_16x16x32_bf16 v[96:99], v[16:19], v[204:207], v[96:99]
  ds_read_b64_tr_b16 v[12:13], v253 offset:160
  v_mfma_f32_16x16x32_bf16 v[132:135], v[16:19], v[208:211], v[132:135]
  ds_read_b64_tr_b16 v[14:15], v253 offset:2464
  v_mfma_f32_16x16x32_bf16 v[168:171], v[16:19], v[212:215], v[168:171]
  s_waitcnt vmcnt(0)
  s_waitcnt lgkmcnt(10)
  v_mfma_f32_16x16x32_bf16 v[100:103], v[20:23], v[220:223], v[100:103]
  ds_read_b64_tr_b16 v[18:19], v253 offset:2496
  v_mfma_f32_16x16x32_bf16 v[136:139], v[20:23], v[224:227], v[136:139]
  v_mfma_f32_16x16x32_bf16 v[64:67], v[20:23], v[216:219], v[64:67]
  ds_read_b64_tr_b16 v[16:17], v253 offset:192
  s_waitcnt lgkmcnt(10)
  v_mfma_f32_16x16x32_bf16 v[104:107], v[228:231], v[220:223], v[104:107]
  ds_read_b64_tr_b16 v[22:23], v253 offset:2528
  v_mfma_f32_16x16x32_bf16 v[140:143], v[228:231], v[224:227], v[140:143]
  v_mfma_f32_16x16x32_bf16 v[68:71], v[228:231], v[216:219], v[68:71]
  ds_read_b64_tr_b16 v[20:21], v253 offset:224
  s_waitcnt lgkmcnt(10)
  v_mfma_f32_16x16x32_bf16 v[108:111], v[232:235], v[220:223], v[108:111]
  ds_read_b64_tr_b16 v[230:231], v253 offset:2560
  v_mfma_f32_16x16x32_bf16 v[144:147], v[232:235], v[224:227], v[144:147]
  v_mfma_f32_16x16x32_bf16 v[72:75], v[232:235], v[216:219], v[72:75]
  ds_read_b64_tr_b16 v[228:229], v253 offset:256
  v_cvt_pk_bf16_f32 v24, v100, v101
  v_cvt_pk_bf16_f32 v25, v102, v103
  v_cvt_pk_bf16_f32 v44, v136, v137
  v_cvt_pk_bf16_f32 v45, v138, v139
  s_waitcnt lgkmcnt(10)
  v_mfma_f32_16x16x32_bf16 v[112:115], v[236:239], v[220:223], v[112:115]
  v_mfma_f32_16x16x32_bf16 v[148:151], v[236:239], v[224:227], v[148:151]
  v_mfma_f32_16x16x32_bf16 v[76:79], v[236:239], v[216:219], v[76:79]
  v_cvt_pk_bf16_f32 v26, v104, v105
  v_cvt_pk_bf16_f32 v27, v106, v107
  v_cvt_pk_bf16_f32 v46, v140, v141
  v_cvt_pk_bf16_f32 v47, v142, v143
  ds_write_b128 v8, v[24:27] offset:0
  ds_write_b128 v9, v[44:47] offset:0
  s_waitcnt lgkmcnt(10)
  v_mfma_f32_16x16x32_bf16 v[116:119], v[240:243], v[220:223], v[116:119]
  v_mfma_f32_16x16x32_bf16 v[152:155], v[240:243], v[224:227], v[152:155]
  v_mfma_f32_16x16x32_bf16 v[80:83], v[240:243], v[216:219], v[80:83]
  v_cvt_pk_bf16_f32 v28, v108, v109
  v_cvt_pk_bf16_f32 v29, v110, v111
  v_cvt_pk_bf16_f32 v48, v144, v145
  v_cvt_pk_bf16_f32 v49, v146, v147
  s_waitcnt lgkmcnt(8)
  v_mfma_f32_16x16x32_bf16 v[120:123], v[12:15], v[220:223], v[120:123]
  v_mfma_f32_16x16x32_bf16 v[156:159], v[12:15], v[224:227], v[156:159]
  v_mfma_f32_16x16x32_bf16 v[84:87], v[12:15], v[216:219], v[84:87]
  v_cvt_pk_bf16_f32 v30, v112, v113
  v_cvt_pk_bf16_f32 v31, v114, v115
  v_cvt_pk_bf16_f32 v50, v148, v149
  v_cvt_pk_bf16_f32 v51, v150, v151
  ds_write_b128 v8, v[28:31] offset:1024
  ds_write_b128 v9, v[48:51] offset:1024
  s_waitcnt lgkmcnt(8)
  v_mfma_f32_16x16x32_bf16 v[124:127], v[16:19], v[220:223], v[124:127]
  v_mfma_f32_16x16x32_bf16 v[160:163], v[16:19], v[224:227], v[160:163]
  v_mfma_f32_16x16x32_bf16 v[88:91], v[16:19], v[216:219], v[88:91]
  v_cvt_pk_bf16_f32 v32, v116, v117
  v_cvt_pk_bf16_f32 v33, v118, v119
  v_cvt_pk_bf16_f32 v52, v152, v153
  v_cvt_pk_bf16_f32 v53, v154, v155
  s_waitcnt lgkmcnt(6)
  v_mfma_f32_16x16x32_bf16 v[128:131], v[20:23], v[220:223], v[128:131]
  v_mfma_f32_16x16x32_bf16 v[164:167], v[20:23], v[224:227], v[164:167]
  v_mfma_f32_16x16x32_bf16 v[92:95], v[20:23], v[216:219], v[92:95]
  v_cvt_pk_bf16_f32 v34, v120, v121
  v_cvt_pk_bf16_f32 v35, v122, v123
  v_cvt_pk_bf16_f32 v54, v156, v157
  v_cvt_pk_bf16_f32 v55, v158, v159
  ds_write_b128 v8, v[32:35] offset:2048
  ds_write_b128 v9, v[52:55] offset:2048
  s_waitcnt lgkmcnt(6)
  v_mfma_f32_16x16x32_bf16 v[132:135], v[228:231], v[220:223], v[132:135]
  v_mfma_f32_16x16x32_bf16 v[168:171], v[228:231], v[224:227], v[168:171]
  v_mfma_f32_16x16x32_bf16 v[96:99], v[228:231], v[216:219], v[96:99]
  v_cvt_pk_bf16_f32 v36, v124, v125
  v_cvt_pk_bf16_f32 v37, v126, v127
  v_cvt_pk_bf16_f32 v56, v160, v161
  v_cvt_pk_bf16_f32 v57, v162, v163
  v_cvt_pk_bf16_f32 v38, v128, v129
  v_cvt_pk_bf16_f32 v39, v130, v131
  v_cvt_pk_bf16_f32 v58, v164, v165
  v_cvt_pk_bf16_f32 v59, v166, v167
  ds_write_b128 v8, v[36:39] offset:3072
  ds_write_b128 v9, v[56:59] offset:3072
  s_nop 2
  v_cvt_pk_bf16_f32 v40, v132, v133
  v_cvt_pk_bf16_f32 v41, v134, v135
  v_cvt_pk_bf16_f32 v60, v168, v169
  v_cvt_pk_bf16_f32 v61, v170, v171
  ds_write_b128 v8, v[40:43] offset:4096
  ds_write_b128 v9, v[60:63] offset:4096
  s_branch at_xch
at_r2:
  buffer_load_dword v11, v1, s[60:63], 0 offen sc1
  ds_read_b64_tr_b16 v[12:13], v253 offset:9216
  ds_read_b64_tr_b16 v[14:15], v253 offset:11520
  ds_read_b64_tr_b16 v[16:17], v253 offset:9248
  ds_read_b64_tr_b16 v[18:19], v253 offset:11552
  ds_read_b64_tr_b16 v[20:21], v253 offset:9280
  ds_read_b64_tr_b16 v[22:23], v253 offset:11584
  ds_read_b64_tr_b16 v[228:229], v253 offset:9312
  ds_read_b64_tr_b16 v[230:231], v253 offset:11616
  s_waitcnt vmcnt(14)
  s_waitcnt lgkmcnt(6)
  v_mfma_f32_16x16x32_bf16 v[64:67], v[12:15], v[24:27], 0
  ds_read_b64_tr_b16 v[232:233], v253 offset:9344
  v_mfma_f32_16x16x32_bf16 v[100:103], v[12:15], v[28:31], 0
  ds_read_b64_tr_b16 v[234:235], v253 offset:11648
  v_mfma_f32_16x16x32_bf16 v[136:139], v[12:15], v[32:35], 0
  s_waitcnt lgkmcnt(6)
  v_mfma_f32_16x16x32_bf16 v[68:71], v[16:19], v[24:27], 0
  ds_read_b64_tr_b16 v[12:13], v253 offset:9376
  v_mfma_f32_16x16x32_bf16 v[104:107], v[16:19], v[28:31], 0
  ds_read_b64_tr_b16 v[14:15], v253 offset:11680
  v_mfma_f32_16x16x32_bf16 v[140:143], v[16:19], v[32:35], 0
  s_waitcnt lgkmcnt(6)
  v_mfma_f32_16x16x32_bf16 v[72:75], v[20:23], v[24:27], 0
  ds_read_b64_tr_b16 v[16:17], v253 offset:9408
  v_mfma_f32_16x16x32_bf16 v[108:111], v[20:23], v[28:31], 0
  ds_read_b64_tr_b16 v[18:19], v253 offset:11712
  v_mfma_f32_16x16x32_bf16 v[144:147], v[20:23], v[32:35], 0
  s_waitcnt lgkmcnt(6)
  v_mfma_f32_16x16x32_bf16 v[76:79], v[228:231], v[24:27], 0
  ds_read_b64_tr_b16 v[20:21], v253 offset:9440
  v_mfma_f32_16x16x32_bf16 v[112:115], v[228:231], v[28:31], 0
  ds_read_b64_tr_b16 v[22:23], v253 offset:11744
  v_mfma_f32_16x16x32_bf16 v[148:151], v[228:231], v[32:35], 0
  s_waitcnt lgkmcnt(6)
  v_mfma_f32_16x16x32_bf16 v[80:83], v[232:235], v[24:27], 0
  ds_read_b64_tr_b16 v[228:229], v253 offset:9472
  v_mfma_f32_16x16x32_bf16 v[116:119], v[232:235], v[28:31], 0
  ds_read_b64_tr_b16 v[230:231], v253 offset:11776
  v_mfma_f32_16x16x32_bf16 v[152:155], v[232:235], v[32:35], 0
  s_waitcnt lgkmcnt(6)
  v_mfma_f32_16x16x32_bf16 v[84:87], v[12:15], v[24:27], 0
  ds_read_b64_tr_b16 v[232:233], v253 offset:18432
  v_mfma_f32_16x16x32_bf16 v[120:123], v[12:15], v[28:31], 0
  ds_read_b64_tr_b16 v[234:235], v253 offset:20736
  v_mfma_f32_16x16x32_bf16 v[156:159], v[12:15], v[32:35], 0
  s_waitcnt lgkmcnt(6)
  v_mfma_f32_16x16x32_bf16 v[88:91], v[16:19], v[24:27], 0
  ds_read_b64_tr_b16 v[12:13], v253 offset:18464
  v_mfma_f32_16x16x32_bf16 v[124:127], v[16:19], v[28:31], 0
  ds_read_b64_tr_b16 v[14:15], v253 offset:20768
  v_mfma_f32_16x16x32_bf16 v[160:163], v[16:19], v[32:35], 0
  s_waitcnt lgkmcnt(6)
  v_mfma_f32_16x16x32_bf16 v[92:95], v[20:23], v[24:27], 0
  ds_read_b64_tr_b16 v[16:17], v253 offset:18496
  v_mfma_f32_16x16x32_bf16 v[128:131], v[20:23], v[28:31], 0
  ds_read_b64_tr_b16 v[18:19], v253 offset:20800
  v_mfma_f32_16x16x32_bf16 v[164:167], v[20:23], v[32:35], 0
  s_waitcnt lgkmcnt(6)
  v_mfma_f32_16x16x32_bf16 v[96:99], v[228:231], v[24:27], 0
  ds_read_b64_tr_b16 v[20:21], v253 offset:18528
  v_mfma_f32_16x16x32_bf16 v[132:135], v[228:231], v[28:31], 0
  ds_read_b64_tr_b16 v[22:23], v253 offset:20832
  v_mfma_f32_16x16x32_bf16 v[168:171], v[228:231], v[32:35], 0
  s_barrier
  s_waitcnt vmcnt(11)
  s_waitcnt lgkmcnt(6)
  v_mfma_f32_16x16x32_bf16 v[64:67], v[232:235], v[36:39], v[64:67]
  ds_read_b64_tr_b16 v[228:229], v253 offset:18560
  v_mfma_f32_16x16x32_bf16 v[100:103], v[232:235], v[40:43], v[100:103]
  ds_read_b64_tr_b16 v[230:231], v253 offset:20864
  v_mfma_f32_16x16x32_bf16 v[136:139], v[232:235], v[44:47], v[136:139]
  s_waitcnt lgkmcnt(6)
  v_mfma_f32_16x16x32_bf16 v[68:71], v[12:15], v[36:39], v[68:71]
  ds_read_b64_tr_b16 v[232:233], v253 offset:18592
  v_mfma_f32_16x16x32_bf16 v[104:107], v[12:15], v[40:43], v[104:107]
  ds_read_b64_tr_b16 v[234:235], v253 offset:20896
  v_mfma_f32_16x16x32_bf16 v[140:143], v[12:15], v[44:47], v[140:143]
  s_waitcnt lgkmcnt(6)
  v_mfma_f32_16x16x32_bf16 v[72:75], v[16:19], v[36:39], v[72:75]
  ds_read_b64_tr_b16 v[12:13], v253 offset:18624
  v_mfma_f32_16x16x32_bf16 v[108:111], v[16:19], v[40:43], v[108:111]
  ds_read_b64_tr_b16 v[14:15], v253 offset:20928
  v_mfma_f32_16x16x32_bf16 v[144:147], v[16:19], v[44:47], v[144:147]
  s_waitcnt lgkmcnt(6)
  v_mfma_f32_16x16x32_bf16 v[76:79], v[20:23], v[36:39], v[76:79]
  ds_read_b64_tr_b16 v[16:17], v253 offset:18656
  v_mfma_f32_16x16x32_bf16 v[112:115], v[20:23], v[40:43], v[112:115]
  ds_read_b64_tr_b16 v[18:19], v253 offset:20960
  v_mfma_f32_16x16x32_bf16 v[148:151], v[20:23], v[44:47], v[148:151]
  s_waitcnt lgkmcnt(6)
  v_mfma_f32_16x16x32_bf16 v[80:83], v[228:231], v[36:39], v[80:83]
  ds_read_b64_tr_b16 v[20:21], v253 offset:18688
  v_mfma_f32_16x16x32_bf16 v[116:119], v[228:231], v[40:43], v[116:119]
  ds_read_b64_tr_b16 v[22:23], v253 offset:20992
  v_mfma_f32_16x16x32_bf16 v[152:155], v[228:231], v[44:47], v[152:155]
  s_waitcnt lgkmcnt(6)
  v_mfma_f32_16x16x32_bf16 v[84:87], v[232:235], v[36:39], v[84:87]
  v_mfma_f32_16x16x32_bf16 v[120:123], v[232:235], v[40:43], v[120:123]
  v_mfma_f32_16x16x32_bf16 v[156:159], v[232:235], v[44:47], v[156:159]
  s_waitcnt lgkmcnt(4)
  v_mfma_f32_16x16x32_bf16 v[88:91], v[12:15], v[36:39], v[88:91]
  v_mfma_f32_16x16x32_bf16 v[124:127], v[12:15], v[40:43], v[124:127]
  v_mfma_f32_16x16x32_bf16 v[160:163], v[12:15], v[44:47], v[160:163]
  s_waitcnt lgkmcnt(2)
  v_mfma_f32_16x16x32_bf16 v[92:95], v[16:19], v[36:39], v[92:95]
  v_mfma_f32_16x16x32_bf16 v[128:131], v[16:19], v[40:43], v[128:131]
  v_mfma_f32_16x16x32_bf16 v[164:167], v[16:19], v[44:47], v[164:167]
  s_waitcnt lgkmcnt(0)
  v_mfma_f32_16x16x32_bf16 v[96:99], v[20:23], v[36:39], v[96:99]
  v_mfma_f32_16x16x32_bf16 v[132:135], v[20:23], v[40:43], v[132:135]
  v_mfma_f32_16x16x32_bf16 v[168:171], v[20:23], v[44:47], v[168:171]
  s_waitcnt vmcnt(0)
  s_mov_b64 exec, 1
  buffer_store_dword v2, off, s[60:63], s101 offset:128 sc1
  s_mov_b64 exec, -1
  v_cmp_ne_u32 vcc, 1, v11
  s_cmp_eq_u64 vcc, 0
  s_cselect_b32 s89, 1, 0
  s_barrier
  s_cmp_eq_u32 s89, 0
  s_cbranch_scc1 tl2_n1
  s_add_u32 s12, s100, 3
  s_and_b32 s12, s12, 3
  s_mul_i32 s11, s12, 24576
  s_add_u32 s11, s11, s93
  buffer_load_dwordx4 v[180:183], v3, s[60:63], s11 offen offset:0 sc1
  buffer_load_dwordx4 v[184:187], v4, s[60:63], s11 offen offset:0 sc1
  buffer_load_dwordx4 v[188:191], v6, s[60:63], s11 offen offset:0 sc1
  buffer_load_dwordx4 v[192:195], v3, s[60:63], s11 offen offset:2048 sc1
  buffer_load_dwordx4 v[196:199], v4, s[60:63], s11 offen offset:2048 sc1
  buffer_load_dwordx4 v[200:203], v6, s[60:63], s11 offen offset:2048 sc1
  s_add_u32 s11, s11, 4096
  buffer_load_dwordx4 v[204:207], v3, s[60:63], s11 offen offset:0 sc1
  buffer_load_dwordx4 v[208:211], v4, s[60:63], s11 offen offset:0 sc1
  buffer_load_dwordx4 v[212:215], v6, s[60:63], s11 offen offset:0 sc1
  buffer_load_dwordx4 v[216:219], v3, s[60:63], s11 offen offset:2048 sc1
  buffer_load_dwordx4 v[220:223], v4, s[60:63], s11 offen offset:2048 sc1
  buffer_load_dwordx4 v[224:227], v6, s[60:63], s11 offen offset:2048 sc1
tl2_n1:
  ds_read_b64_tr_b16 v[12:13], v252 offset:0
  ds_read_b64_tr_b16 v[14:15], v252 offset:2304
  ds_read_b64_tr_b16 v[16:17], v252 offset:32
  ds_read_b64_tr_b16 v[18:19], v252 offset:2336
  ds_read_b64_tr_b16 v[20:21], v252 offset:64
  ds_read_b64_tr_b16 v[22:23], v252 offset:2368
  ds_read_b64_tr_b16 v[228:229], v252 offset:96
  ds_read_b64_tr_b16 v[230:231], v252 offset:2400
  ds_read_b64_tr_b16 v[232:233], v252 offset:128
  ds_read_b64_tr_b16 v[234:235], v252 offset:2432
  ds_read_b64_tr_b16 v[236:237], v252 offset:160
  ds_read_b64_tr_b16 v[238:239], v252 offset:2464
  s_waitcnt lgkmcnt(10)
  v_mfma_f32_16x16x32_bf16 v[64:67], v[12:15], v[48:51], v[64:67]
  ds_read_b64_tr_b16 v[240:241], v252 offset:192
  v_mfma_f32_16x16x32_bf16 v[100:103], v[12:15], v[52:55], v[100:103]
  ds_read_b64_tr_b16 v[242:243], v252 offset:2496
  v_mfma_f32_16x16x32_bf16 v[136:139], v[12:15], v[56:59], v[136:139]
  s_waitcnt lgkmcnt(10)
  v_mfma_f32_16x16x32_bf16 v[68:71], v[16:19], v[48:51], v[68:71]
  ds_read_b64_tr_b16 v[12:13], v252 offset:224
  v_mfma_f32_16x16x32_bf16 v[104:107], v[16:19], v[52:55], v[104:107]
  ds_read_b64_tr_b16 v[14:15], v252 offset:2528
  v_mfma_f32_16x16x32_bf16 v[140:143], v[16:19], v[56:59], v[140:143]
  s_waitcnt lgkmcnt(10)
  v_mfma_f32_16x16x32_bf16 v[72:75], v[20:23], v[48:51], v[72:75]
  ds_read_b64_tr_b16 v[16:17], v252 offset:256
  v_mfma_f32_16x16x32_bf16 v[108:111], v[20:23], v[52:55], v[108:111]
  ds_read_b64_tr_b16 v[18:19], v252 offset:2560
  v_mfma_f32_16x16x32_bf16 v[144:147], v[20:23], v[56:59], v[144:147]
  s_waitcnt lgkmcnt(10)
  v_mfma_f32_16x16x32_bf16 v[76:79], v[228:231], v[48:51], v[76:79]
  ds_read_b64_tr_b16 v[20:21], v252 offset:9216
  v_mfma_f32_16x16x32_bf16 v[112:115], v[228:231], v[52:55], v[112:115]
  ds_read_b64_tr_b16 v[22:23], v252 offset:11520
  v_mfma_f32_16x16x32_bf16 v[148:151], v[228:231], v[56:59], v[148:151]
  s_waitcnt lgkmcnt(10)
  v_mfma_f32_16x16x32_bf16 v[80:83], v[232:235], v[48:51], v[80:83]
  ds_read_b64_tr_b16 v[228:229], v252 offset:9248
  v_mfma_f32_16x16x32_bf16 v[116:119], v[232:235], v[52:55], v[116:119]
  ds_read_b64_tr_b16 v[230:231], v252 offset:11552
  v_mfma_f32_16x16x32_bf16 v[152:155], v[232:235], v[56:59], v[152:155]
  s_waitcnt lgkmcnt(10)
  v_mfma_f32_16x16x32_bf16 v[84:87], v[236:239], v[48:51], v[84:87]
  ds_read_b64_tr_b16 v[232:233], v252 offset:9280
  v_mfma_f32_16x16x32_bf16 v[120:123], v[236:239], v[52:55], v[120:123]
  ds_read_b64_tr_b16 v[234:235], v252 offset:11584
  v_mfma_f32_16x16x32_bf16 v[156:159], v[236:239], v[56:59], v[156:159]
  s_waitcnt lgkmcnt(10)
  v_mfma_f32_16x16x32_bf16 v[88:91], v[240:243], v[48:51], v[88:91]
  ds_read_b64_tr_b16 v[236:237], v252 offset:9312
  v_mfma_f32_16x16x32_bf16 v[124:127], v[240:243], v[52:55], v[124:127]
  ds_read_b64_tr_b16 v[238:239], v252 offset:11616
  v_mfma_f32_16x16x32_bf16 v[160:163], v[240:243], v[56:59], v[160:163]
  s_waitcnt lgkmcnt(10)
  v_mfma_f32_16x16x32_bf16 v[92:95], v[12:15], v[48:51], v[92:95]
  ds_read_b64_tr_b16 v[240:241], v252 offset:9344
  v_mfma_f32_16x16x32_bf16 v[128:131], v[12:15], v[52:55], v[128:131]
  ds_read_b64_tr_b16 v[242:243], v252 offset:11648
  v_mfma_f32_16x16x32_bf16 v[164:167], v[12:15], v[56:59], v[164:167]
  s_waitcnt lgkmcnt(10)
  v_mfma_f32_16x16x32_bf16 v[96:99], v[16:19], v[48:51], v[96:99]
  ds_read_b64_tr_b16 v[12:13], v252 offset:9376
  v_mfma_f32_16x16x32_bf16 v[132:135], v[16:19], v[52:55], v[132:135]
  ds_read_b64_tr_b16 v[14:15], v252 offset:11680
  v_mfma_f32_16x16x32_bf16 v[168:171], v[16:19], v[56:59], v[168:171]
  s_waitcnt lgkmcnt(10)
  v_mfma_f32_16x16x32_bf16 v[64:67], v[20:23], v[60:63], v[64:67]
  ds_read_b64_tr_b16 v[16:17], v252 offset:9408
  v_mfma_f32_16x16x32_bf16 v[100:103], v[20:23], v[172:175], v[100:103]
  ds_read_b64_tr_b16 v[18:19], v252 offset:11712
  v_mfma_f32_16x16x32_bf16 v[136:139], v[20:23], v[176:179], v[136:139]
  s_waitcnt lgkmcnt(10)
  v_mfma_f32_16x16x32_bf16 v[68:71], v[228:231], v[60:63], v[68:71]
  ds_read_b64_tr_b16 v[20:21], v252 offset:9440
  v_mfma_f32_16x16x32_bf16 v[104:107], v[228:231], v[172:175], v[104:107]
  ds_read_b64_tr_b16 v[22:23], v252 offset:11744
  v_mfma_f32_16x16x32_bf16 v[140:143], v[228:231], v[176:179], v[140:143]
  s_waitcnt lgkmcnt(10)
  v_mfma_f32_16x16x32_bf16 v[72:75], v[232:235], v[60:63], v[72:75]
  ds_read_b64_tr_b16 v[228:229], v252 offset:9472
  v_mfma_f32_16x16x32_bf16 v[108:111], v[232:235], v[172:175], v[108:111]
  ds_read_b64_tr_b16 v[230:231], v252 offset:11776
  v_mfma_f32_16x16x32_bf16 v[144:147], v[232:235], v[176:179], v[144:147]
  s_waitcnt lgkmcnt(10)
  v_mfma_f32_16x16x32_bf16 v[76:79], v[236:239], v[60:63], v[76:79]
  v_mfma_f32_16x16x32_bf16 v[112:115], v[236:239], v[172:175], v[112:115]
  v_mfma_f32_16x16x32_bf16 v[148:151], v[236:239], v[176:179], v[148:151]
  s_waitcnt lgkmcnt(8)
  v_mfma_f32_16x16x32_bf16 v[80:83], v[240:243], v[60:63], v[80:83]
  v_mfma_f32_16x16x32_bf16 v[116:119], v[240:243], v[172:175], v[116:119]
  v_mfma_f32_16x16x32_bf16 v[152:155], v[240:243], v[176:179], v[152:155]
  s_waitcnt lgkmcnt(6)
  v_mfma_f32_16x16x32_bf16 v[84:87], v[12:15], v[60:63], v[84:87]
  v_mfma_f32_16x16x32_bf16 v[120:123], v[12:15], v[172:175], v[120:123]
  v_mfma_f32_16x16x32_bf16 v[156:159], v[12:15], v[176:179], v[156:159]
  s_waitcnt lgkmcnt(4)
  v_mfma_f32_16x16x32_bf16 v[88:91], v[16:19], v[60:63], v[88:91]
  v_mfma_f32_16x16x32_bf16 v[124:127], v[16:19], v[172:175], v[124:127]
  v_mfma_f32_16x16x32_bf16 v[160:163], v[16:19], v[176:179], v[160:163]
  s_waitcnt lgkmcnt(2)
  v_mfma_f32_16x16x32_bf16 v[92:95], v[20:23], v[60:63], v[92:95]
  v_mfma_f32_16x16x32_bf16 v[128:131], v[20:23], v[172:175], v[128:131]
  v_mfma_f32_16x16x32_bf16 v[164:167], v[20:23], v[176:179], v[164:167]
  s_waitcnt lgkmcnt(0)
  v_mfma_f32_16x16x32_bf16 v[96:99], v[228:231], v[60:63], v[96:99]
  v_mfma_f32_16x16x32_bf16 v[132:135], v[228:231], v[172:175], v[132:135]
  v_mfma_f32_16x16x32_bf16 v[168:171], v[228:231], v[176:179], v[168:171]
  s_barrier
  s_cmp_lg_u32 s89, 0
  s_cbranch_scc1 tl2_y
  s_mov_b32 s43, 0
tl2_f2_spin:
  buffer_load_dword v11, v1, s[60:63], 0 offen sc1
  s_waitcnt vmcnt(0)
  v_cmp_ne_u32 vcc, 1, v11
  s_cbranch_vccz tl2_f2_ok
  s_add_u32 s43, s43, 1
  s_cmp_lt_u32 s43, 65536
  s_cbranch_scc1 tl2_f2_spin
tl2_f2_ok:
  s_add_u32 s12, s100, 3
  s_and_b32 s12, s12, 3
  s_mul_i32 s11, s12, 24576
  s_add_u32 s11, s11, s93
  buffer_load_dwordx4 v[180:183], v3, s[60:63], s11 offen offset:0 sc1
  buffer_load_dwordx4 v[184:187], v4, s[60:63], s11 offen offset:0 sc1
  buffer_load_dwordx4 v[188:191], v6, s[60:63], s11 offen offset:0 sc1
  buffer_load_dwordx4 v[192:195], v3, s[60:63], s11 offen offset:2048 sc1
  buffer_load_dwordx4 v[196:199], v4, s[60:63], s11 offen offset:2048 sc1
  buffer_load_dwordx4 v[200:203], v6, s[60:63], s11 offen offset:2048 sc1
  s_add_u32 s11, s11, 4096
  buffer_load_dwordx4 v[204:207], v3, s[60:63], s11 offen offset:0 sc1
  buffer_load_dwordx4 v[208:211], v4, s[60:63], s11 offen offset:0 sc1
  buffer_load_dwordx4 v[212:215], v6, s[60:63], s11 offen offset:0 sc1
  buffer_load_dwordx4 v[216:219], v3, s[60:63], s11 offen offset:2048 sc1
  buffer_load_dwordx4 v[220:223], v4, s[60:63], s11 offen offset:2048 sc1
  buffer_load_dwordx4 v[224:227], v6, s[60:63], s11 offen offset:2048 sc1
tl2_y:
  ds_read_b64_tr_b16 v[12:13], v253 offset:9216
  ds_read_b64_tr_b16 v[14:15], v253 offset:11520
  ds_read_b64_tr_b16 v[16:17], v253 offset:9248
  ds_read_b64_tr_b16 v[18:19], v253 offset:11552
  ds_read_b64_tr_b16 v[20:21], v253 offset:9280
  ds_read_b64_tr_b16 v[22:23], v253 offset:11584
  ds_read_b64_tr_b16 v[228:229], v253 offset:9312
  ds_read_b64_tr_b16 v[230:231], v253 offset:11616
  ds_read_b64_tr_b16 v[232:233], v253 offset:9344
  ds_read_b64_tr_b16 v[234:235], v253 offset:11648
  ds_read_b64_tr_b16 v[236:237], v253 offset:9376
  ds_read_b64_tr_b16 v[238:239], v253 offset:11680
  s_waitcnt vmcnt(9)
  s_waitcnt lgkmcnt(10)
  v_mfma_f32_16x16x32_bf16 v[64:67], v[12:15], v[180:183], v[64:67]
  ds_read_b64_tr_b16 v[240:241], v253 offset:9408
  v_mfma_f32_16x16x32_bf16 v[100:103], v[12:15], v[184:187], v[100:103]
  ds_read_b64_tr_b16 v[242:243], v253 offset:11712
  v_mfma_f32_16x16x32_bf16 v[136:139], v[12:15], v[188:191], v[136:139]
  s_waitcnt lgkmcnt(10)
  v_mfma_f32_16x16x32_bf16 v[68:71], v[16:19], v[180:183], v[68:71]
  ds_read_b64_tr_b16 v[12:13], v253 offset:9440
  v_mfma_f32_16x16x32_bf16 v[104:107], v[16:19], v[184:187], v[104:107]
  ds_read_b64_tr_b16 v[14:15], v253 offset:11744
  v_mfma_f32_16x16x32_bf16 v[140:143], v[16:19], v[188:191], v[140:143]
  s_waitcnt lgkmcnt(10)
  v_mfma_f32_16x16x32_bf16 v[72:75], v[20:23], v[180:183], v[72:75]
  ds_read_b64_tr_b16 v[16:17], v253 offset:9472
  v_mfma_f32_16x16x32_bf16 v[108:111], v[20:23], v[184:187], v[108:111]
  ds_read_b64_tr_b16 v[18:19], v253 offset:11776
  v_mfma_f32_16x16x32_bf16 v[144:147], v[20:23], v[188:191], v[144:147]
  s_waitcnt lgkmcnt(10)
  v_mfma_f32_16x16x32_bf16 v[76:79], v[228:231], v[180:183], v[76:79]
  ds_read_b64_tr_b16 v[20:21], v253 offset:18432
  v_mfma_f32_16x16x32_bf16 v[112:115], v[228:231], v[184:187], v[112:115]
  ds_read_b64_tr_b16 v[22:23], v253 offset:20736
  v_mfma_f32_16x16x32_bf16 v[148:151], v[228:231], v[188:191], v[148:151]
  s_waitcnt lgkmcnt(10)
  v_mfma_f32_16x16x32_bf16 v[80:83], v[232:235], v[180:183], v[80:83]
  ds_read_b64_tr_b16 v[228:229], v253 offset:18464
  v_mfma_f32_16x16x32_bf16 v[116:119], v[232:235], v[184:187], v[116:119]
  ds_read_b64_tr_b16 v[230:231], v253 offset:20768
  v_mfma_f32_16x16x32_bf16 v[152:155], v[232:235], v[188:191], v[152:155]
  s_waitcnt lgkmcnt(10)
  v_mfma_f32_16x16x32_bf16 v[84:87], v[236:239], v[180:183], v[84:87]
  ds_read_b64_tr_b16 v[232:233], v253 offset:18496
  v_mfma_f32_16x16x32_bf16 v[120:123], v[236:239], v[184:187], v[120:123]
  ds_read_b64_tr_b16 v[234:235], v253 offset:20800
  v_mfma_f32_16x16x32_bf16 v[156:159], v[236:239], v[188:191], v[156:159]
  s_waitcnt lgkmcnt(10)
  v_mfma_f32_16x16x32_bf16 v[88:91], v[240:243], v[180:183], v[88:91]
  ds_read_b64_tr_b16 v[236:237], v253 offset:18528
  v_mfma_f32_16x16x32_bf16 v[124:127], v[240:243], v[184:187], v[124:127]
  ds_read_b64_tr_b16 v[238:239], v253 offset:20832
  v_mfma_f32_16x16x32_bf16 v[160:163], v[240:243], v[188:191], v[160:163]
  s_waitcnt lgkmcnt(10)
  v_mfma_f32_16x16x32_bf16 v[92:95], v[12:15], v[180:183], v[92:95]
  ds_read_b64_tr_b16 v[240:241], v253 offset:18560
  v_mfma_f32_16x16x32_bf16 v[128:131], v[12:15], v[184:187], v[128:131]
  ds_read_b64_tr_b16 v[242:243], v253 offset:20864
  v_mfma_f32_16x16x32_bf16 v[164:167], v[12:15], v[188:191], v[164:167]
  s_waitcnt lgkmcnt(10)
  v_mfma_f32_16x16x32_bf16 v[96:99], v[16:19], v[180:183], v[96:99]
  ds_read_b64_tr_b16 v[12:13], v253 offset:18592
  v_mfma_f32_16x16x32_bf16 v[132:135], v[16:19], v[184:187], v[132:135]
  ds_read_b64_tr_b16 v[14:15], v253 offset:20896
  v_mfma_f32_16x16x32_bf16 v[168:171], v[16:19], v[188:191], v[168:171]
  s_waitcnt vmcnt(6)
  s_waitcnt lgkmcnt(10)
  v_mfma_f32_16x16x32_bf16 v[64:67], v[20:23], v[192:195], v[64:67]
  ds_read_b64_tr_b16 v[16:17], v253 offset:18624
  v_mfma_f32_16x16x32_bf16 v[100:103], v[20:23], v[196:199], v[100:103]
  ds_read_b64_tr_b16 v[18:19], v253 offset:20928
  v_mfma_f32_16x16x32_bf16 v[136:139], v[20:23], v[200:203], v[136:139]
  s_waitcnt lgkmcnt(10)
  v_mfma_f32_16x16x32_bf16 v[68:71], v[228:231], v[192:195], v[68:71]
  ds_read_b64_tr_b16 v[20:21], v253 offset:18656
  v_mfma_f32_16x16x32_bf16 v[104:107], v[228:231], v[196:199], v[104:107]
  ds_read_b64_tr_b16 v[22:23], v253 offset:20960
  v_mfma_f32_16x16x32_bf16 v[140:143], v[228:231], v[200:203], v[140:143]
  s_waitcnt lgkmcnt(10)
  v_mfma_f32_16x16x32_bf16 v[72:75], v[232:235], v[192:195], v[72:75]
  ds_read_b64_tr_b16 v[228:229], v253 offset:18688
  v_mfma_f32_16x16x32_bf16 v[108:111], v[232:235], v[196:199], v[108:111]
  ds_read_b64_tr_b16 v[230:231], v253 offset:20992
  v_mfma_f32_16x16x32_bf16 v[144:147], v[232:235], v[200:203], v[144:147]
  s_waitcnt lgkmcnt(10)
  v_mfma_f32_16x16x32_bf16 v[76:79], v[236:239], v[192:195], v[76:79]
  v_mfma_f32_16x16x32_bf16 v[112:115], v[236:239], v[196:199], v[112:115]
  v_mfma_f32_16x16x32_bf16 v[148:151], v[236:239], v[200:203], v[148:151]
  s_waitcnt lgkmcnt(8)
  v_mfma_f32_16x16x32_bf16 v[80:83], v[240:243], v[192:195], v[80:83]
  v_mfma_f32_16x16x32_bf16 v[116:119], v[240:243], v[196:199], v[116:119]
  v_mfma_f32_16x16x32_bf16 v[152:155], v[240:243], v[200:203], v[152:155]
  s_waitcnt lgkmcnt(6)
  v_mfma_f32_16x16x32_bf16 v[84:87], v[12:15], v[192:195], v[84:87]
  v_mfma_f32_16x16x32_bf16 v[120:123], v[12:15], v[196:199], v[120:123]
  v_mfma_f32_16x16x32_bf16 v[156:159], v[12:15], v[200:203], v[156:159]
  s_waitcnt lgkmcnt(4)
  v_mfma_f32_16x16x32_bf16 v[88:91], v[16:19], v[192:195], v[88:91]
  v_mfma_f32_16x16x32_bf16 v[124:127], v[16:19], v[196:199], v[124:127]
  v_mfma_f32_16x16x32_bf16 v[160:163], v[16:19], v[200:203], v[160:163]
  s_waitcnt lgkmcnt(2)
  v_mfma_f32_16x16x32_bf16 v[92:95], v[20:23], v[192:195], v[92:95]
  v_mfma_f32_16x16x32_bf16 v[128:131], v[20:23], v[196:199], v[128:131]
  v_mfma_f32_16x16x32_bf16 v[164:167], v[20:23], v[200:203], v[164:167]
  s_waitcnt lgkmcnt(0)
  v_mfma_f32_16x16x32_bf16 v[96:99], v[228:231], v[192:195], v[96:99]
  v_mfma_f32_16x16x32_bf16 v[132:135], v[228:231], v[196:199], v[132:135]
  v_mfma_f32_16x16x32_bf16 v[168:171], v[228:231], v[200:203], v[168:171]
  s_barrier
  ds_read_b64_tr_b16 v[12:13], v252 offset:0
  ds_read_b64_tr_b16 v[14:15], v252 offset:2304
  ds_read_b64_tr_b16 v[16:17], v252 offset:32
  ds_read_b64_tr_b16 v[18:19], v252 offset:2336
  ds_read_b64_tr_b16 v[20:21], v252 offset:64
  ds_read_b64_tr_b16 v[22:23], v252 offset:2368
  ds_read_b64_tr_b16 v[228:229], v252 offset:96
  ds_read_b64_tr_b16 v[230:231], v252 offset:2400
  ds_read_b64_tr_b16 v[232:233], v252 offset:128
  ds_read_b64_tr_b16 v[234:235], v252 offset:2432
  ds_read_b64_tr_b16 v[236:237], v252 offset:160
  ds_read_b64_tr_b16 v[238:239], v252 offset:2464
  s_waitcnt vmcnt(3)
  s_waitcnt lgkmcnt(10)
  v_mfma_f32_16x16x32_bf16 v[64:67], v[12:15], v[204:207], v[64:67]
  ds_read_b64_tr_b16 v[240:241], v252 offset:192
  v_mfma_f32_16x16x32_bf16 v[100:103], v[12:15], v[208:211], v[100:103]
  ds_read_b64_tr_b16 v[242:243], v252 offset:2496
  v_mfma_f32_16x16x32_bf16 v[136:139], v[12:15], v[212:215], v[136:139]
  s_waitcnt lgkmcnt(10)
  v_mfma_f32_16x16x32_bf16 v[68:71], v[16:19], v[204:207], v[68:71]
  ds_read_b64_tr_b16 v[12:13], v252 offset:224
  v_mfma_f32_16x16x32_bf16 v[104:107], v[16:19], v[208:211], v[104:107]
  ds_read_b64_tr_b16 v[14:15], v252 offset:2528
  v_mfma_f32_16x16x32_bf16 v[140:143], v[16:19], v[212:215], v[140:143]
  s_waitcnt lgkmcnt(10)
  v_mfma_f32_16x16x32_bf16 v[72:75], v[20:23], v[204:207], v[72:75]
  ds_read_b64_tr_b16 v[16:17], v252 offset:256
  v_mfma_f32_16x16x32_bf16 v[108:111], v[20:23], v[208:211], v[108:111]
  ds_read_b64_tr_b16 v[18:19], v252 offset:2560
  v_mfma_f32_16x16x32_bf16 v[144:147], v[20:23], v[212:215], v[144:147]
  s_waitcnt lgkmcnt(10)
  v_mfma_f32_16x16x32_bf16 v[76:79], v[228:231], v[204:207], v[76:79]
  ds_read_b64_tr_b16 v[20:21], v252 offset:9216
  v_mfma_f32_16x16x32_bf16 v[112:115], v[228:231], v[208:211], v[112:115]
  ds_read_b64_tr_b16 v[22:23], v252 offset:11520
  v_mfma_f32_16x16x32_bf16 v[148:151], v[228:231], v[212:215], v[148:151]
  s_waitcnt lgkmcnt(10)
  v_mfma_f32_16x16x32_bf16 v[80:83], v[232:235], v[204:207], v[80:83]
  ds_read_b64_tr_b16 v[228:229], v252 offset:9248
  v_mfma_f32_16x16x32_bf16 v[116:119], v[232:235], v[208:211], v[116:119]
  ds_read_b64_tr_b16 v[230:231], v252 offset:11552
  v_mfma_f32_16x16x32_bf16 v[152:155], v[232:235], v[212:215], v[152:155]
  s_waitcnt lgkmcnt(10)
  v_mfma_f32_16x16x32_bf16 v[84:87], v[236:239], v[204:207], v[84:87]
  ds_read_b64_tr_b16 v[232:233], v252 offset:9280
  v_mfma_f32_16x16x32_bf16 v[120:123], v[236:239], v[208:211], v[120:123]
  ds_read_b64_tr_b16 v[234:235], v252 offset:11584
  v_mfma_f32_16x16x32_bf16 v[156:159], v[236:239], v[212:215], v[156:159]
  s_waitcnt lgkmcnt(10)
  v_mfma_f32_16x16x32_bf16 v[88:91], v[240:243], v[204:207], v[88:91]
  ds_read_b64_tr_b16 v[236:237], v252 offset:9312
  v_mfma_f32_16x16x32_bf16 v[124:127], v[240:243], v[208:211], v[124:127]
  ds_read_b64_tr_b16 v[238:239], v252 offset:11616
  v_mfma_f32_16x16x32_bf16 v[160:163], v[240:243], v[212:215], v[160:163]
  s_waitcnt lgkmcnt(10)
  v_mfma_f32_16x16x32_bf16 v[92:95], v[12:15], v[204:207], v[92:95]
  ds_read_b64_tr_b16 v[240:241], v252 offset:9344
  v_mfma_f32_16x16x32_bf16 v[128:131], v[12:15], v[208:211], v[128:131]
  ds_read_b64_tr_b16 v[242:243], v252 offset:11648
  v_mfma_f32_16x16x32_bf16 v[164:167], v[12:15], v[212:215], v[164:167]
  s_waitcnt lgkmcnt(10)
  v_mfma_f32_16x16x32_bf16 v[96:99], v[16:19], v[204:207], v[96:99]
  ds_read_b64_tr_b16 v[12:13], v252 offset:9376
  v_mfma_f32_16x16x32_bf16 v[132:135], v[16:19], v[208:211], v[132:135]
  ds_read_b64_tr_b16 v[14:15], v252 offset:11680
  v_mfma_f32_16x16x32_bf16 v[168:171], v[16:19], v[212:215], v[168:171]
  s_waitcnt vmcnt(0)
  s_waitcnt lgkmcnt(10)
  v_mfma_f32_16x16x32_bf16 v[100:103], v[20:23], v[220:223], v[100:103]
  ds_read_b64_tr_b16 v[18:19], v252 offset:11712
  v_mfma_f32_16x16x32_bf16 v[136:139], v[20:23], v[224:227], v[136:139]
  v_mfma_f32_16x16x32_bf16 v[64:67], v[20:23], v[216:219], v[64:67]
  ds_read_b64_tr_b16 v[16:17], v252 offset:9408
  s_waitcnt lgkmcnt(10)
  v_mfma_f32_16x16x32_bf16 v[104:107], v[228:231], v[220:223], v[104:107]
  ds_read_b64_tr_b16 v[22:23], v252 offset:11744
  v_mfma_f32_16x16x32_bf16 v[140:143], v[228:231], v[224:227], v[140:143]
  v_mfma_f32_16x16x32_bf16 v[68:71], v[228:231], v[216:219], v[68:71]
  ds_read_b64_tr_b16 v[20:21], v252 offset:9440
  s_waitcnt lgkmcnt(10)
  v_mfma_f32_16x16x32_bf16 v[108:111], v[232:235], v[220:223], v[108:111]
  ds_read_b64_tr_b16 v[230:231], v252 offset:11776
  v_mfma_f32_16x16x32_bf16 v[144:147], v[232:235], v[224:227], v[144:147]
  v_mfma_f32_16x16x32_bf16 v[72:75], v[232:235], v[216:219], v[72:75]
  ds_read_b64_tr_b16 v[228:229], v252 offset:9472
  v_cvt_pk_bf16_f32 v24, v100, v101
  v_cvt_pk_bf16_f32 v25, v102, v103
  v_cvt_pk_bf16_f32 v44, v136, v137
  v_cvt_pk_bf16_f32 v45, v138, v139
  s_waitcnt lgkmcnt(10)
  v_mfma_f32_16x16x32_bf16 v[112:115], v[236:239], v[220:223], v[112:115]
  v_mfma_f32_16x16x32_bf16 v[148:151], v[236:239], v[224:227], v[148:151]
  v_mfma_f32_16x16x32_bf16 v[76:79], v[236:239], v[216:219], v[76:79]
  v_cvt_pk_bf16_f32 v26, v104, v105
  v_cvt_pk_bf16_f32 v27, v106, v107
  v_cvt_pk_bf16_f32 v46, v140, v141
  v_cvt_pk_bf16_f32 v47, v142, v143
  ds_write_b128 v8, v[24:27] offset:0
  ds_write_b128 v9, v[44:47] offset:0
  s_waitcnt lgkmcnt(10)
  v_mfma_f32_16x16x32_bf16 v[116:119], v[240:243], v[220:223], v[116:119]
  v_mfma_f32_16x16x32_bf16 v[152:155], v[240:243], v[224:227], v[152:155]
  v_mfma_f32_16x16x32_bf16 v[80:83], v[240:243], v[216:219], v[80:83]
  v_cvt_pk_bf16_f32 v28, v108, v109
  v_cvt_pk_bf16_f32 v29, v110, v111
  v_cvt_pk_bf16_f32 v48, v144, v145
  v_cvt_pk_bf16_f32 v49, v146, v147
  s_waitcnt lgkmcnt(8)
  v_mfma_f32_16x16x32_bf16 v[120:123], v[12:15], v[220:223], v[120:123]
  v_mfma_f32_16x16x32_bf16 v[156:159], v[12:15], v[224:227], v[156:159]
  v_mfma_f32_16x16x32_bf16 v[84:87], v[12:15], v[216:219], v[84:87]
  v_cvt_pk_bf16_f32 v30, v112, v113
  v_cvt_pk_bf16_f32 v31, v114, v115
  v_cvt_pk_bf16_f32 v50, v148, v149
  v_cvt_pk_bf16_f32 v51, v150, v151
  ds_write_b128 v8, v[28:31] offset:1024
  ds_write_b128 v9, v[48:51] offset:1024
  s_waitcnt lgkmcnt(8)
  v_mfma_f32_16x16x32_bf16 v[124:127], v[16:19], v[220:223], v[124:127]
  v_mfma_f32_16x16x32_bf16 v[160:163], v[16:19], v[224:227], v[160:163]
  v_mfma_f32_16x16x32_bf16 v[88:91], v[16:19], v[216:219], v[88:91]
  v_cvt_pk_bf16_f32 v32, v116, v117
  v_cvt_pk_bf16_f32 v33, v118, v119
  v_cvt_pk_bf16_f32 v52, v152, v153
  v_cvt_pk_bf16_f32 v53, v154, v155
  s_waitcnt lgkmcnt(6)
  v_mfma_f32_16x16x32_bf16 v[128:131], v[20:23], v[220:223], v[128:131]
  v_mfma_f32_16x16x32_bf16 v[164:167], v[20:23], v[224:227], v[164:167]
  v_mfma_f32_16x16x32_bf16 v[92:95], v[20:23], v[216:219], v[92:95]
  v_cvt_pk_bf16_f32 v34, v120, v121
  v_cvt_pk_bf16_f32 v35, v122, v123
  v_cvt_pk_bf16_f32 v54, v156, v157
  v_cvt_pk_bf16_f32 v55, v158, v159
  ds_write_b128 v8, v[32:35] offset:2048
  ds_write_b128 v9, v[52:55] offset:2048
  s_waitcnt lgkmcnt(6)
  v_mfma_f32_16x16x32_bf16 v[132:135], v[228:231], v[220:223], v[132:135]
  v_mfma_f32_16x16x32_bf16 v[168:171], v[228:231], v[224:227], v[168:171]
  v_mfma_f32_16x16x32_bf16 v[96:99], v[228:231], v[216:219], v[96:99]
  v_cvt_pk_bf16_f32 v36, v124, v125
  v_cvt_pk_bf16_f32 v37, v126, v127
  v_cvt_pk_bf16_f32 v56, v160, v161
  v_cvt_pk_bf16_f32 v57, v162, v163
  v_cvt_pk_bf16_f32 v38, v128, v129
  v_cvt_pk_bf16_f32 v39, v130, v131
  v_cvt_pk_bf16_f32 v58, v164, v165
  v_cvt_pk_bf16_f32 v59, v166, v167
  ds_write_b128 v8, v[36:39] offset:3072
  ds_write_b128 v9, v[56:59] offset:3072
  s_nop 2
  v_cvt_pk_bf16_f32 v40, v132, v133
  v_cvt_pk_bf16_f32 v41, v134, v135
  v_cvt_pk_bf16_f32 v60, v168, v169
  v_cvt_pk_bf16_f32 v61, v170, v171
  ds_write_b128 v8, v[40:43] offset:4096
  ds_write_b128 v9, v[60:63] offset:4096
  s_branch at_xch
at_xch:
  s_mov_b32 s9, s85
  s_waitcnt lgkmcnt(0)
  s_barrier
  ds_read_b128 v[100:103], v7 offset:0
  ds_read_b128 v[120:123], v7 offset:5120
  ds_read_b128 v[104:107], v7 offset:1024
  ds_read_b128 v[124:127], v7 offset:6144
  ds_read_b128 v[108:111], v7 offset:2048
  ds_read_b128 v[128:131], v7 offset:7168
  ds_read_b128 v[112:115], v7 offset:3072
  ds_read_b128 v[132:135], v7 offset:8192
  ds_read_b128 v[116:119], v7 offset:4096
  ds_read_b128 v[136:139], v7 offset:9216
  s_waitcnt lgkmcnt(8)
  v_lshlrev_b32 v12, 16, v100
  v_and_b32 v13, 0xffff0000, v100
  v_lshlrev_b32 v14, 16, v120
  v_and_b32 v15, 0xffff0000, v120
  v_pk_add_f32 v[64:65], v[64:65], v[12:13]
  v_pk_add_f32 v[64:65], v[64:65], v[14:15]
  v_cvt_pk_bf16_f32 v180, v64, v65
  v_lshlrev_b32 v12, 16, v101
  v_and_b32 v13, 0xffff0000, v101
  v_lshlrev_b32 v14, 16, v121
  v_and_b32 v15, 0xffff0000, v121
  v_pk_add_f32 v[66:67], v[66:67], v[12:13]
  v_pk_add_f32 v[66:67], v[66:67], v[14:15]
  v_cvt_pk_bf16_f32 v181, v66, v67
  v_lshlrev_b32 v12, 16, v102
  v_and_b32 v13, 0xffff0000, v102
  v_lshlrev_b32 v14, 16, v122
  v_and_b32 v15, 0xffff0000, v122
  v_pk_add_f32 v[68:69], v[68:69], v[12:13]
  v_pk_add_f32 v[68:69], v[68:69], v[14:15]
  v_cvt_pk_bf16_f32 v182, v68, v69
  v_lshlrev_b32 v12, 16, v103
  v_and_b32 v13, 0xffff0000, v103
  v_lshlrev_b32 v14, 16, v123
  v_and_b32 v15, 0xffff0000, v123
  v_pk_add_f32 v[70:71], v[70:71], v[12:13]
  v_pk_add_f32 v[70:71], v[70:71], v[14:15]
  v_cvt_pk_bf16_f32 v183, v70, v71
  buffer_store_dwordx4 v[180:183], v5, s[60:63], s9 offen offset:0 sc1
  s_waitcnt lgkmcnt(6)
  v_lshlrev_b32 v12, 16, v104
  v_and_b32 v13, 0xffff0000, v104
  v_lshlrev_b32 v14, 16, v124
  v_and_b32 v15, 0xffff0000, v124
  v_pk_add_f32 v[72:73], v[72:73], v[12:13]
  v_pk_add_f32 v[72:73], v[72:73], v[14:15]
  v_cvt_pk_bf16_f32 v184, v72, v73
  v_lshlrev_b32 v12, 16, v105
  v_and_b32 v13, 0xffff0000, v105
  v_lshlrev_b32 v14, 16, v125
  v_and_b32 v15, 0xffff0000, v125
  v_pk_add_f32 v[74:75], v[74:75], v[12:13]
  v_pk_add_f32 v[74:75], v[74:75], v[14:15]
  v_cvt_pk_bf16_f32 v185, v74, v75
  v_lshlrev_b32 v12, 16, v106
  v_and_b32 v13, 0xffff0000, v106
  v_lshlrev_b32 v14, 16, v126
  v_and_b32 v15, 0xffff0000, v126
  v_pk_add_f32 v[76:77], v[76:77], v[12:13]
  v_pk_add_f32 v[76:77], v[76:77], v[14:15]
  v_cvt_pk_bf16_f32 v186, v76, v77
  v_lshlrev_b32 v12, 16, v107
  v_and_b32 v13, 0xffff0000, v107
  v_lshlrev_b32 v14, 16, v127
  v_and_b32 v15, 0xffff0000, v127
  v_pk_add_f32 v[78:79], v[78:79], v[12:13]
  v_pk_add_f32 v[78:79], v[78:79], v[14:15]
  v_cvt_pk_bf16_f32 v187, v78, v79
  buffer_store_dwordx4 v[184:187], v5, s[60:63], s9 offen offset:1024 sc1
  s_waitcnt lgkmcnt(4)
  v_lshlrev_b32 v12, 16, v108
  v_and_b32 v13, 0xffff0000, v108
  v_lshlrev_b32 v14, 16, v128
  v_and_b32 v15, 0xffff0000, v128
  v_pk_add_f32 v[80:81], v[80:81], v[12:13]
  v_pk_add_f32 v[80:81], v[80:81], v[14:15]
  v_cvt_pk_bf16_f32 v188, v80, v81
  v_lshlrev_b32 v12, 16, v109
  v_and_b32 v13, 0xffff0000, v109
  v_lshlrev_b32 v14, 16, v129
  v_and_b32 v15, 0xffff0000, v129
  v_pk_add_f32 v[82:83], v[82:83], v[12:13]
  v_pk_add_f32 v[82:83], v[82:83], v[14:15]
  v_cvt_pk_bf16_f32 v189, v82, v83
  v_lshlrev_b32 v12, 16, v110
  v_and_b32 v13, 0xffff0000, v110
  v_lshlrev_b32 v14, 16, v130
  v_and_b32 v15, 0xffff0000, v130
  v_pk_add_f32 v[84:85], v[84:85], v[12:13]
  v_pk_add_f32 v[84:85], v[84:85], v[14:15]
  v_cvt_pk_bf16_f32 v190, v84, v85
  v_lshlrev_b32 v12, 16, v111
  v_and_b32 v13, 0xffff0000, v111
  v_lshlrev_b32 v14, 16, v131
  v_and_b32 v15, 0xffff0000, v131
  v_pk_add_f32 v[86:87], v[86:87], v[12:13]
  v_pk_add_f32 v[86:87], v[86:87], v[14:15]
  v_cvt_pk_bf16_f32 v191, v86, v87
  buffer_store_dwordx4 v[188:191], v5, s[60:63], s9 offen offset:2048 sc1
  s_waitcnt lgkmcnt(2)
  v_lshlrev_b32 v12, 16, v112
  v_and_b32 v13, 0xffff0000, v112
  v_lshlrev_b32 v14, 16, v132
  v_and_b32 v15, 0xffff0000, v132
  v_pk_add_f32 v[88:89], v[88:89], v[12:13]
  v_pk_add_f32 v[88:89], v[88:89], v[14:15]
  v_cvt_pk_bf16_f32 v192, v88, v89
  v_lshlrev_b32 v12, 16, v113
  v_and_b32 v13, 0xffff0000, v113
  v_lshlrev_b32 v14, 16, v133
  v_and_b32 v15, 0xffff0000, v133
  v_pk_add_f32 v[90:91], v[90:91], v[12:13]
  v_pk_add_f32 v[90:91], v[90:91], v[14:15]
  v_cvt_pk_bf16_f32 v193, v90, v91
  v_lshlrev_b32 v12, 16, v114
  v_and_b32 v13, 0xffff0000, v114
  v_lshlrev_b32 v14, 16, v134
  v_and_b32 v15, 0xffff0000, v134
  v_pk_add_f32 v[92:93], v[92:93], v[12:13]
  v_pk_add_f32 v[92:93], v[92:93], v[14:15]
  v_cvt_pk_bf16_f32 v194, v92, v93
  v_lshlrev_b32 v12, 16, v115
  v_and_b32 v13, 0xffff0000, v115
  v_lshlrev_b32 v14, 16, v135
  v_and_b32 v15, 0xffff0000, v135
  v_pk_add_f32 v[94:95], v[94:95], v[12:13]
  v_pk_add_f32 v[94:95], v[94:95], v[14:15]
  v_cvt_pk_bf16_f32 v195, v94, v95
  buffer_store_dwordx4 v[192:195], v5, s[60:63], s9 offen offset:3072 sc1
  s_waitcnt lgkmcnt(0)
  v_lshlrev_b32 v12, 16, v116
  v_and_b32 v13, 0xffff0000, v116
  v_lshlrev_b32 v14, 16, v136
  v_and_b32 v15, 0xffff0000, v136
  v_pk_add_f32 v[96:97], v[96:97], v[12:13]
  v_pk_add_f32 v[96:97], v[96:97], v[14:15]
  v_cvt_pk_bf16_f32 v196, v96, v97
  v_lshlrev_b32 v12, 16, v117
  v_and_b32 v13, 0xffff0000, v117
  v_lshlrev_b32 v14, 16, v137
  v_and_b32 v15, 0xffff0000, v137
  v_pk_add_f32 v[98:99], v[98:99], v[12:13]
  v_pk_add_f32 v[98:99], v[98:99], v[14:15]
  v_cvt_pk_bf16_f32 v197, v98, v99
  s_add_u32 s9, s9, 4096
  buffer_store_dwordx4 v[196:199], v5, s[60:63], s9 offen offset:0 sc1
  s_waitcnt vmcnt(0)
  s_mov_b64 exec, 1
  buffer_store_dword v2, off, s[60:63], s101 offset:1024 sc1
  s_mov_b64 exec, -1
  s_lshl_b32 s9, s6, 3
  s_add_u32 s9, s9, s4
  s_cmp_ge_u32 s9, 30
  s_cbranch_scc1 at_done
  v_bfe_u32 v2, v0, 3, 2
  v_lshlrev_b32 v2, 11, v2
  s_and_b32 s10, s13, 0xfc
  s_lshl_b32 s11, s10, 11
  s_add_u32 s11, s11, 20448256
  v_add_u32 v2, s11, v2
  s_mul_i32 s10, s10, 30720
  s_lshl_b32 s11, s9, 10
  s_add_u32 s10, s10, s11
  s_add_u32 s10, s10, 12582912
  v_lshlrev_b32 v3, 4, v0
  s_mul_i32 s11, s9, 13108
  s_lshr_b32 s11, s11, 16
  s_mul_i32 s12, s11, 5
  s_sub_u32 s9, s9, s12
  s_lshl_b32 s12, s11, 2
  s_lshr_b32 s12, 0x513402, s12
  s_and_b32 s12, s12, 7
  s_lshl_b32 s12, s12, 7
  v_add_u32 v2, s12, v2
  s_lshl_b32 s11, s11, 4
  s_mul_i32 s12, s7, 96
  s_add_u32 s11, s11, s12
  s_mul_i32 s11, s11, 2304
  s_mul_i32 s12, s5, 1152
  s_add_u32 s11, s11, s12
  s_mul_i32 s12, s8, 288
  s_add_u32 s11, s11, s12
  s_lshl_b32 s12, s9, 6
  s_add_u32 s11, s11, s12
  v_and_b32 v4, 15, v0
  v_mul_u32_u24 v4, 2304, v4
  v_lshrrev_b32 v5, 4, v0
  v_and_b32 v6, 1, v5
  v_lshl_add_u32 v6, v6, 5, v4
  v_lshrrev_b32 v7, 1, v5
  v_lshl_add_u32 v6, v7, 4, v6
  v_lshl_add_u32 v4, v5, 3, v4
  s_mov_b32 s43, 0
at_f3_spin:
  buffer_load_dword v5, v2, s[60:63], 0 offen sc1
  s_waitcnt vmcnt(0)
  v_cmp_ne_u32 vcc, 1, v5
  s_cbranch_vccz at_f3_ok
  s_add_u32 s43, s43, 1
  s_cmp_lt_u32 s43, 65536
  s_cbranch_scc1 at_f3_spin
at_f3_ok:
  buffer_load_dwordx4 v[8:11], v3, s[60:63], s10 offen sc1
  s_add_u32 s10, s10, 30720
  buffer_load_dwordx4 v[12:15], v3, s[60:63], s10 offen sc1
  s_add_u32 s10, s10, 30720
  buffer_load_dwordx4 v[16:19], v3, s[60:63], s10 offen sc1
  s_add_u32 s10, s10, 30720
  buffer_load_dwordx4 v[20:23], v3, s[60:63], s10 offen sc1
  s_waitcnt vmcnt(3)
  v_lshlrev_b32 v44, 16, v8
  v_and_b32 v45, 0xffff0000, v8
  v_lshlrev_b32 v46, 16, v9
  v_and_b32 v47, 0xffff0000, v9
  v_lshlrev_b32 v48, 16, v10
  v_and_b32 v49, 0xffff0000, v10
  v_lshlrev_b32 v50, 16, v11
  v_and_b32 v51, 0xffff0000, v11
  s_waitcnt vmcnt(2)
  v_lshlrev_b32 v52, 16, v12
  v_and_b32 v53, 0xffff0000, v12
  v_add_f32 v44, v44, v52
  v_add_f32 v45, v45, v53
  v_lshlrev_b32 v52, 16, v13
  v_and_b32 v53, 0xffff0000, v13
  v_add_f32 v46, v46, v52
  v_add_f32 v47, v47, v53
  v_lshlrev_b32 v52, 16, v14
  v_and_b32 v53, 0xffff0000, v14
  v_add_f32 v48, v48, v52
  v_add_f32 v49, v49, v53
  v_lshlrev_b32 v52, 16, v15
  v_and_b32 v53, 0xffff0000, v15
  v_add_f32 v50, v50, v52
  v_add_f32 v51, v51, v53
  s_waitcnt vmcnt(1)
  v_lshlrev_b32 v52, 16, v16
  v_and_b32 v53, 0xffff0000, v16
  v_add_f32 v44, v44, v52
  v_add_f32 v45, v45, v53
  v_lshlrev_b32 v52, 16, v17
  v_and_b32 v53, 0xffff0000, v17
  v_add_f32 v46, v46, v52
  v_add_f32 v47, v47, v53
  v_lshlrev_b32 v52, 16, v18
  v_and_b32 v53, 0xffff0000, v18
  v_add_f32 v48, v48, v52
  v_add_f32 v49, v49, v53
  v_lshlrev_b32 v52, 16, v19
  v_and_b32 v53, 0xffff0000, v19
  v_add_f32 v50, v50, v52
  v_add_f32 v51, v51, v53
  s_waitcnt vmcnt(0)
  v_lshlrev_b32 v52, 16, v20
  v_and_b32 v53, 0xffff0000, v20
  v_add_f32 v44, v44, v52
  v_add_f32 v45, v45, v53
  v_lshlrev_b32 v52, 16, v21
  v_and_b32 v53, 0xffff0000, v21
  v_add_f32 v46, v46, v52
  v_add_f32 v47, v47, v53
  v_lshlrev_b32 v52, 16, v22
  v_and_b32 v53, 0xffff0000, v22
  v_add_f32 v48, v48, v52
  v_add_f32 v49, v49, v53
  v_lshlrev_b32 v52, 16, v23
  v_and_b32 v53, 0xffff0000, v23
  v_add_f32 v50, v50, v52
  v_add_f32 v51, v51, v53
  v_cvt_pk_bf16_f32 v8, v44, v45
  v_cvt_pk_bf16_f32 v9, v46, v47
  v_cvt_pk_bf16_f32 v10, v48, v49
  v_cvt_pk_bf16_f32 v11, v50, v51
  s_cmp_eq_u32 s9, 4
  s_cbranch_scc1 at_narrow
  v_permlane16_swap_b32 v8, v10
  v_permlane16_swap_b32 v9, v11
  buffer_store_dwordx4 v[8:11], v6, s[68:71], s11 offen sc1
  s_branch at_st
at_narrow:
  buffer_store_dwordx2 v[8:9], v4, s[68:71], s11 offen sc1
at_st:
at_done:
  s_endpgm
at_mid:
  s_cmp_lg_u32 s4, 1
  s_cbranch_scc1 at_mid_nc
  s_getpc_b64 s[94:95]
cpf1_pc:
  s_add_u32 s94, s94, concat_heads__mha_block_cached__gqa_block_cached__near_ridge_kernel-cpf1_pc
  s_addc_u32 s95, s95, (concat_heads__mha_block_cached__gqa_block_cached__near_ridge_kernel-cpf1_pc)>>32
  s_lshr_b32 s9, s13, 3
  s_mul_i32 s9, s9, 2048
  s_add_u32 s10, s9, 0
  s_min_u32 s10, s10, L_end-concat_heads__mha_block_cached__gqa_block_cached__near_ridge_kernel-1024
  v_lshl_add_u32 v240, v0, 4, s10
  global_load_dwordx4 v[242:245], v240, s[94:95]
  s_add_u32 s10, s9, 1024
  s_min_u32 s10, s10, L_end-concat_heads__mha_block_cached__gqa_block_cached__near_ridge_kernel-1024
  v_lshl_add_u32 v240, v0, 4, s10
  global_load_dwordx4 v[242:245], v240, s[94:95]
at_mid_nc:
  s_cmp_eq_u32 s75, 0
  s_cbranch_scc1 at_midback
  s_waitcnt vmcnt(0)
  v_mov_b32 v15, 1
  s_mov_b64 exec, 1
  buffer_store_dword v15, off, s[60:63], s88 sc1
  s_mov_b64 exec, -1
  s_branch at_midback
ats_rare:
  v_max3_f32 v20, v176, v177, v178
  v_max3_f32 v20, v20, v179, v180
  v_max3_f32 v20, v20, v181, v182
  v_max3_f32 v20, v20, v183, v184
  v_max3_f32 v20, v20, v185, v186
  v_max3_f32 v20, v20, v187, v188
  v_max3_f32 v20, v20, v189, v190
  v_max_f32 v20, v20, v191
  v_mov_b32 v21, v20
  s_nop 1
  v_permlane32_swap_b32 v20, v21
  s_nop 1
  v_max_f32 v20, v20, v21
  v_max_f32 v20, 0, v20
  v_sub_f32 v21, 0, v20
  v_exp_f32 v21, v21
  v_sub_f32 v176, v176, v20
  v_sub_f32 v177, v177, v20
  v_sub_f32 v178, v178, v20
  v_sub_f32 v179, v179, v20
  v_sub_f32 v180, v180, v20
  v_sub_f32 v181, v181, v20
  v_sub_f32 v182, v182, v20
  v_sub_f32 v183, v183, v20
  v_sub_f32 v184, v184, v20
  v_sub_f32 v185, v185, v20
  v_sub_f32 v186, v186, v20
  v_sub_f32 v187, v187, v20
  v_sub_f32 v188, v188, v20
  v_sub_f32 v189, v189, v20
  v_sub_f32 v190, v190, v20
  v_sub_f32 v191, v191, v20
  v_sub_f32 v160, v160, v20
  v_sub_f32 v161, v161, v20
  v_sub_f32 v162, v162, v20
  v_sub_f32 v163, v163, v20
  v_sub_f32 v164, v164, v20
  v_sub_f32 v165, v165, v20
  v_sub_f32 v166, v166, v20
  v_sub_f32 v167, v167, v20
  v_sub_f32 v168, v168, v20
  v_sub_f32 v169, v169, v20
  v_sub_f32 v170, v170, v20
  v_sub_f32 v171, v171, v20
  v_sub_f32 v172, v172, v20
  v_sub_f32 v173, v173, v20
  v_sub_f32 v174, v174, v20
  v_sub_f32 v175, v175, v20
  v_mul_f32 v64, v64, v21
  v_mul_f32 v65, v65, v21
  v_mul_f32 v66, v66, v21
  v_mul_f32 v67, v67, v21
  v_mul_f32 v68, v68, v21
  v_mul_f32 v69, v69, v21
  v_mul_f32 v70, v70, v21
  v_mul_f32 v71, v71, v21
  v_mul_f32 v72, v72, v21
  v_mul_f32 v73, v73, v21
  v_mul_f32 v74, v74, v21
  v_mul_f32 v75, v75, v21
  v_mul_f32 v76, v76, v21
  v_mul_f32 v77, v77, v21
  v_mul_f32 v78, v78, v21
  v_mul_f32 v79, v79, v21
  v_mul_f32 v80, v80, v21
  v_mul_f32 v81, v81, v21
  v_mul_f32 v82, v82, v21
  v_mul_f32 v83, v83, v21
  v_mul_f32 v84, v84, v21
  v_mul_f32 v85, v85, v21
  v_mul_f32 v86, v86, v21
  v_mul_f32 v87, v87, v21
  v_mul_f32 v88, v88, v21
  v_mul_f32 v89, v89, v21
  v_mul_f32 v90, v90, v21
  v_mul_f32 v91, v91, v21
  v_mul_f32 v92, v92, v21
  v_mul_f32 v93, v93, v21
  v_mul_f32 v94, v94, v21
  v_mul_f32 v95, v95, v21
  v_mul_f32 v96, v96, v21
  v_mul_f32 v97, v97, v21
  v_mul_f32 v98, v98, v21
  v_mul_f32 v99, v99, v21
  v_mul_f32 v100, v100, v21
  v_mul_f32 v101, v101, v21
  v_mul_f32 v102, v102, v21
  v_mul_f32 v103, v103, v21
  v_mul_f32 v104, v104, v21
  v_mul_f32 v105, v105, v21
  v_mul_f32 v106, v106, v21
  v_mul_f32 v107, v107, v21
  v_mul_f32 v108, v108, v21
  v_mul_f32 v109, v109, v21
  v_mul_f32 v110, v110, v21
  v_mul_f32 v111, v111, v21
  v_mul_f32 v112, v112, v21
  v_mul_f32 v113, v113, v21
  v_mul_f32 v114, v114, v21
  v_mul_f32 v115, v115, v21
  v_mul_f32 v116, v116, v21
  v_mul_f32 v117, v117, v21
  v_mul_f32 v118, v118, v21
  v_mul_f32 v119, v119, v21
  v_mul_f32 v120, v120, v21
  v_mul_f32 v121, v121, v21
  v_mul_f32 v122, v122, v21
  v_mul_f32 v123, v123, v21
  v_mul_f32 v124, v124, v21
  v_mul_f32 v125, v125, v21
  v_mul_f32 v126, v126, v21
  v_mul_f32 v127, v127, v21
  v_mul_f32 v12, v12, v21
  v_exp_f32 v16, v176
  v_exp_f32 v17, v177
  v_exp_f32 v18, v178
  v_exp_f32 v19, v179
  v_mov_b32 v13, v16
  v_mov_b32 v14, v17
  v_cvt_pk_bf16_f32 v192, v16, v17
  v_exp_f32 v16, v180
  v_exp_f32 v17, v181
  v_add_f32 v13, v13, v18
  v_add_f32 v14, v14, v19
  v_cvt_pk_bf16_f32 v193, v18, v19
  v_exp_f32 v18, v182
  v_exp_f32 v19, v183
  v_add_f32 v13, v13, v16
  v_add_f32 v14, v14, v17
  v_cvt_pk_bf16_f32 v194, v16, v17
  v_exp_f32 v16, v184
  v_exp_f32 v17, v185
  v_add_f32 v13, v13, v18
  v_add_f32 v14, v14, v19
  v_cvt_pk_bf16_f32 v195, v18, v19
  v_exp_f32 v18, v186
  v_exp_f32 v19, v187
  v_add_f32 v13, v13, v16
  v_add_f32 v14, v14, v17
  v_cvt_pk_bf16_f32 v196, v16, v17
  v_exp_f32 v16, v188
  v_exp_f32 v17, v189
  v_add_f32 v13, v13, v18
  v_add_f32 v14, v14, v19
  v_cvt_pk_bf16_f32 v197, v18, v19
  v_exp_f32 v18, v190
  v_exp_f32 v19, v191
  v_add_f32 v13, v13, v16
  v_add_f32 v14, v14, v17
  v_cvt_pk_bf16_f32 v198, v16, v17
  s_nop 0
  v_add_f32 v13, v13, v18
  v_add_f32 v14, v14, v19
  v_cvt_pk_bf16_f32 v199, v18, v19
  v_add_f32 v13, v13, v14
  s_branch ats_back
L_end:
  s_endpgm
.section .rodata,"a"
.p2align 6
.amdhsa_kernel concat_heads__mha_block_cached__gqa_block_cached__near_ridge_kernel
  .amdhsa_next_free_vgpr 256
  .amdhsa_next_free_sgpr 102
  .amdhsa_accum_offset 256
  .amdhsa_group_segment_fixed_size 0
  .amdhsa_kernarg_size 104
  .amdhsa_user_sgpr_count 2
  .amdhsa_user_sgpr_kernarg_segment_ptr 1
  .amdhsa_system_sgpr_workgroup_id_x 1
.end_amdhsa_kernel
```
